```python
import torch

def _softmax(x, axis=-1):
    return torch.softmax(x, dim=axis)

def _gelu(x):
    return torch.nn.functional.gelu(x, approximate='tanh')

def _silu(x):
    return torch.nn.functional.silu(x)

def _sigmoid(x):
    return torch.sigmoid(x)

def _layernorm(x, axis=-1, eps=1e-05):
    m = x.mean(dim=axis, keepdim=True)
    v = x.var(dim=axis, keepdim=True, unbiased=False)
    return (x - m) / torch.sqrt(v + eps)

def _scatter_add(tgt, idx, src, axis=0):
    return tgt.clone().index_add_(axis, idx, src)

def _segment_sum(src, seg, n):
    out = torch.zeros((n,) + src.shape[1:], dtype=src.dtype)
    return out.index_add_(0, seg, src)

def _pad(x, pw):
    flat = tuple((v for pair in reversed(pw) for v in pair))
    return torch.nn.functional.pad(x, flat)
kernel_name = 'adaLN_cond__grouped_kv_mqa__dense_activation_silu__prompt'

def setup_inputs():

    _w = lambda a: (lambda t: t.to(torch.bfloat16) if t.is_floating_point() else t)(torch.as_tensor(a))

    def _A_setup():
        B, S, D, H = (1, 2048, 1024, 32)
        Dh = D // H
        return {'x': _w((lambda *s: torch.randn(*s, dtype=torch.bfloat16) * 0.05)(B, S, D)), 'wq': _w((lambda *s: torch.randn(*s, dtype=torch.bfloat16) * 0.05)(D, H * Dh)), 'wk': _w((lambda *s: torch.randn(*s, dtype=torch.bfloat16) * 0.05)(D, Dh)), 'wv': _w((lambda *s: torch.randn(*s, dtype=torch.bfloat16) * 0.05)(D, Dh)), 'wo': _w((lambda *s: torch.randn(*s, dtype=torch.bfloat16) * 0.05)(H * Dh, D))}
    _A_in = _A_setup()

    def _B_setup():
        B, S, D, F = (1, 2048, 1024, 3584)
        return {'x': _w((lambda *s: torch.randn(*s, dtype=torch.bfloat16) * 0.05)(B, S, D)), 'w1': _w((lambda *s: torch.randn(*s, dtype=torch.bfloat16) * 3.2)(D, F) * D ** (-0.5)), 'w2': _w((lambda *s: torch.randn(*s, dtype=torch.bfloat16) * 0.8)(F, D) * F ** (-0.5))}
    _B_in = _B_setup()
    return {'A_x': _A_in['x'], 'A_wq': _A_in['wq'], 'A_wk': _A_in['wk'], 'A_wv': _A_in['wv'], 'A_wo': _A_in['wo'], 'B_x': _B_in['x'], 'B_w1': _B_in['w1'], 'B_w2': _B_in['w2'], 'c': _w((lambda *s: torch.randn(*s, dtype=torch.bfloat16) * 0.1)(1, 1024) * 8.0), 'w_mod': _w((lambda *s: torch.randn(*s, dtype=torch.bfloat16) * 0.1)(1024, 6 * 1024) * 1024 ** (-0.5) * 8.0)}

def reference(A_x, A_wq, A_wk, A_wv, A_wo, B_x, B_w1, B_w2, c, w_mod):

    def _A_ref(x, wq, wk, wv, wo):
        B, S, D = x.shape
        H = 32
        Dh = D // H
        q = (lambda x, *d: x.permute(*d))((x @ wq).reshape(B, S, H, Dh), 0, 2, 1, 3)
        k = x @ wk
        v = x @ wv
        scores = torch.einsum('bhqd,bkd->bhqk', q, k) * Dh ** (-0.5)
        p = _softmax(scores, axis=-1)
        o = torch.einsum('bhqk,bkd->bhqd', p, v)
        return (lambda x, *d: x.permute(*d))(o, 0, 2, 1, 3).reshape(B, S, H * Dh) @ wo

    def _B_ref(x, w1, w2):
        h = torch.einsum('bsd,df->bsf', x, w1)
        h = _silu(h)
        out = torch.einsum('bsf,fd->bsd', h, w2)
        return out
    x = A_x
    mod = (_silu(c) @ w_mod).reshape(c.shape[0], 6, 1, -1)
    sa, ca, ga, sb, cb, gb = (mod[:, 0].clone(), mod[:, 1].clone(), mod[:, 2].clone(), mod[:, 3].clone(), mod[:, 4].clone(), mod[:, 5].clone())
    h = _layernorm(x, axis=-1) * (1 + ca) + sa
    x = x + ga * _A_ref(h, A_wq, A_wk, A_wv, A_wo)
    h = _layernorm(x, axis=-1) * (1 + cb) + sb
    x = x + gb * _B_ref(h, B_w1, B_w2)
    return x
```

```asm
; @launch kernel=k1_mod_ln_kernel grid=(256,1,1) block=(512,1,1) lds=33792
; @launch kernel=k2_qkv_kernel grid=(256,1,1) block=(256,1,1) lds=124928
; @launch kernel=k3_attn_kernel grid=(256,1,1) block=(256,1,1) lds=163840
.amdgcn_target "amdgcn-amd-amdhsa--gfx950"
.text
.globl k1_mod_ln_kernel
.p2align 8
.type k1_mod_ln_kernel,@function
k1_mod_ln_kernel:
    s_cmp_ge_u32 s2, 256
    s_cbranch_scc1 K1_END
    s_load_dwordx8 s[40:47], s[0:1], 0
    s_load_dwordx4 s[8:11], s[0:1], 64
    s_load_dwordx2 s[6:7], s[0:1], 96
    s_load_dwordx4 s[48:51], s[0:1], 48
    s_load_dwordx2 s[52:53], s[0:1], 32
    s_load_dwordx2 s[54:55], s[0:1], 80
    v_and_b32 v1, 63, v0
    v_lshrrev_b32 v2, 6, v0
    s_lshr_b32 s28, s2, 1
    v_readfirstlane_b32 s33, v2
    s_and_b32 s29, s2, 7
    s_lshr_b32 s28, s2, 4
    s_lshl_b32 s28, s28, 3
    s_add_u32 s28, s28, s29
    s_bitcmp1_b32 s2, 3
    s_cbranch_scc1 K1_LN
    s_and_b32 s29, s28, 31
    s_lshr_b32 s28, s28, 5
    v_lshrrev_b32 v3, 3, v0
    v_lshlrev_b32 v3, 2, v3
    s_lshl_b32 s30, s28, 8
    v_add_u32 v3, s30, v3
    v_mul_u32_u24 v4, 12288, v3
    v_and_b32 v5, 7, v1
    v_lshl_add_u32 v4, v5, 4, v4
    s_lshl_b32 s32, s29, 7
    v_lshlrev_b32 v6, 1, v3
    s_waitcnt lgkmcnt(0)
    s_mov_b32 s20, s10
    s_and_b32 s21, s11, 0xffff
    s_mov_b32 s22, 0xc00000
    s_mov_b32 s23, 0x20000
    global_load_dwordx2 v[8:9], v6, s[8:9]
    buffer_load_dwordx4 v[16:19], v4, s[20:23], s32 offen nt
    s_add_u32 s32, s32, 12288
    buffer_load_dwordx4 v[20:23], v4, s[20:23], s32 offen nt
    s_add_u32 s32, s32, 12288
    buffer_load_dwordx4 v[24:27], v4, s[20:23], s32 offen nt
    s_add_u32 s32, s32, 12288
    buffer_load_dwordx4 v[28:31], v4, s[20:23], s32 offen nt
    s_mov_b32 s24, s6
    s_and_b32 s25, s7, 0xffff
    s_mov_b32 s26, 0x3400000
    s_mov_b32 s27, 0x20000
    s_cmp_ge_u32 s33, 4
    s_cbranch_scc1 K1_PFAG
    s_lshr_b32 s36, s2, 3
    s_lshl_b32 s36, s36, 2
    s_add_u32 s36, s36, s33
    s_lshl_b32 s36, s36, 14
    s_and_b32 s37, s2, 1
    s_lshl_b32 s37, s37, 10
    s_add_u32 s36, s36, s37
    v_lshrrev_b32 v60, 3, v1
    v_lshlrev_b32 v60, 11, v60
    v_and_b32 v61, 7, v1
    v_lshl_add_u32 v60, v61, 7, v60
    v_add_u32 v60, s36, v60
    global_load_dword v60, v60, s[42:43]
    s_branch K1_PFG
K1_PFAG:
    s_cmp_eq_u32 s33, 4
    s_cbranch_scc0 K1_PFBG
    s_cmp_ge_u32 s2, 64
    s_cbranch_scc1 K1_PFG
    s_bitcmp1_b32 s2, 0
    s_cselect_b32 s36, s46, s44
    s_cselect_b32 s37, s47, s45
    s_lshr_b32 s38, s2, 3
    s_lshl_b32 s38, s38, 13
    v_lshlrev_b32 v60, 7, v1
    v_add_u32 v60, s38, v60
    global_load_dword v60, v60, s[36:37]
    s_branch K1_PFG
K1_PFBG:
    s_cmp_eq_u32 s33, 5
    s_cbranch_scc0 K1_PFCG
    s_lshr_b32 s35, s2, 3
    s_cmp_ge_u32 s35, (CODE_END-k2_qkv_kernel+8191)/8192
    s_cbranch_scc1 CPF_K1G
    s_getpc_b64 s[36:37]
CPC_K1G:
    s_lshl_b32 s35, s35, 13
    s_add_u32 s35, s35, (k2_qkv_kernel-CPC_K1G)
    s_min_u32 s35, s35, (CODE_END-CPC_K1G-8192)
    v_lshlrev_b32 v60, 7, v1
    v_add_u32 v60, s35, v60
    global_load_dword v60, v60, s[36:37]
CPF_K1G:
    s_branch K1_PFG
K1_PFCG:
    s_cmp_eq_u32 s33, 7
    s_cbranch_scc0 K1_PFDG
    s_lshl_b32 s38, s2, 13
    v_lshlrev_b32 v60, 7, v1
    v_add_u32 v60, s38, v60
    global_load_dword v60, v60, s[52:53]
    s_branch K1_PFG
K1_PFDG:
    s_cmp_eq_u32 s33, 6
    s_cbranch_scc0 K1_PFG
    s_cmp_ge_u32 s2, 16
    s_cbranch_scc1 K1_PFG
    v_lshlrev_b32 v60, 21, v1
    buffer_load_dword v61, v60, s[24:27], 0 offen
    v_and_b32 v60, 0x600000, v60
    global_load_dword v61, v60, s[48:49]
    global_load_dword v61, v60, s[50:51]
    v_and_b32 v60, 0x200000, v60
    global_load_dword v61, v60, s[54:55]
    v_mov_b32 v60, 0
    global_load_dword v61, v60, s[52:53]
K1_PFG:
    s_waitcnt vmcnt(4)
    v_lshlrev_b32 v48, 16, v8
    v_and_b32 v49, 0xffff0000, v8
    v_lshlrev_b32 v50, 16, v9
    v_and_b32 v51, 0xffff0000, v9
    v_mul_f32 v56, 0xbfb8aa3b, v48
    v_mul_f32 v57, 0xbfb8aa3b, v49
    v_mul_f32 v58, 0xbfb8aa3b, v50
    v_mul_f32 v59, 0xbfb8aa3b, v51
    v_exp_f32 v56, v56
    v_exp_f32 v57, v57
    v_exp_f32 v58, v58
    v_exp_f32 v59, v59
    s_nop 0
    v_add_f32 v56, 1.0, v56
    v_add_f32 v57, 1.0, v57
    v_add_f32 v58, 1.0, v58
    v_add_f32 v59, 1.0, v59
    v_rcp_f32 v56, v56
    v_rcp_f32 v57, v57
    v_rcp_f32 v58, v58
    v_rcp_f32 v59, v59
    s_nop 0
    v_mul_f32 v48, v48, v56
    v_mul_f32 v49, v49, v57
    v_mul_f32 v50, v50, v58
    v_mul_f32 v51, v51, v59
    v_cvt_pk_bf16_f32 v10, v48, v49
    v_cvt_pk_bf16_f32 v11, v50, v51
    v_lshlrev_b32 v48, 16, v10
    v_and_b32 v49, 0xffff0000, v10
    v_lshlrev_b32 v50, 16, v11
    v_and_b32 v51, 0xffff0000, v11
    s_waitcnt vmcnt(3)
    v_lshlrev_b32 v56, 16, v16
    v_and_b32 v57, 0xffff0000, v16
    v_pk_mul_f32 v[32:33], v[56:57], v[48:49] op_sel_hi:[1,0]
    v_lshlrev_b32 v56, 16, v17
    v_and_b32 v57, 0xffff0000, v17
    v_pk_mul_f32 v[34:35], v[56:57], v[48:49] op_sel_hi:[1,0]
    v_lshlrev_b32 v56, 16, v18
    v_and_b32 v57, 0xffff0000, v18
    v_pk_mul_f32 v[36:37], v[56:57], v[48:49] op_sel_hi:[1,0]
    v_lshlrev_b32 v56, 16, v19
    v_and_b32 v57, 0xffff0000, v19
    v_pk_mul_f32 v[38:39], v[56:57], v[48:49] op_sel_hi:[1,0]
    s_waitcnt vmcnt(2)
    v_lshlrev_b32 v56, 16, v20
    v_and_b32 v57, 0xffff0000, v20
    v_pk_fma_f32 v[32:33], v[56:57], v[48:49], v[32:33] op_sel:[0,1,0] op_sel_hi:[1,1,1]
    v_lshlrev_b32 v56, 16, v21
    v_and_b32 v57, 0xffff0000, v21
    v_pk_fma_f32 v[34:35], v[56:57], v[48:49], v[34:35] op_sel:[0,1,0] op_sel_hi:[1,1,1]
    v_lshlrev_b32 v56, 16, v22
    v_and_b32 v57, 0xffff0000, v22
    v_pk_fma_f32 v[36:37], v[56:57], v[48:49], v[36:37] op_sel:[0,1,0] op_sel_hi:[1,1,1]
    v_lshlrev_b32 v56, 16, v23
    v_and_b32 v57, 0xffff0000, v23
    v_pk_fma_f32 v[38:39], v[56:57], v[48:49], v[38:39] op_sel:[0,1,0] op_sel_hi:[1,1,1]
    s_waitcnt vmcnt(1)
    v_lshlrev_b32 v56, 16, v24
    v_and_b32 v57, 0xffff0000, v24
    v_pk_fma_f32 v[32:33], v[56:57], v[50:51], v[32:33] op_sel_hi:[1,0,1]
    v_lshlrev_b32 v56, 16, v25
    v_and_b32 v57, 0xffff0000, v25
    v_pk_fma_f32 v[34:35], v[56:57], v[50:51], v[34:35] op_sel_hi:[1,0,1]
    v_lshlrev_b32 v56, 16, v26
    v_and_b32 v57, 0xffff0000, v26
    v_pk_fma_f32 v[36:37], v[56:57], v[50:51], v[36:37] op_sel_hi:[1,0,1]
    v_lshlrev_b32 v56, 16, v27
    v_and_b32 v57, 0xffff0000, v27
    v_pk_fma_f32 v[38:39], v[56:57], v[50:51], v[38:39] op_sel_hi:[1,0,1]
    s_waitcnt vmcnt(0)
    v_lshlrev_b32 v56, 16, v28
    v_and_b32 v57, 0xffff0000, v28
    v_pk_fma_f32 v[32:33], v[56:57], v[50:51], v[32:33] op_sel:[0,1,0] op_sel_hi:[1,1,1]
    v_lshlrev_b32 v56, 16, v29
    v_and_b32 v57, 0xffff0000, v29
    v_pk_fma_f32 v[34:35], v[56:57], v[50:51], v[34:35] op_sel:[0,1,0] op_sel_hi:[1,1,1]
    v_lshlrev_b32 v56, 16, v30
    v_and_b32 v57, 0xffff0000, v30
    v_pk_fma_f32 v[36:37], v[56:57], v[50:51], v[36:37] op_sel:[0,1,0] op_sel_hi:[1,1,1]
    v_lshlrev_b32 v56, 16, v31
    v_and_b32 v57, 0xffff0000, v31
    v_pk_fma_f32 v[38:39], v[56:57], v[50:51], v[38:39] op_sel:[0,1,0] op_sel_hi:[1,1,1]
    s_nop 1
    v_permlane16_swap_b32 v32, v33
    v_permlane16_swap_b32 v34, v35
    v_permlane16_swap_b32 v36, v37
    v_permlane16_swap_b32 v38, v39
    v_add_f32 v40, v32, v33
    v_add_f32 v41, v34, v35
    v_add_f32 v42, v36, v37
    v_add_f32 v43, v38, v39
    v_lshrrev_b32 v7, 4, v1
    v_lshl_add_u32 v7, v5, 3, v7
    v_permlane32_swap_b32 v40, v41
    v_permlane32_swap_b32 v42, v43
    v_add_f32 v44, v40, v41
    v_add_f32 v45, v42, v43
    v_lshlrev_b32 v7, 2, v7
    v_lshl_add_u32 v7, v2, 8, v7
    v_add_f32_dpp v46, v44, v44 row_ror:8 row_mask:0xf bank_mask:0xf
    v_add_f32_dpp v47, v45, v45 row_ror:8 row_mask:0xf bank_mask:0xf
    ds_write_b32 v7, v46
    ds_write_b32 v7, v47 offset:16
    s_cmp_lg_u32 s29, 0
    s_cbranch_scc1 K1_NOSC
    s_mov_b32 s34, 98304
    buffer_store_dwordx2 v[10:11], v6, s[24:27], s34 offen sc1
K1_NOSC:
    s_waitcnt lgkmcnt(0)
    s_barrier
    s_cmp_lg_u32 s33, 7
    s_cbranch_scc1 K1_DONE
    v_lshlrev_b32 v7, 2, v1
    ds_read_b32 v16, v7 offset:0
    ds_read_b32 v17, v7 offset:256
    ds_read_b32 v18, v7 offset:512
    ds_read_b32 v19, v7 offset:768
    ds_read_b32 v20, v7 offset:1024
    ds_read_b32 v21, v7 offset:1280
    ds_read_b32 v22, v7 offset:1536
    ds_read_b32 v23, v7 offset:1792
    s_mul_i32 s34, s28, 24576
    s_lshl_b32 s35, s29, 8
    s_add_u32 s34, s34, s35
    s_add_u32 s34, s34, 0
    s_waitcnt lgkmcnt(0)
    v_add_f32 v16, v16, v17
    v_add_f32 v18, v18, v19
    v_add_f32 v20, v20, v21
    v_add_f32 v22, v22, v23
    v_add_f32 v16, v16, v18
    v_add_f32 v20, v20, v22
    v_add_f32 v16, v16, v20
    buffer_store_dword v16, v7, s[24:27], s34 offen sc1
    s_branch K1_DONE
K1_LN:
    v_lshrrev_b32 v5, 2, v1
    v_and_b32 v6, 3, v1
    s_lshl_b32 s29, s28, 15
    v_lshlrev_b32 v8, 11, v5
    v_lshl_add_u32 v8, v2, 8, v8
    v_lshl_add_u32 v8, v6, 4, v8
    v_add_u32 v8, s29, v8
    s_waitcnt lgkmcnt(0)
    global_load_dwordx4 v[16:19], v8, s[40:41] offset:0
    global_load_dwordx4 v[20:23], v8, s[40:41] offset:64
    global_load_dwordx4 v[24:27], v8, s[40:41] offset:128
    global_load_dwordx4 v[28:31], v8, s[40:41] offset:192
    s_mov_b32 s24, s6
    s_and_b32 s25, s7, 0xffff
    s_mov_b32 s26, 0x3400000
    s_mov_b32 s27, 0x20000
    s_cmp_ge_u32 s33, 4
    s_cbranch_scc1 K1_PFAL
    s_lshr_b32 s36, s2, 3
    s_lshl_b32 s36, s36, 2
    s_add_u32 s36, s36, s33
    s_lshl_b32 s36, s36, 14
    s_and_b32 s37, s2, 1
    s_lshl_b32 s37, s37, 10
    s_add_u32 s36, s36, s37
    v_lshrrev_b32 v60, 3, v1
    v_lshlrev_b32 v60, 11, v60
    v_and_b32 v61, 7, v1
    v_lshl_add_u32 v60, v61, 7, v60
    v_add_u32 v60, s36, v60
    global_load_dword v60, v60, s[42:43]
    s_branch K1_PFL
K1_PFAL:
    s_cmp_eq_u32 s33, 4
    s_cbranch_scc0 K1_PFBL
    s_cmp_ge_u32 s2, 64
    s_cbranch_scc1 K1_PFL
    s_bitcmp1_b32 s2, 0
    s_cselect_b32 s36, s46, s44
    s_cselect_b32 s37, s47, s45
    s_lshr_b32 s38, s2, 3
    s_lshl_b32 s38, s38, 13
    v_lshlrev_b32 v60, 7, v1
    v_add_u32 v60, s38, v60
    global_load_dword v60, v60, s[36:37]
    s_branch K1_PFL
K1_PFBL:
    s_cmp_eq_u32 s33, 5
    s_cbranch_scc0 K1_PFCL
    s_lshr_b32 s35, s2, 3
    s_cmp_ge_u32 s35, (CODE_END-k2_qkv_kernel+8191)/8192
    s_cbranch_scc1 CPF_K1L
    s_getpc_b64 s[36:37]
CPC_K1L:
    s_lshl_b32 s35, s35, 13
    s_add_u32 s35, s35, (k2_qkv_kernel-CPC_K1L)
    s_min_u32 s35, s35, (CODE_END-CPC_K1L-8192)
    v_lshlrev_b32 v60, 7, v1
    v_add_u32 v60, s35, v60
    global_load_dword v60, v60, s[36:37]
CPF_K1L:
    s_branch K1_PFL
K1_PFCL:
    s_cmp_eq_u32 s33, 7
    s_cbranch_scc0 K1_PFDL
    s_lshl_b32 s38, s2, 13
    v_lshlrev_b32 v60, 7, v1
    v_add_u32 v60, s38, v60
    global_load_dword v60, v60, s[52:53]
    s_branch K1_PFL
K1_PFDL:
    s_cmp_eq_u32 s33, 6
    s_cbranch_scc0 K1_PFL
    s_cmp_ge_u32 s2, 16
    s_cbranch_scc1 K1_PFL
    v_lshlrev_b32 v60, 21, v1
    buffer_load_dword v61, v60, s[24:27], 0 offen
    v_and_b32 v60, 0x600000, v60
    global_load_dword v61, v60, s[48:49]
    global_load_dword v61, v60, s[50:51]
    v_and_b32 v60, 0x200000, v60
    global_load_dword v61, v60, s[54:55]
    v_mov_b32 v60, 0
    global_load_dword v61, v60, s[52:53]
K1_PFL:
    s_cmp_lt_u32 s33, 3
    s_cbranch_scc1 K1_NOZ
    v_mov_b64 v[44:45], 0
    v_mov_b64 v[46:47], 0
    v_lshlrev_b32 v48, 4, v0
    s_mul_i32 s34, s28, 5120
    s_add_u32 s34, s34, 25162752
    buffer_store_dwordx4 v[44:47], v48, s[24:27], s34 offen sc1
K1_NOZ:
    v_lshlrev_b32 v10, 6, v5
    v_add_u32 v10, 0x8000, v10
    v_lshl_add_u32 v9, v2, 3, v10
    v_and_b32 v34, 1, v6
    v_lshlrev_b32 v35, 2, v34
    v_xor_b32 v35, v35, v5
    v_lshlrev_b32 v35, 4, v35
    v_lshl_add_u32 v35, v34, 9, v35
    v_lshrrev_b32 v36, 1, v6
    v_lshl_add_u32 v35, v36, 3, v35
    v_lshl_add_u32 v35, v2, 12, v35
    v_lshrrev_b32 v36, 5, v1
    v_lshlrev_b32 v36, 2, v36
    v_xor_b32 v36, v36, v1
    v_lshlrev_b32 v36, 4, v36
    v_lshl_add_u32 v36, v2, 12, v36
    v_lshlrev_b32 v37, 19, v2
    v_lshl_add_u32 v37, v1, 4, v37
    s_lshl_b32 s32, s28, 10
    s_add_u32 s32, s32, 0x100000
    s_waitcnt vmcnt(3)
    v_lshlrev_b32 v64, 16, v16
    v_and_b32 v65, 0xffff0000, v16
    v_lshlrev_b32 v66, 16, v17
    v_and_b32 v67, 0xffff0000, v17
    v_lshlrev_b32 v68, 16, v18
    v_and_b32 v69, 0xffff0000, v18
    v_lshlrev_b32 v70, 16, v19
    v_and_b32 v71, 0xffff0000, v19
    v_pk_add_f32 v[12:13], v[64:65], v[66:67]
    v_pk_add_f32 v[12:13], v[12:13], v[68:69]
    v_pk_add_f32 v[12:13], v[12:13], v[70:71]
    s_waitcnt vmcnt(2)
    v_lshlrev_b32 v72, 16, v20
    v_and_b32 v73, 0xffff0000, v20
    v_lshlrev_b32 v74, 16, v21
    v_and_b32 v75, 0xffff0000, v21
    v_lshlrev_b32 v76, 16, v22
    v_and_b32 v77, 0xffff0000, v22
    v_lshlrev_b32 v78, 16, v23
    v_and_b32 v79, 0xffff0000, v23
    v_pk_add_f32 v[12:13], v[12:13], v[72:73]
    v_pk_add_f32 v[12:13], v[12:13], v[74:75]
    v_pk_add_f32 v[12:13], v[12:13], v[76:77]
    v_pk_add_f32 v[12:13], v[12:13], v[78:79]
    s_waitcnt vmcnt(1)
    v_lshlrev_b32 v80, 16, v24
    v_and_b32 v81, 0xffff0000, v24
    v_lshlrev_b32 v82, 16, v25
    v_and_b32 v83, 0xffff0000, v25
    v_lshlrev_b32 v84, 16, v26
    v_and_b32 v85, 0xffff0000, v26
    v_lshlrev_b32 v86, 16, v27
    v_and_b32 v87, 0xffff0000, v27
    v_pk_add_f32 v[12:13], v[12:13], v[80:81]
    v_pk_add_f32 v[12:13], v[12:13], v[82:83]
    v_pk_add_f32 v[12:13], v[12:13], v[84:85]
    v_pk_add_f32 v[12:13], v[12:13], v[86:87]
    s_waitcnt vmcnt(0)
    v_lshlrev_b32 v88, 16, v28
    v_and_b32 v89, 0xffff0000, v28
    v_lshlrev_b32 v90, 16, v29
    v_and_b32 v91, 0xffff0000, v29
    v_lshlrev_b32 v92, 16, v30
    v_and_b32 v93, 0xffff0000, v30
    v_lshlrev_b32 v94, 16, v31
    v_and_b32 v95, 0xffff0000, v31
    v_pk_add_f32 v[12:13], v[12:13], v[88:89]
    v_pk_add_f32 v[12:13], v[12:13], v[90:91]
    v_pk_add_f32 v[12:13], v[12:13], v[92:93]
    v_pk_add_f32 v[12:13], v[12:13], v[94:95]
    v_add_f32 v12, v12, v13
    s_nop 1
    v_add_f32_dpp v12, v12, v12 quad_perm:[1,0,3,2] row_mask:0xf bank_mask:0xf
    s_nop 1
    v_add_f32_dpp v12, v12, v12 quad_perm:[2,3,0,1] row_mask:0xf bank_mask:0xf
    v_mul_f32 v14, 0xbc000000, v12
    v_pk_add_f32 v[40:41], v[64:65], v[14:15] op_sel_hi:[1,0]
    v_pk_mul_f32 v[38:39], v[40:41], v[40:41]
    v_pk_add_f32 v[40:41], v[66:67], v[14:15] op_sel_hi:[1,0]
    v_pk_fma_f32 v[38:39], v[40:41], v[40:41], v[38:39]
    v_pk_add_f32 v[40:41], v[68:69], v[14:15] op_sel_hi:[1,0]
    v_pk_fma_f32 v[38:39], v[40:41], v[40:41], v[38:39]
    v_pk_add_f32 v[40:41], v[70:71], v[14:15] op_sel_hi:[1,0]
    v_pk_fma_f32 v[38:39], v[40:41], v[40:41], v[38:39]
    v_pk_add_f32 v[40:41], v[72:73], v[14:15] op_sel_hi:[1,0]
    v_pk_fma_f32 v[38:39], v[40:41], v[40:41], v[38:39]
    v_pk_add_f32 v[40:41], v[74:75], v[14:15] op_sel_hi:[1,0]
    v_pk_fma_f32 v[38:39], v[40:41], v[40:41], v[38:39]
    v_pk_add_f32 v[40:41], v[76:77], v[14:15] op_sel_hi:[1,0]
    v_pk_fma_f32 v[38:39], v[40:41], v[40:41], v[38:39]
    v_pk_add_f32 v[40:41], v[78:79], v[14:15] op_sel_hi:[1,0]
    v_pk_fma_f32 v[38:39], v[40:41], v[40:41], v[38:39]
    v_pk_add_f32 v[40:41], v[80:81], v[14:15] op_sel_hi:[1,0]
    v_pk_fma_f32 v[38:39], v[40:41], v[40:41], v[38:39]
    v_pk_add_f32 v[40:41], v[82:83], v[14:15] op_sel_hi:[1,0]
    v_pk_fma_f32 v[38:39], v[40:41], v[40:41], v[38:39]
    v_pk_add_f32 v[40:41], v[84:85], v[14:15] op_sel_hi:[1,0]
    v_pk_fma_f32 v[38:39], v[40:41], v[40:41], v[38:39]
    v_pk_add_f32 v[40:41], v[86:87], v[14:15] op_sel_hi:[1,0]
    v_pk_fma_f32 v[38:39], v[40:41], v[40:41], v[38:39]
    v_pk_add_f32 v[40:41], v[88:89], v[14:15] op_sel_hi:[1,0]
    v_pk_fma_f32 v[38:39], v[40:41], v[40:41], v[38:39]
    v_pk_add_f32 v[40:41], v[90:91], v[14:15] op_sel_hi:[1,0]
    v_pk_fma_f32 v[38:39], v[40:41], v[40:41], v[38:39]
    v_pk_add_f32 v[40:41], v[92:93], v[14:15] op_sel_hi:[1,0]
    v_pk_fma_f32 v[38:39], v[40:41], v[40:41], v[38:39]
    v_pk_add_f32 v[40:41], v[94:95], v[14:15] op_sel_hi:[1,0]
    v_pk_fma_f32 v[38:39], v[40:41], v[40:41], v[38:39]
    v_add_f32 v13, v38, v39
    s_nop 1
    v_add_f32_dpp v13, v13, v13 quad_perm:[1,0,3,2] row_mask:0xf bank_mask:0xf
    s_nop 1
    v_add_f32_dpp v13, v13, v13 quad_perm:[2,3,0,1] row_mask:0xf bank_mask:0xf
    ds_write_b64 v9, v[12:13]
    s_waitcnt lgkmcnt(0)
    s_barrier
    ds_read_b128 v[16:19], v10 offset:0
    ds_read_b128 v[20:23], v10 offset:16
    ds_read_b128 v[24:27], v10 offset:32
    ds_read_b128 v[28:31], v10 offset:48
    s_mov_b32 s30, 0x3c000000
    s_mov_b32 s31, 0x43000000
    s_waitcnt lgkmcnt(0)
    v_pk_add_f32 v[38:39], v[16:17], v[18:19]
    v_pk_add_f32 v[38:39], v[38:39], v[20:21]
    v_pk_add_f32 v[38:39], v[38:39], v[22:23]
    v_pk_add_f32 v[38:39], v[38:39], v[24:25]
    v_pk_add_f32 v[38:39], v[38:39], v[26:27]
    v_pk_add_f32 v[38:39], v[38:39], v[28:29]
    v_pk_add_f32 v[38:39], v[38:39], v[30:31]
    v_mul_f32 v38, 0x3a800000, v38
    v_fma_f32 v40, v16, s30, -v38
    v_mul_f32 v40, v40, v40
    v_fma_f32 v39, v40, s31, v39
    v_fma_f32 v40, v18, s30, -v38
    v_mul_f32 v40, v40, v40
    v_fma_f32 v39, v40, s31, v39
    v_fma_f32 v40, v20, s30, -v38
    v_mul_f32 v40, v40, v40
    v_fma_f32 v39, v40, s31, v39
    v_fma_f32 v40, v22, s30, -v38
    v_mul_f32 v40, v40, v40
    v_fma_f32 v39, v40, s31, v39
    v_fma_f32 v40, v24, s30, -v38
    v_mul_f32 v40, v40, v40
    v_fma_f32 v39, v40, s31, v39
    v_fma_f32 v40, v26, s30, -v38
    v_mul_f32 v40, v40, v40
    v_fma_f32 v39, v40, s31, v39
    v_fma_f32 v40, v28, s30, -v38
    v_mul_f32 v40, v40, v40
    v_fma_f32 v39, v40, s31, v39
    v_fma_f32 v40, v30, s30, -v38
    v_mul_f32 v40, v40, v40
    v_fma_f32 v39, v40, s31, v39
    v_mul_f32 v39, 0x3a800000, v39
    v_cvt_pk_bf16_f32 v38, v38, v38
    v_and_b32 v38, 0xffff0000, v38
    v_cvt_pk_bf16_f32 v39, v39, v39
    v_and_b32 v39, 0xffff0000, v39
    v_add_f32 v39, 0x3727c5ac, v39
    v_cvt_pk_bf16_f32 v39, v39, v39
    v_and_b32 v39, 0xffff0000, v39
    v_sqrt_f32 v39, v39
    s_nop 0
    v_cvt_pk_bf16_f32 v39, v39, v39
    v_and_b32 v39, 0xffff0000, v39
    v_rcp_f32 v40, v39
    s_nop 0
    v_mul_f32 v42, -v38, v40
    v_pk_fma_f32 v[64:65], v[64:65], v[40:41], v[42:43] op_sel_hi:[1,0,0]
    v_pk_fma_f32 v[66:67], v[66:67], v[40:41], v[42:43] op_sel_hi:[1,0,0]
    v_pk_fma_f32 v[68:69], v[68:69], v[40:41], v[42:43] op_sel_hi:[1,0,0]
    v_pk_fma_f32 v[70:71], v[70:71], v[40:41], v[42:43] op_sel_hi:[1,0,0]
    v_cvt_pk_f16_f32 v16, v64, v65
    v_cvt_pk_f16_f32 v17, v66, v67
    v_cvt_pk_f16_f32 v18, v68, v69
    v_cvt_pk_f16_f32 v19, v70, v71
    ds_write_b64 v35, v[16:17] offset:0
    ds_write_b64 v35, v[18:19] offset:256
    v_pk_fma_f32 v[72:73], v[72:73], v[40:41], v[42:43] op_sel_hi:[1,0,0]
    v_pk_fma_f32 v[74:75], v[74:75], v[40:41], v[42:43] op_sel_hi:[1,0,0]
    v_pk_fma_f32 v[76:77], v[76:77], v[40:41], v[42:43] op_sel_hi:[1,0,0]
    v_pk_fma_f32 v[78:79], v[78:79], v[40:41], v[42:43] op_sel_hi:[1,0,0]
    v_cvt_pk_f16_f32 v20, v72, v73
    v_cvt_pk_f16_f32 v21, v74, v75
    v_cvt_pk_f16_f32 v22, v76, v77
    v_cvt_pk_f16_f32 v23, v78, v79
    ds_write_b64 v35, v[20:21] offset:1024
    ds_write_b64 v35, v[22:23] offset:1280
    v_pk_fma_f32 v[80:81], v[80:81], v[40:41], v[42:43] op_sel_hi:[1,0,0]
    v_pk_fma_f32 v[82:83], v[82:83], v[40:41], v[42:43] op_sel_hi:[1,0,0]
    v_pk_fma_f32 v[84:85], v[84:85], v[40:41], v[42:43] op_sel_hi:[1,0,0]
    v_pk_fma_f32 v[86:87], v[86:87], v[40:41], v[42:43] op_sel_hi:[1,0,0]
    v_cvt_pk_f16_f32 v24, v80, v81
    v_cvt_pk_f16_f32 v25, v82, v83
    v_cvt_pk_f16_f32 v26, v84, v85
    v_cvt_pk_f16_f32 v27, v86, v87
    ds_write_b64 v35, v[24:25] offset:2048
    ds_write_b64 v35, v[26:27] offset:2304
    v_pk_fma_f32 v[88:89], v[88:89], v[40:41], v[42:43] op_sel_hi:[1,0,0]
    v_pk_fma_f32 v[90:91], v[90:91], v[40:41], v[42:43] op_sel_hi:[1,0,0]
    v_pk_fma_f32 v[92:93], v[92:93], v[40:41], v[42:43] op_sel_hi:[1,0,0]
    v_pk_fma_f32 v[94:95], v[94:95], v[40:41], v[42:43] op_sel_hi:[1,0,0]
    v_cvt_pk_f16_f32 v28, v88, v89
    v_cvt_pk_f16_f32 v29, v90, v91
    v_cvt_pk_f16_f32 v30, v92, v93
    v_cvt_pk_f16_f32 v31, v94, v95
    ds_write_b64 v35, v[28:29] offset:3072
    ds_write_b64 v35, v[30:31] offset:3328
    s_waitcnt lgkmcnt(0)
    ds_read_b128 v[44:47], v36 offset:0
    ds_read_b128 v[48:51], v36 offset:1024
    ds_read_b128 v[52:55], v36 offset:2048
    ds_read_b128 v[56:59], v36 offset:3072
    s_waitcnt lgkmcnt(3)
    buffer_store_dwordx4 v[44:47], v37, s[24:27], s32 offen sc1
    s_add_u32 s32, s32, 131072
    s_waitcnt lgkmcnt(2)
    buffer_store_dwordx4 v[48:51], v37, s[24:27], s32 offen sc1
    s_add_u32 s32, s32, 131072
    s_waitcnt lgkmcnt(1)
    buffer_store_dwordx4 v[52:55], v37, s[24:27], s32 offen sc1
    s_add_u32 s32, s32, 131072
    s_waitcnt lgkmcnt(0)
    buffer_store_dwordx4 v[56:59], v37, s[24:27], s32 offen sc1
K1_DONE:
K1_END:
    s_endpgm
.text
.globl k2_qkv_kernel
.p2align 8
.type k2_qkv_kernel,@function
k2_qkv_kernel:
    s_cmp_ge_u32 s2, 256
    s_cbranch_scc1 K2_END
    s_load_dwordx4 s[4:7], s[0:1], 8
    s_load_dwordx2 s[8:9], s[0:1], 24
    s_load_dwordx2 s[10:11], s[0:1], 96
    s_and_b32 s41, s2, 7
    s_lshr_b32 s36, s41, 1
    s_lshl_b32 s36, s36, 2
    s_lshr_b32 s37, s2, 6
    s_add_u32 s36, s36, s37
    s_and_b32 s41, s41, 1
    s_lshl_b32 s41, s41, 3
    s_bfe_u32 s37, s2, 0x30003
    s_add_u32 s37, s37, s41
    v_and_b32 v1, 63, v0
    v_lshrrev_b32 v2, 6, v0
    v_lshlrev_b32 v3, 4, v0
    v_readfirstlane_b32 s38, v2
    v_lshrrev_b32 v23, 4, v1
    v_lshlrev_b32 v12, 4, v1
    s_lshr_b32 s39, s38, 1
    s_and_b32 s40, s38, 1
    s_lshl_b32 s41, s36, 1
    s_add_u32 s41, s41, s40
    s_lshl_b32 s47, s41, 1
    s_lshl_b32 s41, s41, 12
    v_add_u32 v12, s41, v12
    s_lshl_b32 s48, s39, 17
    v_lshrrev_b32 v4, 3, v1
    v_lshl_add_u32 v4, v2, 4, v4
    v_lshlrev_b32 v13, 11, v4
    v_lshlrev_b32 v4, 1, v23
    v_and_b32 v5, 7, v1
    v_xor_b32 v4, v4, v5
    v_lshl_add_u32 v13, v4, 4, v13
    s_lshl_b32 s41, s37, 7
    v_add_u32 v13, s41, v13
    v_add_u32 v14, 15360, v13
    v_lshrrev_b32 v4, 1, v1
    v_lshl_add_u32 v4, v2, 6, v4
    v_lshlrev_b32 v15, 6, v4
    v_and_b32 v4, 1, v1
    v_lshl_add_u32 v15, v4, 4, v15
    s_and_b32 s41, s37, 1
    s_lshl_b32 s41, s41, 5
    v_add_u32 v15, s41, v15
    v_add_u32 v16, 1024, v15
    s_mov_b32 s49, 0
    s_mov_b32 s50, 0
    s_lshl_b32 s51, s38, 11
    s_add_u32 s52, s51, 65536
    s_mov_b32 s56, 0
    s_mov_b32 s60, 4096
    s_mov_b32 s57, 24576
    s_mov_b32 s61, 28672
    s_mov_b32 s58, 49152
    s_mov_b32 s62, 53248
    s_mov_b32 s59, 73728
    s_mov_b32 s63, 77824
    s_waitcnt lgkmcnt(0)
    s_mov_b32 s24, s10
    s_and_b32 s25, s11, 0xffff
    s_mov_b32 s26, 0x3400000
    s_mov_b32 s27, 0x20000
    s_lshr_b32 s43, s2, 3
    s_lshl_b32 s43, s43, 2
    s_add_u32 s43, s43, s38
    s_cmp_ge_u32 s43, (CODE_END-k3_attn_kernel+2047)/2048
    s_cbranch_scc1 CPF_K2
    s_getpc_b64 s[44:45]
CPC_K2:
    s_lshl_b32 s43, s43, 11
    s_add_u32 s43, s43, (k3_attn_kernel-CPC_K2)
    s_min_u32 s43, s43, (CODE_END-CPC_K2-2048)
    v_lshlrev_b32 v152, 5, v1
    v_add_u32 v152, s43, v152
    global_load_dword v152, v152, s[44:45]
CPF_K2:
    buffer_load_dwordx4 v[88:91], v3, s[24:27], s56 offen
    buffer_load_dwordx4 v[92:95], v3, s[24:27], s57 offen
    buffer_load_dwordx4 v[96:99], v3, s[24:27], s58 offen
    buffer_load_dwordx4 v[100:103], v3, s[24:27], s59 offen
    buffer_load_dwordx4 v[104:107], v3, s[24:27], s60 offen
    buffer_load_dwordx4 v[108:111], v3, s[24:27], s61 offen
    buffer_load_dwordx4 v[112:115], v3, s[24:27], s62 offen
    buffer_load_dwordx4 v[116:119], v3, s[24:27], s63 offen
    s_add_u32 s28, s10, 0x100000
    s_addc_u32 s29, s11, 0
    s_and_b32 s29, s29, 0xffff
    s_mov_b32 s30, 0x400000
    s_mov_b32 s31, 0x20000
    buffer_load_dwordx4 v[24:27], v12, s[28:31], s48 offen offset:0
    buffer_load_dwordx4 v[28:31], v12, s[28:31], s48 offen offset:1024
    buffer_load_dwordx4 v[32:35], v12, s[28:31], s48 offen offset:2048
    buffer_load_dwordx4 v[36:39], v12, s[28:31], s48 offen offset:3072
    s_add_u32 s48, s48, 0x40000
    s_mov_b32 s12, s4
    s_and_b32 s13, s5, 0xffff
    s_mov_b32 s14, 0x200000
    s_mov_b32 s15, 0x20000
    s_cmp_ge_u32 s37, 8
    s_cselect_b32 s16, s8, s6
    s_cselect_b32 s17, s9, s7
    s_and_b32 s17, s17, 0xffff
    s_and_b32 s41, s37, 6
    s_cmp_eq_u32 s41, 0
    s_cselect_b32 s18, 0x10000, 0
    s_cselect_b32 s46, 1, 0
    s_mov_b32 s19, 0x20000
    s_add_u32 m0, s51, 0
    s_nop 0
    buffer_load_dwordx4 v13, s[12:15], s49 offen lds
    buffer_load_dwordx4 v14, s[12:15], s49 offen offset:1024 lds
    s_add_u32 s49, s49, 0x20000
    s_mov_b32 m0, s52
    s_add_u32 s52, s52, 8192
    buffer_load_dwordx4 v15, s[16:19], s50 offen lds
    buffer_load_dwordx4 v16, s[16:19], s50 offen offset:1024 lds
    s_add_u32 s50, s50, 16384
    buffer_load_dwordx4 v[40:43], v12, s[28:31], s48 offen offset:0
    buffer_load_dwordx4 v[44:47], v12, s[28:31], s48 offen offset:1024
    buffer_load_dwordx4 v[48:51], v12, s[28:31], s48 offen offset:2048
    buffer_load_dwordx4 v[52:55], v12, s[28:31], s48 offen offset:3072
    s_add_u32 s48, s48, 0x40000
    s_add_u32 m0, s51, 8192
    s_nop 0
    buffer_load_dwordx4 v13, s[12:15], s49 offen lds
    buffer_load_dwordx4 v14, s[12:15], s49 offen offset:1024 lds
    s_add_u32 s49, s49, 0x20000
    v_bfe_u32 v4, v1, 2, 2
    v_lshl_add_u32 v5, v23, 2, v4
    s_lshl_b32 s41, s39, 5
    v_add_u32 v5, s41, v5
    v_and_b32 v4, 3, v1
    v_lshlrev_b32 v4, 3, v4
    v_lshl_add_u32 v21, v5, 5, v4
    v_add_u32 v21, 65536, v21
    v_lshl_add_u32 v17, v5, 7, v4
    v_bfe_u32 v5, v5, 1, 2
    v_lshl_add_u32 v17, v5, 5, v17
    v_xor_b32 v18, 32, v17
    v_xor_b32 v19, 64, v17
    v_xor_b32 v20, 96, v17
    s_lshl_b32 s41, s39, 7
    s_add_u32 s41, s41, 114688
    v_lshlrev_b32 v22, 4, v23
    v_add_u32 v22, s41, v22
    v_add_u32 v3, 114688, v3
    v_mov_b64 v[160:161], 0
    v_mov_b64 v[162:163], 0
    v_mov_b64 v[164:165], 0
    v_mov_b64 v[166:167], 0
    v_mov_b64 v[168:169], 0
    v_mov_b64 v[170:171], 0
    v_mov_b64 v[172:173], 0
    v_mov_b64 v[174:175], 0
    v_mov_b64 v[176:177], 0
    v_mov_b64 v[178:179], 0
    v_mov_b64 v[180:181], 0
    v_mov_b64 v[182:183], 0
    v_mov_b64 v[184:185], 0
    v_mov_b64 v[186:187], 0
    v_mov_b64 v[188:189], 0
    v_mov_b64 v[190:191], 0
    v_mov_b64 v[192:193], 0
    v_mov_b64 v[194:195], 0
    v_mov_b64 v[196:197], 0
    v_mov_b64 v[198:199], 0
    v_mov_b64 v[200:201], 0
    v_mov_b64 v[202:203], 0
    v_mov_b64 v[204:205], 0
    v_mov_b64 v[206:207], 0
    v_mov_b64 v[208:209], 0
    v_mov_b64 v[210:211], 0
    v_mov_b64 v[212:213], 0
    v_mov_b64 v[214:215], 0
    v_mov_b64 v[216:217], 0
    v_mov_b64 v[218:219], 0
    v_mov_b64 v[220:221], 0
    v_mov_b64 v[222:223], 0
    v_mov_b64 v[224:225], 0
    v_mov_b64 v[226:227], 0
    v_mov_b64 v[228:229], 0
    v_mov_b64 v[230:231], 0
    v_mov_b64 v[232:233], 0
    v_mov_b64 v[234:235], 0
    v_mov_b64 v[236:237], 0
    v_mov_b64 v[238:239], 0
    buffer_load_dwordx4 v[56:59], v12, s[28:31], s48 offen offset:0
    buffer_load_dwordx4 v[60:63], v12, s[28:31], s48 offen offset:1024
    buffer_load_dwordx4 v[64:67], v12, s[28:31], s48 offen offset:2048
    buffer_load_dwordx4 v[68:71], v12, s[28:31], s48 offen offset:3072
    s_add_u32 s48, s48, 0x40000
    s_add_u32 m0, s51, 16384
    s_nop 0
    buffer_load_dwordx4 v13, s[12:15], s49 offen lds
    buffer_load_dwordx4 v14, s[12:15], s49 offen offset:1024 lds
    s_add_u32 s49, s49, 0x20000
    s_waitcnt vmcnt(20)
    v_pk_add_f32 v[88:89], v[88:89], v[92:93]
    v_pk_add_f32 v[96:97], v[96:97], v[100:101]
    v_pk_add_f32 v[120:121], v[88:89], v[96:97]
    v_pk_add_f32 v[90:91], v[90:91], v[94:95]
    v_pk_add_f32 v[98:99], v[98:99], v[102:103]
    v_pk_add_f32 v[122:123], v[90:91], v[98:99]
    v_pk_add_f32 v[104:105], v[104:105], v[108:109]
    v_pk_add_f32 v[112:113], v[112:113], v[116:117]
    v_pk_add_f32 v[128:129], v[104:105], v[112:113]
    v_pk_add_f32 v[106:107], v[106:107], v[110:111]
    v_pk_add_f32 v[114:115], v[114:115], v[118:119]
    v_pk_add_f32 v[130:131], v[106:107], v[114:115]
    v_cvt_pk_bf16_f32 v124, v120, v121
    v_cvt_pk_bf16_f32 v132, v128, v129
    v_cvt_pk_bf16_f32 v125, v122, v123
    v_cvt_pk_bf16_f32 v133, v130, v131
    v_lshlrev_b32 v120, 16, v124
    v_and_b32 v121, 0xffff0000, v124
    v_lshlrev_b32 v128, 16, v132
    v_and_b32 v129, 0xffff0000, v132
    v_lshlrev_b32 v122, 16, v125
    v_and_b32 v123, 0xffff0000, v125
    v_lshlrev_b32 v130, 16, v133
    v_and_b32 v131, 0xffff0000, v133
    ds_write_b128 v3, v[120:123] offset:4096
    v_add_f32 v128, 1.0, v128
    v_add_f32 v129, 1.0, v129
    v_add_f32 v130, 1.0, v130
    v_add_f32 v131, 1.0, v131
    v_cvt_pk_bf16_f32 v132, v128, v129
    v_cvt_pk_bf16_f32 v133, v130, v131
    v_lshlrev_b32 v128, 16, v132
    v_and_b32 v129, 0xffff0000, v132
    v_lshlrev_b32 v130, 16, v133
    v_and_b32 v131, 0xffff0000, v133
    ds_write_b128 v3, v[128:131]
    s_waitcnt vmcnt(12) lgkmcnt(0)
    s_barrier
    ds_read_b128 v[120:123], v22 offset:0
    ds_read_b128 v[124:127], v22 offset:64
    ds_read_b128 v[128:131], v22 offset:4096
    ds_read_b128 v[132:135], v22 offset:4160
    ds_read_b128 v[136:139], v22 offset:256
    ds_read_b128 v[140:143], v22 offset:320
    ds_read_b128 v[144:147], v22 offset:4352
    ds_read_b128 v[148:151], v22 offset:4416
    ds_read_b64_tr_b16 a[0:1], v17 offset:0
    ds_read_b64_tr_b16 a[2:3], v17 offset:2048
    ds_read_b64_tr_b16 a[4:5], v18 offset:0
    ds_read_b64_tr_b16 a[6:7], v18 offset:2048
    ds_read_b64_tr_b16 a[8:9], v19 offset:0
    ds_read_b64_tr_b16 a[10:11], v19 offset:2048
    ds_read_b64_tr_b16 a[12:13], v20 offset:0
    ds_read_b64_tr_b16 a[14:15], v20 offset:2048
    ds_read_b64_tr_b16 a[16:17], v21 offset:0
    ds_read_b64_tr_b16 a[18:19], v21 offset:512
    buffer_load_dwordx4 v[72:75], v12, s[28:31], s48 offen offset:0
    buffer_load_dwordx4 v[76:79], v12, s[28:31], s48 offen offset:1024
    buffer_load_dwordx4 v[80:83], v12, s[28:31], s48 offen offset:2048
    buffer_load_dwordx4 v[84:87], v12, s[28:31], s48 offen offset:3072
    s_add_u32 s48, s48, 0x40000
    s_add_u32 m0, s51, 24576
    s_nop 0
    buffer_load_dwordx4 v13, s[12:15], s49 offen lds
    buffer_load_dwordx4 v14, s[12:15], s49 offen offset:1024 lds
    s_add_u32 s49, s49, 0x20000
    s_xor_b32 s51, s51, 0x8000
    s_waitcnt lgkmcnt(14)
    v_fma_mix_f32 v152, v24, v120, v128 op_sel_hi:[1,0,0]
    v_fma_mix_f32 v153, v24, v121, v129 op_sel:[1,0,0] op_sel_hi:[1,0,0]
    v_cvt_pk_bf16_f32 v88, v152, v153
    v_fma_mix_f32 v154, v25, v122, v130 op_sel_hi:[1,0,0]
    v_fma_mix_f32 v155, v25, v123, v131 op_sel:[1,0,0] op_sel_hi:[1,0,0]
    v_cvt_pk_bf16_f32 v89, v154, v155
    v_fma_mix_f32 v156, v26, v124, v132 op_sel_hi:[1,0,0]
    v_fma_mix_f32 v157, v26, v125, v133 op_sel:[1,0,0] op_sel_hi:[1,0,0]
    v_cvt_pk_bf16_f32 v90, v156, v157
    v_fma_mix_f32 v158, v27, v126, v134 op_sel_hi:[1,0,0]
    v_fma_mix_f32 v159, v27, v127, v135 op_sel:[1,0,0] op_sel_hi:[1,0,0]
    v_cvt_pk_bf16_f32 v91, v158, v159
    v_fma_mix_f32 v152, v28, v120, v128 op_sel_hi:[1,0,0]
    v_fma_mix_f32 v153, v28, v121, v129 op_sel:[1,0,0] op_sel_hi:[1,0,0]
    v_cvt_pk_bf16_f32 v92, v152, v153
    v_fma_mix_f32 v154, v29, v122, v130 op_sel_hi:[1,0,0]
    v_fma_mix_f32 v155, v29, v123, v131 op_sel:[1,0,0] op_sel_hi:[1,0,0]
    v_cvt_pk_bf16_f32 v93, v154, v155
    v_fma_mix_f32 v156, v30, v124, v132 op_sel_hi:[1,0,0]
    v_fma_mix_f32 v157, v30, v125, v133 op_sel:[1,0,0] op_sel_hi:[1,0,0]
    v_cvt_pk_bf16_f32 v94, v156, v157
    v_fma_mix_f32 v158, v31, v126, v134 op_sel_hi:[1,0,0]
    v_fma_mix_f32 v159, v31, v127, v135 op_sel:[1,0,0] op_sel_hi:[1,0,0]
    v_cvt_pk_bf16_f32 v95, v158, v159
    v_fma_mix_f32 v152, v32, v120, v128 op_sel_hi:[1,0,0]
    v_fma_mix_f32 v153, v32, v121, v129 op_sel:[1,0,0] op_sel_hi:[1,0,0]
    v_cvt_pk_bf16_f32 v96, v152, v153
    v_fma_mix_f32 v154, v33, v122, v130 op_sel_hi:[1,0,0]
    v_fma_mix_f32 v155, v33, v123, v131 op_sel:[1,0,0] op_sel_hi:[1,0,0]
    v_cvt_pk_bf16_f32 v97, v154, v155
    v_fma_mix_f32 v156, v34, v124, v132 op_sel_hi:[1,0,0]
    v_fma_mix_f32 v157, v34, v125, v133 op_sel:[1,0,0] op_sel_hi:[1,0,0]
    v_cvt_pk_bf16_f32 v98, v156, v157
    v_fma_mix_f32 v158, v35, v126, v134 op_sel_hi:[1,0,0]
    v_fma_mix_f32 v159, v35, v127, v135 op_sel:[1,0,0] op_sel_hi:[1,0,0]
    v_cvt_pk_bf16_f32 v99, v158, v159
    v_fma_mix_f32 v152, v36, v120, v128 op_sel_hi:[1,0,0]
    v_fma_mix_f32 v153, v36, v121, v129 op_sel:[1,0,0] op_sel_hi:[1,0,0]
    v_cvt_pk_bf16_f32 v100, v152, v153
    v_fma_mix_f32 v154, v37, v122, v130 op_sel_hi:[1,0,0]
    v_fma_mix_f32 v155, v37, v123, v131 op_sel:[1,0,0] op_sel_hi:[1,0,0]
    v_cvt_pk_bf16_f32 v101, v154, v155
    v_fma_mix_f32 v156, v38, v124, v132 op_sel_hi:[1,0,0]
    v_fma_mix_f32 v157, v38, v125, v133 op_sel:[1,0,0] op_sel_hi:[1,0,0]
    v_cvt_pk_bf16_f32 v102, v156, v157
    v_fma_mix_f32 v158, v39, v126, v134 op_sel_hi:[1,0,0]
    v_fma_mix_f32 v159, v39, v127, v135 op_sel:[1,0,0] op_sel_hi:[1,0,0]
    v_cvt_pk_bf16_f32 v103, v158, v159
    s_add_u32 m0, s51, 0
    s_nop 0
    buffer_load_dwordx4 v13, s[12:15], s49 offen lds
    buffer_load_dwordx4 v14, s[12:15], s49 offen offset:1024 lds
    s_add_u32 s49, s49, 0x20000
    s_mov_b32 m0, s52
    s_add_u32 s52, s52, 8192
    buffer_load_dwordx4 v15, s[16:19], s50 offen lds
    buffer_load_dwordx4 v16, s[16:19], s50 offen offset:1024 lds
    s_add_u32 s50, s50, 16384
    buffer_load_dwordx4 v[24:27], v12, s[28:31], s48 offen offset:0
    buffer_load_dwordx4 v[28:31], v12, s[28:31], s48 offen offset:1024
    buffer_load_dwordx4 v[32:35], v12, s[28:31], s48 offen offset:2048
    buffer_load_dwordx4 v[36:39], v12, s[28:31], s48 offen offset:3072
    s_add_u32 s48, s48, 0x40000
    s_mov_b32 s53, 3
    .p2align 6
K2_LOOP:
    s_add_u32 m0, s51, 8192
    s_waitcnt vmcnt(20) lgkmcnt(2)
    v_mfma_f32_16x16x32_bf16 v[160:163], a[0:3], v[88:91], v[160:163]
    buffer_load_dwordx4 v13, s[12:15], s49 offen lds
    v_fma_mix_f32 v152, v40, v136, v144 op_sel_hi:[1,0,0]
    v_fma_mix_f32 v153, v40, v137, v145 op_sel:[1,0,0] op_sel_hi:[1,0,0]
    v_cvt_pk_bf16_f32 v104, v152, v153
    v_mfma_f32_16x16x32_bf16 v[164:167], a[0:3], v[92:95], v[164:167]
    buffer_load_dwordx4 v14, s[12:15], s49 offen offset:1024 lds
    v_fma_mix_f32 v154, v41, v138, v146 op_sel_hi:[1,0,0]
    v_fma_mix_f32 v155, v41, v139, v147 op_sel:[1,0,0] op_sel_hi:[1,0,0]
    v_cvt_pk_bf16_f32 v105, v154, v155
    v_mfma_f32_16x16x32_bf16 v[168:171], a[0:3], v[96:99], v[168:171]
    v_fma_mix_f32 v156, v42, v140, v148 op_sel_hi:[1,0,0]
    v_fma_mix_f32 v157, v42, v141, v149 op_sel:[1,0,0] op_sel_hi:[1,0,0]
    v_cvt_pk_bf16_f32 v106, v156, v157
    s_barrier
    v_mfma_f32_16x16x32_bf16 v[172:175], a[0:3], v[100:103], v[172:175]
    ds_read_b64_tr_b16 a[0:1], v17 offset:8192
    ds_read_b64_tr_b16 a[2:3], v17 offset:10240
    v_fma_mix_f32 v158, v43, v142, v150 op_sel_hi:[1,0,0]
    v_mfma_f32_16x16x32_bf16 v[176:179], a[4:7], v[88:91], v[176:179]
    ds_read_b128 v[120:123], v22 offset:512
    v_fma_mix_f32 v159, v43, v143, v151 op_sel:[1,0,0] op_sel_hi:[1,0,0]
    v_cvt_pk_bf16_f32 v107, v158, v159
    v_fma_mix_f32 v152, v44, v136, v144 op_sel_hi:[1,0,0]
    v_mfma_f32_16x16x32_bf16 v[180:183], a[4:7], v[92:95], v[180:183]
    ds_read_b128 v[124:127], v22 offset:576
    v_fma_mix_f32 v153, v44, v137, v145 op_sel:[1,0,0] op_sel_hi:[1,0,0]
    v_cvt_pk_bf16_f32 v108, v152, v153
    v_fma_mix_f32 v154, v45, v138, v146 op_sel_hi:[1,0,0]
    v_mfma_f32_16x16x32_bf16 v[184:187], a[4:7], v[96:99], v[184:187]
    buffer_load_dwordx4 v[40:43], v12, s[28:31], s48 offen offset:0
    v_fma_mix_f32 v155, v45, v139, v147 op_sel:[1,0,0] op_sel_hi:[1,0,0]
    v_cvt_pk_bf16_f32 v109, v154, v155
    v_fma_mix_f32 v156, v46, v140, v148 op_sel_hi:[1,0,0]
    v_mfma_f32_16x16x32_bf16 v[188:191], a[4:7], v[100:103], v[188:191]
    ds_read_b64_tr_b16 a[4:5], v18 offset:8192
    ds_read_b64_tr_b16 a[6:7], v18 offset:10240
    v_fma_mix_f32 v157, v46, v141, v149 op_sel:[1,0,0] op_sel_hi:[1,0,0]
    v_mfma_f32_16x16x32_bf16 v[192:195], a[8:11], v[88:91], v[192:195]
    ds_read_b128 v[128:131], v22 offset:4608
    v_cvt_pk_bf16_f32 v110, v156, v157
    v_fma_mix_f32 v158, v47, v142, v150 op_sel_hi:[1,0,0]
    v_fma_mix_f32 v159, v47, v143, v151 op_sel:[1,0,0] op_sel_hi:[1,0,0]
    v_mfma_f32_16x16x32_bf16 v[196:199], a[8:11], v[92:95], v[196:199]
    ds_read_b128 v[132:135], v22 offset:4672
    v_cvt_pk_bf16_f32 v111, v158, v159
    v_fma_mix_f32 v152, v48, v136, v144 op_sel_hi:[1,0,0]
    v_fma_mix_f32 v153, v48, v137, v145 op_sel:[1,0,0] op_sel_hi:[1,0,0]
    v_mfma_f32_16x16x32_bf16 v[200:203], a[8:11], v[96:99], v[200:203]
    buffer_load_dwordx4 v[44:47], v12, s[28:31], s48 offen offset:1024
    v_cvt_pk_bf16_f32 v112, v152, v153
    v_fma_mix_f32 v154, v49, v138, v146 op_sel_hi:[1,0,0]
    v_fma_mix_f32 v155, v49, v139, v147 op_sel:[1,0,0] op_sel_hi:[1,0,0]
    v_mfma_f32_16x16x32_bf16 v[204:207], a[8:11], v[100:103], v[204:207]
    ds_read_b64_tr_b16 a[8:9], v19 offset:8192
    ds_read_b64_tr_b16 a[10:11], v19 offset:10240
    v_cvt_pk_bf16_f32 v113, v154, v155
    v_mfma_f32_16x16x32_bf16 v[208:211], a[12:15], v[88:91], v[208:211]
    v_fma_mix_f32 v156, v50, v140, v148 op_sel_hi:[1,0,0]
    v_fma_mix_f32 v157, v50, v141, v149 op_sel:[1,0,0] op_sel_hi:[1,0,0]
    v_cvt_pk_bf16_f32 v114, v156, v157
    v_mfma_f32_16x16x32_bf16 v[212:215], a[12:15], v[92:95], v[212:215]
    v_fma_mix_f32 v158, v51, v142, v150 op_sel_hi:[1,0,0]
    v_fma_mix_f32 v159, v51, v143, v151 op_sel:[1,0,0] op_sel_hi:[1,0,0]
    v_cvt_pk_bf16_f32 v115, v158, v159
    v_mfma_f32_16x16x32_bf16 v[216:219], a[12:15], v[96:99], v[216:219]
    buffer_load_dwordx4 v[48:51], v12, s[28:31], s48 offen offset:2048
    v_fma_mix_f32 v152, v52, v136, v144 op_sel_hi:[1,0,0]
    v_fma_mix_f32 v153, v52, v137, v145 op_sel:[1,0,0] op_sel_hi:[1,0,0]
    v_cvt_pk_bf16_f32 v116, v152, v153
    v_mfma_f32_16x16x32_bf16 v[220:223], a[12:15], v[100:103], v[220:223]
    ds_read_b64_tr_b16 a[12:13], v20 offset:8192
    ds_read_b64_tr_b16 a[14:15], v20 offset:10240
    v_fma_mix_f32 v154, v53, v138, v146 op_sel_hi:[1,0,0]
    s_waitcnt lgkmcnt(12)
    v_mfma_f32_16x16x32_bf16 v[224:227], a[16:19], v[88:91], v[224:227]
    v_fma_mix_f32 v155, v53, v139, v147 op_sel:[1,0,0] op_sel_hi:[1,0,0]
    v_cvt_pk_bf16_f32 v117, v154, v155
    v_fma_mix_f32 v156, v54, v140, v148 op_sel_hi:[1,0,0]
    v_fma_mix_f32 v157, v54, v141, v149 op_sel:[1,0,0] op_sel_hi:[1,0,0]
    v_mfma_f32_16x16x32_bf16 v[228:231], a[16:19], v[92:95], v[228:231]
    v_cvt_pk_bf16_f32 v118, v156, v157
    v_fma_mix_f32 v158, v55, v142, v150 op_sel_hi:[1,0,0]
    v_fma_mix_f32 v159, v55, v143, v151 op_sel:[1,0,0] op_sel_hi:[1,0,0]
    v_cvt_pk_bf16_f32 v119, v158, v159
    v_mfma_f32_16x16x32_bf16 v[232:235], a[16:19], v[96:99], v[232:235]
    buffer_load_dwordx4 v[52:55], v12, s[28:31], s48 offen offset:3072
    v_mfma_f32_16x16x32_bf16 v[236:239], a[16:19], v[100:103], v[236:239]
    ds_read_b64_tr_b16 a[16:17], v21 offset:2048
    ds_read_b64_tr_b16 a[18:19], v21 offset:2560
    s_add_u32 s49, s49, 0x20000
    s_add_u32 s48, s48, 0x40000
    s_add_u32 m0, s51, 16384
    s_waitcnt vmcnt(20) lgkmcnt(2)
    v_mfma_f32_16x16x32_bf16 v[160:163], a[0:3], v[104:107], v[160:163]
    buffer_load_dwordx4 v13, s[12:15], s49 offen lds
    v_fma_mix_f32 v152, v56, v120, v128 op_sel_hi:[1,0,0]
    v_fma_mix_f32 v153, v56, v121, v129 op_sel:[1,0,0] op_sel_hi:[1,0,0]
    v_cvt_pk_bf16_f32 v88, v152, v153
    v_mfma_f32_16x16x32_bf16 v[164:167], a[0:3], v[108:111], v[164:167]
    buffer_load_dwordx4 v14, s[12:15], s49 offen offset:1024 lds
    v_fma_mix_f32 v154, v57, v122, v130 op_sel_hi:[1,0,0]
    v_fma_mix_f32 v155, v57, v123, v131 op_sel:[1,0,0] op_sel_hi:[1,0,0]
    v_cvt_pk_bf16_f32 v89, v154, v155
    v_mfma_f32_16x16x32_bf16 v[168:171], a[0:3], v[112:115], v[168:171]
    v_fma_mix_f32 v156, v58, v124, v132 op_sel_hi:[1,0,0]
    v_fma_mix_f32 v157, v58, v125, v133 op_sel:[1,0,0] op_sel_hi:[1,0,0]
    v_cvt_pk_bf16_f32 v90, v156, v157
    s_barrier
    v_mfma_f32_16x16x32_bf16 v[172:175], a[0:3], v[116:119], v[172:175]
    ds_read_b64_tr_b16 a[0:1], v17 offset:16384
    ds_read_b64_tr_b16 a[2:3], v17 offset:18432
    v_fma_mix_f32 v158, v59, v126, v134 op_sel_hi:[1,0,0]
    v_mfma_f32_16x16x32_bf16 v[176:179], a[4:7], v[104:107], v[176:179]
    ds_read_b128 v[136:139], v22 offset:768
    v_fma_mix_f32 v159, v59, v127, v135 op_sel:[1,0,0] op_sel_hi:[1,0,0]
    v_cvt_pk_bf16_f32 v91, v158, v159
    v_fma_mix_f32 v152, v60, v120, v128 op_sel_hi:[1,0,0]
    v_mfma_f32_16x16x32_bf16 v[180:183], a[4:7], v[108:111], v[180:183]
    ds_read_b128 v[140:143], v22 offset:832
    v_fma_mix_f32 v153, v60, v121, v129 op_sel:[1,0,0] op_sel_hi:[1,0,0]
    v_cvt_pk_bf16_f32 v92, v152, v153
    v_fma_mix_f32 v154, v61, v122, v130 op_sel_hi:[1,0,0]
    v_mfma_f32_16x16x32_bf16 v[184:187], a[4:7], v[112:115], v[184:187]
    buffer_load_dwordx4 v[56:59], v12, s[28:31], s48 offen offset:0
    v_fma_mix_f32 v155, v61, v123, v131 op_sel:[1,0,0] op_sel_hi:[1,0,0]
    v_cvt_pk_bf16_f32 v93, v154, v155
    v_fma_mix_f32 v156, v62, v124, v132 op_sel_hi:[1,0,0]
    v_mfma_f32_16x16x32_bf16 v[188:191], a[4:7], v[116:119], v[188:191]
    ds_read_b64_tr_b16 a[4:5], v18 offset:16384
    ds_read_b64_tr_b16 a[6:7], v18 offset:18432
    v_fma_mix_f32 v157, v62, v125, v133 op_sel:[1,0,0] op_sel_hi:[1,0,0]
    v_mfma_f32_16x16x32_bf16 v[192:195], a[8:11], v[104:107], v[192:195]
    ds_read_b128 v[144:147], v22 offset:4864
    v_cvt_pk_bf16_f32 v94, v156, v157
    v_fma_mix_f32 v158, v63, v126, v134 op_sel_hi:[1,0,0]
    v_fma_mix_f32 v159, v63, v127, v135 op_sel:[1,0,0] op_sel_hi:[1,0,0]
    v_mfma_f32_16x16x32_bf16 v[196:199], a[8:11], v[108:111], v[196:199]
    ds_read_b128 v[148:151], v22 offset:4928
    v_cvt_pk_bf16_f32 v95, v158, v159
    v_fma_mix_f32 v152, v64, v120, v128 op_sel_hi:[1,0,0]
    v_fma_mix_f32 v153, v64, v121, v129 op_sel:[1,0,0] op_sel_hi:[1,0,0]
    v_mfma_f32_16x16x32_bf16 v[200:203], a[8:11], v[112:115], v[200:203]
    buffer_load_dwordx4 v[60:63], v12, s[28:31], s48 offen offset:1024
    v_cvt_pk_bf16_f32 v96, v152, v153
    v_fma_mix_f32 v154, v65, v122, v130 op_sel_hi:[1,0,0]
    v_fma_mix_f32 v155, v65, v123, v131 op_sel:[1,0,0] op_sel_hi:[1,0,0]
    v_mfma_f32_16x16x32_bf16 v[204:207], a[8:11], v[116:119], v[204:207]
    ds_read_b64_tr_b16 a[8:9], v19 offset:16384
    ds_read_b64_tr_b16 a[10:11], v19 offset:18432
    v_cvt_pk_bf16_f32 v97, v154, v155
    v_mfma_f32_16x16x32_bf16 v[208:211], a[12:15], v[104:107], v[208:211]
    v_fma_mix_f32 v156, v66, v124, v132 op_sel_hi:[1,0,0]
    v_fma_mix_f32 v157, v66, v125, v133 op_sel:[1,0,0] op_sel_hi:[1,0,0]
    v_cvt_pk_bf16_f32 v98, v156, v157
    v_mfma_f32_16x16x32_bf16 v[212:215], a[12:15], v[108:111], v[212:215]
    v_fma_mix_f32 v158, v67, v126, v134 op_sel_hi:[1,0,0]
    v_fma_mix_f32 v159, v67, v127, v135 op_sel:[1,0,0] op_sel_hi:[1,0,0]
    v_cvt_pk_bf16_f32 v99, v158, v159
    v_mfma_f32_16x16x32_bf16 v[216:219], a[12:15], v[112:115], v[216:219]
    buffer_load_dwordx4 v[64:67], v12, s[28:31], s48 offen offset:2048
    v_fma_mix_f32 v152, v68, v120, v128 op_sel_hi:[1,0,0]
    v_fma_mix_f32 v153, v68, v121, v129 op_sel:[1,0,0] op_sel_hi:[1,0,0]
    v_cvt_pk_bf16_f32 v100, v152, v153
    v_mfma_f32_16x16x32_bf16 v[220:223], a[12:15], v[116:119], v[220:223]
    ds_read_b64_tr_b16 a[12:13], v20 offset:16384
    ds_read_b64_tr_b16 a[14:15], v20 offset:18432
    v_fma_mix_f32 v154, v69, v122, v130 op_sel_hi:[1,0,0]
    s_waitcnt lgkmcnt(12)
    v_mfma_f32_16x16x32_bf16 v[224:227], a[16:19], v[104:107], v[224:227]
    v_fma_mix_f32 v155, v69, v123, v131 op_sel:[1,0,0] op_sel_hi:[1,0,0]
    v_cvt_pk_bf16_f32 v101, v154, v155
    v_fma_mix_f32 v156, v70, v124, v132 op_sel_hi:[1,0,0]
    v_fma_mix_f32 v157, v70, v125, v133 op_sel:[1,0,0] op_sel_hi:[1,0,0]
    v_mfma_f32_16x16x32_bf16 v[228:231], a[16:19], v[108:111], v[228:231]
    v_cvt_pk_bf16_f32 v102, v156, v157
    v_fma_mix_f32 v158, v71, v126, v134 op_sel_hi:[1,0,0]
    v_fma_mix_f32 v159, v71, v127, v135 op_sel:[1,0,0] op_sel_hi:[1,0,0]
    v_cvt_pk_bf16_f32 v103, v158, v159
    v_mfma_f32_16x16x32_bf16 v[232:235], a[16:19], v[112:115], v[232:235]
    buffer_load_dwordx4 v[68:71], v12, s[28:31], s48 offen offset:3072
    v_mfma_f32_16x16x32_bf16 v[236:239], a[16:19], v[116:119], v[236:239]
    ds_read_b64_tr_b16 a[16:17], v21 offset:4096
    ds_read_b64_tr_b16 a[18:19], v21 offset:4608
    s_add_u32 s49, s49, 0x20000
    s_add_u32 s48, s48, 0x40000
    s_add_u32 m0, s51, 24576
    s_waitcnt vmcnt(20) lgkmcnt(2)
    v_mfma_f32_16x16x32_bf16 v[160:163], a[0:3], v[88:91], v[160:163]
    buffer_load_dwordx4 v13, s[12:15], s49 offen lds
    v_fma_mix_f32 v152, v72, v136, v144 op_sel_hi:[1,0,0]
    v_fma_mix_f32 v153, v72, v137, v145 op_sel:[1,0,0] op_sel_hi:[1,0,0]
    v_cvt_pk_bf16_f32 v104, v152, v153
    v_mfma_f32_16x16x32_bf16 v[164:167], a[0:3], v[92:95], v[164:167]
    buffer_load_dwordx4 v14, s[12:15], s49 offen offset:1024 lds
    v_fma_mix_f32 v154, v73, v138, v146 op_sel_hi:[1,0,0]
    v_fma_mix_f32 v155, v73, v139, v147 op_sel:[1,0,0] op_sel_hi:[1,0,0]
    v_cvt_pk_bf16_f32 v105, v154, v155
    v_mfma_f32_16x16x32_bf16 v[168:171], a[0:3], v[96:99], v[168:171]
    v_fma_mix_f32 v156, v74, v140, v148 op_sel_hi:[1,0,0]
    v_fma_mix_f32 v157, v74, v141, v149 op_sel:[1,0,0] op_sel_hi:[1,0,0]
    v_cvt_pk_bf16_f32 v106, v156, v157
    s_barrier
    v_mfma_f32_16x16x32_bf16 v[172:175], a[0:3], v[100:103], v[172:175]
    ds_read_b64_tr_b16 a[0:1], v17 offset:24576
    ds_read_b64_tr_b16 a[2:3], v17 offset:26624
    v_fma_mix_f32 v158, v75, v142, v150 op_sel_hi:[1,0,0]
    v_mfma_f32_16x16x32_bf16 v[176:179], a[4:7], v[88:91], v[176:179]
    ds_read_b128 v[120:123], v22 offset:1024
    v_fma_mix_f32 v159, v75, v143, v151 op_sel:[1,0,0] op_sel_hi:[1,0,0]
    v_cvt_pk_bf16_f32 v107, v158, v159
    v_fma_mix_f32 v152, v76, v136, v144 op_sel_hi:[1,0,0]
    v_mfma_f32_16x16x32_bf16 v[180:183], a[4:7], v[92:95], v[180:183]
    ds_read_b128 v[124:127], v22 offset:1088
    v_fma_mix_f32 v153, v76, v137, v145 op_sel:[1,0,0] op_sel_hi:[1,0,0]
    v_cvt_pk_bf16_f32 v108, v152, v153
    v_fma_mix_f32 v154, v77, v138, v146 op_sel_hi:[1,0,0]
    v_mfma_f32_16x16x32_bf16 v[184:187], a[4:7], v[96:99], v[184:187]
    buffer_load_dwordx4 v[72:75], v12, s[28:31], s48 offen offset:0
    v_fma_mix_f32 v155, v77, v139, v147 op_sel:[1,0,0] op_sel_hi:[1,0,0]
    v_cvt_pk_bf16_f32 v109, v154, v155
    v_fma_mix_f32 v156, v78, v140, v148 op_sel_hi:[1,0,0]
    v_mfma_f32_16x16x32_bf16 v[188:191], a[4:7], v[100:103], v[188:191]
    ds_read_b64_tr_b16 a[4:5], v18 offset:24576
    ds_read_b64_tr_b16 a[6:7], v18 offset:26624
    v_fma_mix_f32 v157, v78, v141, v149 op_sel:[1,0,0] op_sel_hi:[1,0,0]
    v_mfma_f32_16x16x32_bf16 v[192:195], a[8:11], v[88:91], v[192:195]
    ds_read_b128 v[128:131], v22 offset:5120
    v_cvt_pk_bf16_f32 v110, v156, v157
    v_fma_mix_f32 v158, v79, v142, v150 op_sel_hi:[1,0,0]
    v_fma_mix_f32 v159, v79, v143, v151 op_sel:[1,0,0] op_sel_hi:[1,0,0]
    v_mfma_f32_16x16x32_bf16 v[196:199], a[8:11], v[92:95], v[196:199]
    ds_read_b128 v[132:135], v22 offset:5184
    v_cvt_pk_bf16_f32 v111, v158, v159
    v_fma_mix_f32 v152, v80, v136, v144 op_sel_hi:[1,0,0]
    v_fma_mix_f32 v153, v80, v137, v145 op_sel:[1,0,0] op_sel_hi:[1,0,0]
    v_mfma_f32_16x16x32_bf16 v[200:203], a[8:11], v[96:99], v[200:203]
    buffer_load_dwordx4 v[76:79], v12, s[28:31], s48 offen offset:1024
    v_cvt_pk_bf16_f32 v112, v152, v153
    v_fma_mix_f32 v154, v81, v138, v146 op_sel_hi:[1,0,0]
    v_fma_mix_f32 v155, v81, v139, v147 op_sel:[1,0,0] op_sel_hi:[1,0,0]
    v_mfma_f32_16x16x32_bf16 v[204:207], a[8:11], v[100:103], v[204:207]
    ds_read_b64_tr_b16 a[8:9], v19 offset:24576
    ds_read_b64_tr_b16 a[10:11], v19 offset:26624
    v_cvt_pk_bf16_f32 v113, v154, v155
    v_mfma_f32_16x16x32_bf16 v[208:211], a[12:15], v[88:91], v[208:211]
    v_fma_mix_f32 v156, v82, v140, v148 op_sel_hi:[1,0,0]
    v_fma_mix_f32 v157, v82, v141, v149 op_sel:[1,0,0] op_sel_hi:[1,0,0]
    v_cvt_pk_bf16_f32 v114, v156, v157
    v_mfma_f32_16x16x32_bf16 v[212:215], a[12:15], v[92:95], v[212:215]
    v_fma_mix_f32 v158, v83, v142, v150 op_sel_hi:[1,0,0]
    v_fma_mix_f32 v159, v83, v143, v151 op_sel:[1,0,0] op_sel_hi:[1,0,0]
    v_cvt_pk_bf16_f32 v115, v158, v159
    v_mfma_f32_16x16x32_bf16 v[216:219], a[12:15], v[96:99], v[216:219]
    buffer_load_dwordx4 v[80:83], v12, s[28:31], s48 offen offset:2048
    v_fma_mix_f32 v152, v84, v136, v144 op_sel_hi:[1,0,0]
    v_fma_mix_f32 v153, v84, v137, v145 op_sel:[1,0,0] op_sel_hi:[1,0,0]
    v_cvt_pk_bf16_f32 v116, v152, v153
    v_mfma_f32_16x16x32_bf16 v[220:223], a[12:15], v[100:103], v[220:223]
    ds_read_b64_tr_b16 a[12:13], v20 offset:24576
    ds_read_b64_tr_b16 a[14:15], v20 offset:26624
    v_fma_mix_f32 v154, v85, v138, v146 op_sel_hi:[1,0,0]
    s_waitcnt lgkmcnt(12)
    v_mfma_f32_16x16x32_bf16 v[224:227], a[16:19], v[88:91], v[224:227]
    v_fma_mix_f32 v155, v85, v139, v147 op_sel:[1,0,0] op_sel_hi:[1,0,0]
    v_cvt_pk_bf16_f32 v117, v154, v155
    v_fma_mix_f32 v156, v86, v140, v148 op_sel_hi:[1,0,0]
    v_fma_mix_f32 v157, v86, v141, v149 op_sel:[1,0,0] op_sel_hi:[1,0,0]
    v_mfma_f32_16x16x32_bf16 v[228:231], a[16:19], v[92:95], v[228:231]
    v_cvt_pk_bf16_f32 v118, v156, v157
    v_fma_mix_f32 v158, v87, v142, v150 op_sel_hi:[1,0,0]
    v_fma_mix_f32 v159, v87, v143, v151 op_sel:[1,0,0] op_sel_hi:[1,0,0]
    v_cvt_pk_bf16_f32 v119, v158, v159
    v_mfma_f32_16x16x32_bf16 v[232:235], a[16:19], v[96:99], v[232:235]
    buffer_load_dwordx4 v[84:87], v12, s[28:31], s48 offen offset:3072
    v_mfma_f32_16x16x32_bf16 v[236:239], a[16:19], v[100:103], v[236:239]
    ds_read_b64_tr_b16 a[16:17], v21 offset:6144
    ds_read_b64_tr_b16 a[18:19], v21 offset:6656
    s_add_u32 s49, s49, 0x20000
    s_add_u32 s48, s48, 0x40000
    v_xor_b32 v17, 0x8000, v17
    v_xor_b32 v18, 0x8000, v18
    v_xor_b32 v19, 0x8000, v19
    v_xor_b32 v20, 0x8000, v20
    v_add_u32 v21, 8192, v21
    v_add_u32 v22, 1024, v22
    s_xor_b32 s51, s51, 0x8000
    s_add_u32 m0, s51, 0
    s_waitcnt vmcnt(18) lgkmcnt(2)
    v_mfma_f32_16x16x32_bf16 v[160:163], a[0:3], v[104:107], v[160:163]
    buffer_load_dwordx4 v13, s[12:15], s49 offen lds
    v_fma_mix_f32 v152, v24, v120, v128 op_sel_hi:[1,0,0]
    v_fma_mix_f32 v153, v24, v121, v129 op_sel:[1,0,0] op_sel_hi:[1,0,0]
    v_cvt_pk_bf16_f32 v88, v152, v153
    v_mfma_f32_16x16x32_bf16 v[164:167], a[0:3], v[108:111], v[164:167]
    buffer_load_dwordx4 v14, s[12:15], s49 offen offset:1024 lds
    v_fma_mix_f32 v154, v25, v122, v130 op_sel_hi:[1,0,0]
    v_fma_mix_f32 v155, v25, v123, v131 op_sel:[1,0,0] op_sel_hi:[1,0,0]
    v_cvt_pk_bf16_f32 v89, v154, v155
    v_mfma_f32_16x16x32_bf16 v[168:171], a[0:3], v[112:115], v[168:171]
    v_fma_mix_f32 v156, v26, v124, v132 op_sel_hi:[1,0,0]
    v_fma_mix_f32 v157, v26, v125, v133 op_sel:[1,0,0] op_sel_hi:[1,0,0]
    v_cvt_pk_bf16_f32 v90, v156, v157
    s_barrier
    v_mfma_f32_16x16x32_bf16 v[172:175], a[0:3], v[116:119], v[172:175]
    ds_read_b64_tr_b16 a[0:1], v17 offset:0
    ds_read_b64_tr_b16 a[2:3], v17 offset:2048
    v_fma_mix_f32 v158, v27, v126, v134 op_sel_hi:[1,0,0]
    v_mfma_f32_16x16x32_bf16 v[176:179], a[4:7], v[104:107], v[176:179]
    ds_read_b128 v[136:139], v22 offset:256
    v_fma_mix_f32 v159, v27, v127, v135 op_sel:[1,0,0] op_sel_hi:[1,0,0]
    v_cvt_pk_bf16_f32 v91, v158, v159
    v_fma_mix_f32 v152, v28, v120, v128 op_sel_hi:[1,0,0]
    v_mfma_f32_16x16x32_bf16 v[180:183], a[4:7], v[108:111], v[180:183]
    ds_read_b128 v[140:143], v22 offset:320
    v_fma_mix_f32 v153, v28, v121, v129 op_sel:[1,0,0] op_sel_hi:[1,0,0]
    v_cvt_pk_bf16_f32 v92, v152, v153
    v_fma_mix_f32 v154, v29, v122, v130 op_sel_hi:[1,0,0]
    v_mfma_f32_16x16x32_bf16 v[184:187], a[4:7], v[112:115], v[184:187]
    buffer_load_dwordx4 v[24:27], v12, s[28:31], s48 offen offset:0
    v_fma_mix_f32 v155, v29, v123, v131 op_sel:[1,0,0] op_sel_hi:[1,0,0]
    v_cvt_pk_bf16_f32 v93, v154, v155
    v_fma_mix_f32 v156, v30, v124, v132 op_sel_hi:[1,0,0]
    v_mfma_f32_16x16x32_bf16 v[188:191], a[4:7], v[116:119], v[188:191]
    ds_read_b64_tr_b16 a[4:5], v18 offset:0
    ds_read_b64_tr_b16 a[6:7], v18 offset:2048
    v_fma_mix_f32 v157, v30, v125, v133 op_sel:[1,0,0] op_sel_hi:[1,0,0]
    v_mfma_f32_16x16x32_bf16 v[192:195], a[8:11], v[104:107], v[192:195]
    ds_read_b128 v[144:147], v22 offset:4352
    v_cvt_pk_bf16_f32 v94, v156, v157
    v_fma_mix_f32 v158, v31, v126, v134 op_sel_hi:[1,0,0]
    v_fma_mix_f32 v159, v31, v127, v135 op_sel:[1,0,0] op_sel_hi:[1,0,0]
    v_mfma_f32_16x16x32_bf16 v[196:199], a[8:11], v[108:111], v[196:199]
    ds_read_b128 v[148:151], v22 offset:4416
    v_cvt_pk_bf16_f32 v95, v158, v159
    v_fma_mix_f32 v152, v32, v120, v128 op_sel_hi:[1,0,0]
    v_fma_mix_f32 v153, v32, v121, v129 op_sel:[1,0,0] op_sel_hi:[1,0,0]
    v_mfma_f32_16x16x32_bf16 v[200:203], a[8:11], v[112:115], v[200:203]
    buffer_load_dwordx4 v[28:31], v12, s[28:31], s48 offen offset:1024
    v_cvt_pk_bf16_f32 v96, v152, v153
    v_fma_mix_f32 v154, v33, v122, v130 op_sel_hi:[1,0,0]
    v_fma_mix_f32 v155, v33, v123, v131 op_sel:[1,0,0] op_sel_hi:[1,0,0]
    v_mfma_f32_16x16x32_bf16 v[204:207], a[8:11], v[116:119], v[204:207]
    ds_read_b64_tr_b16 a[8:9], v19 offset:0
    ds_read_b64_tr_b16 a[10:11], v19 offset:2048
    v_cvt_pk_bf16_f32 v97, v154, v155
    s_mov_b32 m0, s52
    v_mfma_f32_16x16x32_bf16 v[208:211], a[12:15], v[104:107], v[208:211]
    buffer_load_dwordx4 v15, s[16:19], s50 offen lds
    v_fma_mix_f32 v156, v34, v124, v132 op_sel_hi:[1,0,0]
    v_fma_mix_f32 v157, v34, v125, v133 op_sel:[1,0,0] op_sel_hi:[1,0,0]
    v_cvt_pk_bf16_f32 v98, v156, v157
    v_mfma_f32_16x16x32_bf16 v[212:215], a[12:15], v[108:111], v[212:215]
    buffer_load_dwordx4 v16, s[16:19], s50 offen offset:1024 lds
    v_fma_mix_f32 v158, v35, v126, v134 op_sel_hi:[1,0,0]
    v_fma_mix_f32 v159, v35, v127, v135 op_sel:[1,0,0] op_sel_hi:[1,0,0]
    v_cvt_pk_bf16_f32 v99, v158, v159
    v_mfma_f32_16x16x32_bf16 v[216:219], a[12:15], v[112:115], v[216:219]
    buffer_load_dwordx4 v[32:35], v12, s[28:31], s48 offen offset:2048
    v_fma_mix_f32 v152, v36, v120, v128 op_sel_hi:[1,0,0]
    v_fma_mix_f32 v153, v36, v121, v129 op_sel:[1,0,0] op_sel_hi:[1,0,0]
    v_cvt_pk_bf16_f32 v100, v152, v153
    v_mfma_f32_16x16x32_bf16 v[220:223], a[12:15], v[116:119], v[220:223]
    ds_read_b64_tr_b16 a[12:13], v20 offset:0
    ds_read_b64_tr_b16 a[14:15], v20 offset:2048
    v_fma_mix_f32 v154, v37, v122, v130 op_sel_hi:[1,0,0]
    s_waitcnt lgkmcnt(12)
    v_mfma_f32_16x16x32_bf16 v[224:227], a[16:19], v[104:107], v[224:227]
    v_fma_mix_f32 v155, v37, v123, v131 op_sel:[1,0,0] op_sel_hi:[1,0,0]
    v_cvt_pk_bf16_f32 v101, v154, v155
    v_fma_mix_f32 v156, v38, v124, v132 op_sel_hi:[1,0,0]
    v_fma_mix_f32 v157, v38, v125, v133 op_sel:[1,0,0] op_sel_hi:[1,0,0]
    v_mfma_f32_16x16x32_bf16 v[228:231], a[16:19], v[108:111], v[228:231]
    v_cvt_pk_bf16_f32 v102, v156, v157
    v_fma_mix_f32 v158, v39, v126, v134 op_sel_hi:[1,0,0]
    v_fma_mix_f32 v159, v39, v127, v135 op_sel:[1,0,0] op_sel_hi:[1,0,0]
    v_cvt_pk_bf16_f32 v103, v158, v159
    v_mfma_f32_16x16x32_bf16 v[232:235], a[16:19], v[112:115], v[232:235]
    buffer_load_dwordx4 v[36:39], v12, s[28:31], s48 offen offset:3072
    v_mfma_f32_16x16x32_bf16 v[236:239], a[16:19], v[116:119], v[236:239]
    ds_read_b64_tr_b16 a[16:17], v21 offset:0
    ds_read_b64_tr_b16 a[18:19], v21 offset:512
    s_add_u32 s49, s49, 0x20000
    s_add_u32 s48, s48, 0x40000
    s_add_u32 s52, s52, 8192
    s_add_u32 s50, s50, 16384
    s_sub_u32 s53, s53, 1
    s_cmp_lg_u32 s53, 0
    s_cbranch_scc1 K2_LOOP
    s_waitcnt vmcnt(20) lgkmcnt(2)
    v_mfma_f32_16x16x32_bf16 v[160:163], a[0:3], v[88:91], v[160:163]

    v_fma_mix_f32 v152, v40, v136, v144 op_sel_hi:[1,0,0]
    v_fma_mix_f32 v153, v40, v137, v145 op_sel:[1,0,0] op_sel_hi:[1,0,0]
    v_cvt_pk_bf16_f32 v104, v152, v153
    v_mfma_f32_16x16x32_bf16 v[164:167], a[0:3], v[92:95], v[164:167]

    v_fma_mix_f32 v154, v41, v138, v146 op_sel_hi:[1,0,0]
    v_fma_mix_f32 v155, v41, v139, v147 op_sel:[1,0,0] op_sel_hi:[1,0,0]
    v_cvt_pk_bf16_f32 v105, v154, v155
    v_mfma_f32_16x16x32_bf16 v[168:171], a[0:3], v[96:99], v[168:171]
    v_fma_mix_f32 v156, v42, v140, v148 op_sel_hi:[1,0,0]
    v_fma_mix_f32 v157, v42, v141, v149 op_sel:[1,0,0] op_sel_hi:[1,0,0]
    v_cvt_pk_bf16_f32 v106, v156, v157
    s_barrier
    v_mfma_f32_16x16x32_bf16 v[172:175], a[0:3], v[100:103], v[172:175]
    ds_read_b64_tr_b16 a[0:1], v17 offset:8192
    ds_read_b64_tr_b16 a[2:3], v17 offset:10240
    v_fma_mix_f32 v158, v43, v142, v150 op_sel_hi:[1,0,0]
    v_mfma_f32_16x16x32_bf16 v[176:179], a[4:7], v[88:91], v[176:179]
    ds_read_b128 v[120:123], v22 offset:512
    v_fma_mix_f32 v159, v43, v143, v151 op_sel:[1,0,0] op_sel_hi:[1,0,0]
    v_cvt_pk_bf16_f32 v107, v158, v159
    v_fma_mix_f32 v152, v44, v136, v144 op_sel_hi:[1,0,0]
    v_mfma_f32_16x16x32_bf16 v[180:183], a[4:7], v[92:95], v[180:183]
    ds_read_b128 v[124:127], v22 offset:576
    v_fma_mix_f32 v153, v44, v137, v145 op_sel:[1,0,0] op_sel_hi:[1,0,0]
    v_cvt_pk_bf16_f32 v108, v152, v153
    v_fma_mix_f32 v154, v45, v138, v146 op_sel_hi:[1,0,0]
    v_mfma_f32_16x16x32_bf16 v[184:187], a[4:7], v[96:99], v[184:187]

    v_fma_mix_f32 v155, v45, v139, v147 op_sel:[1,0,0] op_sel_hi:[1,0,0]
    v_cvt_pk_bf16_f32 v109, v154, v155
    v_fma_mix_f32 v156, v46, v140, v148 op_sel_hi:[1,0,0]
    v_mfma_f32_16x16x32_bf16 v[188:191], a[4:7], v[100:103], v[188:191]
    ds_read_b64_tr_b16 a[4:5], v18 offset:8192
    ds_read_b64_tr_b16 a[6:7], v18 offset:10240
    v_fma_mix_f32 v157, v46, v141, v149 op_sel:[1,0,0] op_sel_hi:[1,0,0]
    v_mfma_f32_16x16x32_bf16 v[192:195], a[8:11], v[88:91], v[192:195]
    ds_read_b128 v[128:131], v22 offset:4608
    v_cvt_pk_bf16_f32 v110, v156, v157
    v_fma_mix_f32 v158, v47, v142, v150 op_sel_hi:[1,0,0]
    v_fma_mix_f32 v159, v47, v143, v151 op_sel:[1,0,0] op_sel_hi:[1,0,0]
    v_mfma_f32_16x16x32_bf16 v[196:199], a[8:11], v[92:95], v[196:199]
    ds_read_b128 v[132:135], v22 offset:4672
    v_cvt_pk_bf16_f32 v111, v158, v159
    v_fma_mix_f32 v152, v48, v136, v144 op_sel_hi:[1,0,0]
    v_fma_mix_f32 v153, v48, v137, v145 op_sel:[1,0,0] op_sel_hi:[1,0,0]
    v_mfma_f32_16x16x32_bf16 v[200:203], a[8:11], v[96:99], v[200:203]

    v_cvt_pk_bf16_f32 v112, v152, v153
    v_fma_mix_f32 v154, v49, v138, v146 op_sel_hi:[1,0,0]
    v_fma_mix_f32 v155, v49, v139, v147 op_sel:[1,0,0] op_sel_hi:[1,0,0]
    v_mfma_f32_16x16x32_bf16 v[204:207], a[8:11], v[100:103], v[204:207]
    ds_read_b64_tr_b16 a[8:9], v19 offset:8192
    ds_read_b64_tr_b16 a[10:11], v19 offset:10240
    v_cvt_pk_bf16_f32 v113, v154, v155
    v_mfma_f32_16x16x32_bf16 v[208:211], a[12:15], v[88:91], v[208:211]
    v_fma_mix_f32 v156, v50, v140, v148 op_sel_hi:[1,0,0]
    v_fma_mix_f32 v157, v50, v141, v149 op_sel:[1,0,0] op_sel_hi:[1,0,0]
    v_cvt_pk_bf16_f32 v114, v156, v157
    v_mfma_f32_16x16x32_bf16 v[212:215], a[12:15], v[92:95], v[212:215]
    v_fma_mix_f32 v158, v51, v142, v150 op_sel_hi:[1,0,0]
    v_fma_mix_f32 v159, v51, v143, v151 op_sel:[1,0,0] op_sel_hi:[1,0,0]
    v_cvt_pk_bf16_f32 v115, v158, v159
    v_mfma_f32_16x16x32_bf16 v[216:219], a[12:15], v[96:99], v[216:219]

    v_fma_mix_f32 v152, v52, v136, v144 op_sel_hi:[1,0,0]
    v_fma_mix_f32 v153, v52, v137, v145 op_sel:[1,0,0] op_sel_hi:[1,0,0]
    v_cvt_pk_bf16_f32 v116, v152, v153
    v_mfma_f32_16x16x32_bf16 v[220:223], a[12:15], v[100:103], v[220:223]
    ds_read_b64_tr_b16 a[12:13], v20 offset:8192
    ds_read_b64_tr_b16 a[14:15], v20 offset:10240
    v_fma_mix_f32 v154, v53, v138, v146 op_sel_hi:[1,0,0]
    s_waitcnt lgkmcnt(12)
    v_mfma_f32_16x16x32_bf16 v[224:227], a[16:19], v[88:91], v[224:227]
    v_fma_mix_f32 v155, v53, v139, v147 op_sel:[1,0,0] op_sel_hi:[1,0,0]
    v_cvt_pk_bf16_f32 v117, v154, v155
    v_fma_mix_f32 v156, v54, v140, v148 op_sel_hi:[1,0,0]
    v_fma_mix_f32 v157, v54, v141, v149 op_sel:[1,0,0] op_sel_hi:[1,0,0]
    v_mfma_f32_16x16x32_bf16 v[228:231], a[16:19], v[92:95], v[228:231]
    v_cvt_pk_bf16_f32 v118, v156, v157
    v_fma_mix_f32 v158, v55, v142, v150 op_sel_hi:[1,0,0]
    v_fma_mix_f32 v159, v55, v143, v151 op_sel:[1,0,0] op_sel_hi:[1,0,0]
    v_cvt_pk_bf16_f32 v119, v158, v159
    v_mfma_f32_16x16x32_bf16 v[232:235], a[16:19], v[96:99], v[232:235]

    v_mfma_f32_16x16x32_bf16 v[236:239], a[16:19], v[100:103], v[236:239]
    ds_read_b64_tr_b16 a[16:17], v21 offset:2048
    ds_read_b64_tr_b16 a[18:19], v21 offset:2560
    s_waitcnt vmcnt(14) lgkmcnt(2)
    v_mfma_f32_16x16x32_bf16 v[160:163], a[0:3], v[104:107], v[160:163]

    v_fma_mix_f32 v152, v56, v120, v128 op_sel_hi:[1,0,0]
    v_fma_mix_f32 v153, v56, v121, v129 op_sel:[1,0,0] op_sel_hi:[1,0,0]
    v_cvt_pk_bf16_f32 v88, v152, v153
    v_mfma_f32_16x16x32_bf16 v[164:167], a[0:3], v[108:111], v[164:167]

    v_fma_mix_f32 v154, v57, v122, v130 op_sel_hi:[1,0,0]
    v_fma_mix_f32 v155, v57, v123, v131 op_sel:[1,0,0] op_sel_hi:[1,0,0]
    v_cvt_pk_bf16_f32 v89, v154, v155
    v_mfma_f32_16x16x32_bf16 v[168:171], a[0:3], v[112:115], v[168:171]
    v_fma_mix_f32 v156, v58, v124, v132 op_sel_hi:[1,0,0]
    v_fma_mix_f32 v157, v58, v125, v133 op_sel:[1,0,0] op_sel_hi:[1,0,0]
    v_cvt_pk_bf16_f32 v90, v156, v157
    s_barrier
    v_mfma_f32_16x16x32_bf16 v[172:175], a[0:3], v[116:119], v[172:175]
    ds_read_b64_tr_b16 a[0:1], v17 offset:16384
    ds_read_b64_tr_b16 a[2:3], v17 offset:18432
    v_fma_mix_f32 v158, v59, v126, v134 op_sel_hi:[1,0,0]
    v_mfma_f32_16x16x32_bf16 v[176:179], a[4:7], v[104:107], v[176:179]
    ds_read_b128 v[136:139], v22 offset:768
    v_fma_mix_f32 v159, v59, v127, v135 op_sel:[1,0,0] op_sel_hi:[1,0,0]
    v_cvt_pk_bf16_f32 v91, v158, v159
    v_fma_mix_f32 v152, v60, v120, v128 op_sel_hi:[1,0,0]
    v_mfma_f32_16x16x32_bf16 v[180:183], a[4:7], v[108:111], v[180:183]
    ds_read_b128 v[140:143], v22 offset:832
    v_fma_mix_f32 v153, v60, v121, v129 op_sel:[1,0,0] op_sel_hi:[1,0,0]
    v_cvt_pk_bf16_f32 v92, v152, v153
    v_fma_mix_f32 v154, v61, v122, v130 op_sel_hi:[1,0,0]
    v_mfma_f32_16x16x32_bf16 v[184:187], a[4:7], v[112:115], v[184:187]

    v_fma_mix_f32 v155, v61, v123, v131 op_sel:[1,0,0] op_sel_hi:[1,0,0]
    v_cvt_pk_bf16_f32 v93, v154, v155
    v_fma_mix_f32 v156, v62, v124, v132 op_sel_hi:[1,0,0]
    v_mfma_f32_16x16x32_bf16 v[188:191], a[4:7], v[116:119], v[188:191]
    ds_read_b64_tr_b16 a[4:5], v18 offset:16384
    ds_read_b64_tr_b16 a[6:7], v18 offset:18432
    v_fma_mix_f32 v157, v62, v125, v133 op_sel:[1,0,0] op_sel_hi:[1,0,0]
    v_mfma_f32_16x16x32_bf16 v[192:195], a[8:11], v[104:107], v[192:195]
    ds_read_b128 v[144:147], v22 offset:4864
    v_cvt_pk_bf16_f32 v94, v156, v157
    v_fma_mix_f32 v158, v63, v126, v134 op_sel_hi:[1,0,0]
    v_fma_mix_f32 v159, v63, v127, v135 op_sel:[1,0,0] op_sel_hi:[1,0,0]
    v_mfma_f32_16x16x32_bf16 v[196:199], a[8:11], v[108:111], v[196:199]
    ds_read_b128 v[148:151], v22 offset:4928
    v_cvt_pk_bf16_f32 v95, v158, v159
    v_fma_mix_f32 v152, v64, v120, v128 op_sel_hi:[1,0,0]
    v_fma_mix_f32 v153, v64, v121, v129 op_sel:[1,0,0] op_sel_hi:[1,0,0]
    v_mfma_f32_16x16x32_bf16 v[200:203], a[8:11], v[112:115], v[200:203]

    v_cvt_pk_bf16_f32 v96, v152, v153
    v_fma_mix_f32 v154, v65, v122, v130 op_sel_hi:[1,0,0]
    v_fma_mix_f32 v155, v65, v123, v131 op_sel:[1,0,0] op_sel_hi:[1,0,0]
    v_mfma_f32_16x16x32_bf16 v[204:207], a[8:11], v[116:119], v[204:207]
    ds_read_b64_tr_b16 a[8:9], v19 offset:16384
    ds_read_b64_tr_b16 a[10:11], v19 offset:18432
    v_cvt_pk_bf16_f32 v97, v154, v155
    v_mfma_f32_16x16x32_bf16 v[208:211], a[12:15], v[104:107], v[208:211]
    v_fma_mix_f32 v156, v66, v124, v132 op_sel_hi:[1,0,0]
    v_fma_mix_f32 v157, v66, v125, v133 op_sel:[1,0,0] op_sel_hi:[1,0,0]
    v_cvt_pk_bf16_f32 v98, v156, v157
    v_mfma_f32_16x16x32_bf16 v[212:215], a[12:15], v[108:111], v[212:215]
    v_fma_mix_f32 v158, v67, v126, v134 op_sel_hi:[1,0,0]
    v_fma_mix_f32 v159, v67, v127, v135 op_sel:[1,0,0] op_sel_hi:[1,0,0]
    v_cvt_pk_bf16_f32 v99, v158, v159
    v_mfma_f32_16x16x32_bf16 v[216:219], a[12:15], v[112:115], v[216:219]

    v_fma_mix_f32 v152, v68, v120, v128 op_sel_hi:[1,0,0]
    v_fma_mix_f32 v153, v68, v121, v129 op_sel:[1,0,0] op_sel_hi:[1,0,0]
    v_cvt_pk_bf16_f32 v100, v152, v153
    v_mfma_f32_16x16x32_bf16 v[220:223], a[12:15], v[116:119], v[220:223]
    ds_read_b64_tr_b16 a[12:13], v20 offset:16384
    ds_read_b64_tr_b16 a[14:15], v20 offset:18432
    v_fma_mix_f32 v154, v69, v122, v130 op_sel_hi:[1,0,0]
    s_waitcnt lgkmcnt(12)
    v_mfma_f32_16x16x32_bf16 v[224:227], a[16:19], v[104:107], v[224:227]
    v_fma_mix_f32 v155, v69, v123, v131 op_sel:[1,0,0] op_sel_hi:[1,0,0]
    v_cvt_pk_bf16_f32 v101, v154, v155
    v_fma_mix_f32 v156, v70, v124, v132 op_sel_hi:[1,0,0]
    v_fma_mix_f32 v157, v70, v125, v133 op_sel:[1,0,0] op_sel_hi:[1,0,0]
    v_mfma_f32_16x16x32_bf16 v[228:231], a[16:19], v[108:111], v[228:231]
    v_cvt_pk_bf16_f32 v102, v156, v157
    v_fma_mix_f32 v158, v71, v126, v134 op_sel_hi:[1,0,0]
    v_fma_mix_f32 v159, v71, v127, v135 op_sel:[1,0,0] op_sel_hi:[1,0,0]
    v_cvt_pk_bf16_f32 v103, v158, v159
    v_mfma_f32_16x16x32_bf16 v[232:235], a[16:19], v[112:115], v[232:235]

    v_mfma_f32_16x16x32_bf16 v[236:239], a[16:19], v[116:119], v[236:239]
    ds_read_b64_tr_b16 a[16:17], v21 offset:4096
    ds_read_b64_tr_b16 a[18:19], v21 offset:4608
    s_waitcnt vmcnt(8) lgkmcnt(2)
    v_mfma_f32_16x16x32_bf16 v[160:163], a[0:3], v[88:91], v[160:163]

    v_fma_mix_f32 v152, v72, v136, v144 op_sel_hi:[1,0,0]
    v_fma_mix_f32 v153, v72, v137, v145 op_sel:[1,0,0] op_sel_hi:[1,0,0]
    v_cvt_pk_bf16_f32 v104, v152, v153
    v_mfma_f32_16x16x32_bf16 v[164:167], a[0:3], v[92:95], v[164:167]

    v_fma_mix_f32 v154, v73, v138, v146 op_sel_hi:[1,0,0]
    v_fma_mix_f32 v155, v73, v139, v147 op_sel:[1,0,0] op_sel_hi:[1,0,0]
    v_cvt_pk_bf16_f32 v105, v154, v155
    v_mfma_f32_16x16x32_bf16 v[168:171], a[0:3], v[96:99], v[168:171]
    v_fma_mix_f32 v156, v74, v140, v148 op_sel_hi:[1,0,0]
    v_fma_mix_f32 v157, v74, v141, v149 op_sel:[1,0,0] op_sel_hi:[1,0,0]
    v_cvt_pk_bf16_f32 v106, v156, v157
    s_barrier
    v_mfma_f32_16x16x32_bf16 v[172:175], a[0:3], v[100:103], v[172:175]
    ds_read_b64_tr_b16 a[0:1], v17 offset:24576
    ds_read_b64_tr_b16 a[2:3], v17 offset:26624
    v_fma_mix_f32 v158, v75, v142, v150 op_sel_hi:[1,0,0]
    v_mfma_f32_16x16x32_bf16 v[176:179], a[4:7], v[88:91], v[176:179]

    v_fma_mix_f32 v159, v75, v143, v151 op_sel:[1,0,0] op_sel_hi:[1,0,0]
    v_cvt_pk_bf16_f32 v107, v158, v159
    v_fma_mix_f32 v152, v76, v136, v144 op_sel_hi:[1,0,0]
    v_mfma_f32_16x16x32_bf16 v[180:183], a[4:7], v[92:95], v[180:183]

    v_fma_mix_f32 v153, v76, v137, v145 op_sel:[1,0,0] op_sel_hi:[1,0,0]
    v_cvt_pk_bf16_f32 v108, v152, v153
    v_fma_mix_f32 v154, v77, v138, v146 op_sel_hi:[1,0,0]
    v_mfma_f32_16x16x32_bf16 v[184:187], a[4:7], v[96:99], v[184:187]

    v_fma_mix_f32 v155, v77, v139, v147 op_sel:[1,0,0] op_sel_hi:[1,0,0]
    v_cvt_pk_bf16_f32 v109, v154, v155
    v_fma_mix_f32 v156, v78, v140, v148 op_sel_hi:[1,0,0]
    v_mfma_f32_16x16x32_bf16 v[188:191], a[4:7], v[100:103], v[188:191]
    ds_read_b64_tr_b16 a[4:5], v18 offset:24576
    ds_read_b64_tr_b16 a[6:7], v18 offset:26624
    v_fma_mix_f32 v157, v78, v141, v149 op_sel:[1,0,0] op_sel_hi:[1,0,0]
    v_mfma_f32_16x16x32_bf16 v[192:195], a[8:11], v[88:91], v[192:195]

    v_cvt_pk_bf16_f32 v110, v156, v157
    v_fma_mix_f32 v158, v79, v142, v150 op_sel_hi:[1,0,0]
    v_fma_mix_f32 v159, v79, v143, v151 op_sel:[1,0,0] op_sel_hi:[1,0,0]
    v_mfma_f32_16x16x32_bf16 v[196:199], a[8:11], v[92:95], v[196:199]

    v_cvt_pk_bf16_f32 v111, v158, v159
    v_fma_mix_f32 v152, v80, v136, v144 op_sel_hi:[1,0,0]
    v_fma_mix_f32 v153, v80, v137, v145 op_sel:[1,0,0] op_sel_hi:[1,0,0]
    v_mfma_f32_16x16x32_bf16 v[200:203], a[8:11], v[96:99], v[200:203]

    v_cvt_pk_bf16_f32 v112, v152, v153
    v_fma_mix_f32 v154, v81, v138, v146 op_sel_hi:[1,0,0]
    v_fma_mix_f32 v155, v81, v139, v147 op_sel:[1,0,0] op_sel_hi:[1,0,0]
    v_mfma_f32_16x16x32_bf16 v[204:207], a[8:11], v[100:103], v[204:207]
    ds_read_b64_tr_b16 a[8:9], v19 offset:24576
    ds_read_b64_tr_b16 a[10:11], v19 offset:26624
    v_cvt_pk_bf16_f32 v113, v154, v155
    v_mfma_f32_16x16x32_bf16 v[208:211], a[12:15], v[88:91], v[208:211]
    v_fma_mix_f32 v156, v82, v140, v148 op_sel_hi:[1,0,0]
    v_fma_mix_f32 v157, v82, v141, v149 op_sel:[1,0,0] op_sel_hi:[1,0,0]
    v_cvt_pk_bf16_f32 v114, v156, v157
    v_mfma_f32_16x16x32_bf16 v[212:215], a[12:15], v[92:95], v[212:215]
    v_fma_mix_f32 v158, v83, v142, v150 op_sel_hi:[1,0,0]
    v_fma_mix_f32 v159, v83, v143, v151 op_sel:[1,0,0] op_sel_hi:[1,0,0]
    v_cvt_pk_bf16_f32 v115, v158, v159
    v_mfma_f32_16x16x32_bf16 v[216:219], a[12:15], v[96:99], v[216:219]

    v_fma_mix_f32 v152, v84, v136, v144 op_sel_hi:[1,0,0]
    v_fma_mix_f32 v153, v84, v137, v145 op_sel:[1,0,0] op_sel_hi:[1,0,0]
    v_cvt_pk_bf16_f32 v116, v152, v153
    v_mfma_f32_16x16x32_bf16 v[220:223], a[12:15], v[100:103], v[220:223]
    ds_read_b64_tr_b16 a[12:13], v20 offset:24576
    ds_read_b64_tr_b16 a[14:15], v20 offset:26624
    v_fma_mix_f32 v154, v85, v138, v146 op_sel_hi:[1,0,0]
    s_waitcnt lgkmcnt(8)
    v_mfma_f32_16x16x32_bf16 v[224:227], a[16:19], v[88:91], v[224:227]
    v_fma_mix_f32 v155, v85, v139, v147 op_sel:[1,0,0] op_sel_hi:[1,0,0]
    v_cvt_pk_bf16_f32 v117, v154, v155
    v_fma_mix_f32 v156, v86, v140, v148 op_sel_hi:[1,0,0]
    v_fma_mix_f32 v157, v86, v141, v149 op_sel:[1,0,0] op_sel_hi:[1,0,0]
    v_mfma_f32_16x16x32_bf16 v[228:231], a[16:19], v[92:95], v[228:231]
    v_cvt_pk_bf16_f32 v118, v156, v157
    v_fma_mix_f32 v158, v87, v142, v150 op_sel_hi:[1,0,0]
    v_fma_mix_f32 v159, v87, v143, v151 op_sel:[1,0,0] op_sel_hi:[1,0,0]
    v_cvt_pk_bf16_f32 v119, v158, v159
    v_mfma_f32_16x16x32_bf16 v[232:235], a[16:19], v[96:99], v[232:235]

    v_mfma_f32_16x16x32_bf16 v[236:239], a[16:19], v[100:103], v[236:239]
    ds_read_b64_tr_b16 a[16:17], v21 offset:6144
    ds_read_b64_tr_b16 a[18:19], v21 offset:6656
    s_waitcnt vmcnt(8) lgkmcnt(2)
    v_mfma_f32_16x16x32_bf16 v[160:163], a[0:3], v[104:107], v[160:163]

    v_mfma_f32_16x16x32_bf16 v[164:167], a[0:3], v[108:111], v[164:167]

    v_mfma_f32_16x16x32_bf16 v[168:171], a[0:3], v[112:115], v[168:171]

    v_mfma_f32_16x16x32_bf16 v[172:175], a[0:3], v[116:119], v[172:175]

    v_mfma_f32_16x16x32_bf16 v[176:179], a[4:7], v[104:107], v[176:179]

    v_mfma_f32_16x16x32_bf16 v[180:183], a[4:7], v[108:111], v[180:183]

    v_mfma_f32_16x16x32_bf16 v[184:187], a[4:7], v[112:115], v[184:187]

    v_mfma_f32_16x16x32_bf16 v[188:191], a[4:7], v[116:119], v[188:191]

    v_mfma_f32_16x16x32_bf16 v[192:195], a[8:11], v[104:107], v[192:195]

    v_mfma_f32_16x16x32_bf16 v[196:199], a[8:11], v[108:111], v[196:199]

    v_mfma_f32_16x16x32_bf16 v[200:203], a[8:11], v[112:115], v[200:203]

    v_mfma_f32_16x16x32_bf16 v[204:207], a[8:11], v[116:119], v[204:207]

    v_mfma_f32_16x16x32_bf16 v[208:211], a[12:15], v[104:107], v[208:211]

    v_mfma_f32_16x16x32_bf16 v[212:215], a[12:15], v[108:111], v[212:215]

    v_mfma_f32_16x16x32_bf16 v[216:219], a[12:15], v[112:115], v[216:219]

    v_mfma_f32_16x16x32_bf16 v[220:223], a[12:15], v[116:119], v[220:223]

    s_waitcnt lgkmcnt(0)
    v_mfma_f32_16x16x32_bf16 v[224:227], a[16:19], v[104:107], v[224:227]

    v_mfma_f32_16x16x32_bf16 v[228:231], a[16:19], v[108:111], v[228:231]

    v_mfma_f32_16x16x32_bf16 v[232:235], a[16:19], v[112:115], v[232:235]

    v_mfma_f32_16x16x32_bf16 v[236:239], a[16:19], v[116:119], v[236:239]
    s_waitcnt vmcnt(0) lgkmcnt(0)
    s_barrier
    s_cmp_eq_u32 s39, 0
    s_cbranch_scc1 K2_NOSWAP
    v_swap_b32 v160, v192
    v_swap_b32 v161, v193
    v_swap_b32 v162, v194
    v_swap_b32 v163, v195
    v_swap_b32 v164, v196
    v_swap_b32 v165, v197
    v_swap_b32 v166, v198
    v_swap_b32 v167, v199
    v_swap_b32 v168, v200
    v_swap_b32 v169, v201
    v_swap_b32 v170, v202
    v_swap_b32 v171, v203
    v_swap_b32 v172, v204
    v_swap_b32 v173, v205
    v_swap_b32 v174, v206
    v_swap_b32 v175, v207
    v_swap_b32 v176, v208
    v_swap_b32 v177, v209
    v_swap_b32 v178, v210
    v_swap_b32 v179, v211
    v_swap_b32 v180, v212
    v_swap_b32 v181, v213
    v_swap_b32 v182, v214
    v_swap_b32 v183, v215
    v_swap_b32 v184, v216
    v_swap_b32 v185, v217
    v_swap_b32 v186, v218
    v_swap_b32 v187, v219
    v_swap_b32 v188, v220
    v_swap_b32 v189, v221
    v_swap_b32 v190, v222
    v_swap_b32 v191, v223
K2_NOSWAP:
    v_lshlrev_b32 v3, 4, v1
    s_lshl_b32 s41, s38, 13
    v_add_u32 v4, s41, v3
    v_xor_b32 v5, 0x4000, v4
    v_and_b32 v6, 15, v1
    v_lshlrev_b32 v7, 6, v6
    v_lshl_add_u32 v7, v23, 4, v7
    s_lshl_b32 s41, s38, 12
    s_add_u32 s41, s41, 32768
    v_add_u32 v7, s41, v7
    ds_write_b128 v4, v[192:195] offset:0
    ds_write_b128 v4, v[196:199] offset:1024
    ds_write_b128 v4, v[200:203] offset:2048
    ds_write_b128 v4, v[204:207] offset:3072
    ds_write_b128 v4, v[208:211] offset:4096
    ds_write_b128 v4, v[212:215] offset:5120
    ds_write_b128 v4, v[216:219] offset:6144
    ds_write_b128 v4, v[220:223] offset:7168
    s_cmp_eq_u32 s46, 0
    s_cbranch_scc1 K2_NOEXTW
    ds_write_b128 v7, v[224:227] offset:0
    ds_write_b128 v7, v[228:231] offset:1024
    ds_write_b128 v7, v[232:235] offset:2048
    ds_write_b128 v7, v[236:239] offset:3072
K2_NOEXTW:
    s_lshl_b32 s41, s37, 1
    s_add_u32 s41, s41, s39
    s_lshl_b32 s41, s41, 6
    s_add_u32 s41, s41, s47
    s_lshl_b32 s41, s41, 11
    s_add_u32 s41, s41, 0x500000
    v_lshlrev_b32 v8, 9, v23
    v_lshl_add_u32 v8, v6, 4, v8
    s_mov_b32 s42, 0x3e8293ee
    s_mov_b32 s43, s42
    s_waitcnt lgkmcnt(0)
    s_barrier
    ds_read_b128 v[192:195], v5 offset:0
    ds_read_b128 v[208:211], v5 offset:4096
    ds_read_b128 v[196:199], v5 offset:1024
    ds_read_b128 v[212:215], v5 offset:5120
    ds_read_b128 v[200:203], v5 offset:2048
    ds_read_b128 v[216:219], v5 offset:6144
    ds_read_b128 v[204:207], v5 offset:3072
    ds_read_b128 v[220:223], v5 offset:7168
    s_waitcnt lgkmcnt(6)
    v_pk_add_f32 v[160:161], v[160:161], v[192:193]
    v_pk_add_f32 v[162:163], v[162:163], v[194:195]
    v_pk_add_f32 v[176:177], v[176:177], v[208:209]
    v_pk_add_f32 v[178:179], v[178:179], v[210:211]
    v_pk_mul_f32 v[160:161], v[160:161], s[42:43]
    v_pk_mul_f32 v[162:163], v[162:163], s[42:43]
    v_pk_mul_f32 v[176:177], v[176:177], s[42:43]
    v_pk_mul_f32 v[178:179], v[178:179], s[42:43]
    v_cvt_pk_bf16_f32 v24, v160, v161
    v_cvt_pk_bf16_f32 v25, v162, v163
    v_cvt_pk_bf16_f32 v26, v176, v177
    v_cvt_pk_bf16_f32 v27, v178, v179
    buffer_store_dwordx4 v[24:27], v8, s[24:27], s41 offen offset:0 sc1
    s_waitcnt lgkmcnt(4)
    v_pk_add_f32 v[164:165], v[164:165], v[196:197]
    v_pk_add_f32 v[166:167], v[166:167], v[198:199]
    v_pk_add_f32 v[180:181], v[180:181], v[212:213]
    v_pk_add_f32 v[182:183], v[182:183], v[214:215]
    v_pk_mul_f32 v[164:165], v[164:165], s[42:43]
    v_pk_mul_f32 v[166:167], v[166:167], s[42:43]
    v_pk_mul_f32 v[180:181], v[180:181], s[42:43]
    v_pk_mul_f32 v[182:183], v[182:183], s[42:43]
    v_cvt_pk_bf16_f32 v28, v164, v165
    v_cvt_pk_bf16_f32 v29, v166, v167
    v_cvt_pk_bf16_f32 v30, v180, v181
    v_cvt_pk_bf16_f32 v31, v182, v183
    buffer_store_dwordx4 v[28:31], v8, s[24:27], s41 offen offset:256 sc1
    s_waitcnt lgkmcnt(2)
    v_pk_add_f32 v[168:169], v[168:169], v[200:201]
    v_pk_add_f32 v[170:171], v[170:171], v[202:203]
    v_pk_add_f32 v[184:185], v[184:185], v[216:217]
    v_pk_add_f32 v[186:187], v[186:187], v[218:219]
    v_pk_mul_f32 v[168:169], v[168:169], s[42:43]
    v_pk_mul_f32 v[170:171], v[170:171], s[42:43]
    v_pk_mul_f32 v[184:185], v[184:185], s[42:43]
    v_pk_mul_f32 v[186:187], v[186:187], s[42:43]
    v_cvt_pk_bf16_f32 v32, v168, v169
    v_cvt_pk_bf16_f32 v33, v170, v171
    v_cvt_pk_bf16_f32 v34, v184, v185
    v_cvt_pk_bf16_f32 v35, v186, v187
    buffer_store_dwordx4 v[32:35], v8, s[24:27], s41 offen offset:2048 sc1
    s_waitcnt lgkmcnt(0)
    v_pk_add_f32 v[172:173], v[172:173], v[204:205]
    v_pk_add_f32 v[174:175], v[174:175], v[206:207]
    v_pk_add_f32 v[188:189], v[188:189], v[220:221]
    v_pk_add_f32 v[190:191], v[190:191], v[222:223]
    v_pk_mul_f32 v[172:173], v[172:173], s[42:43]
    v_pk_mul_f32 v[174:175], v[174:175], s[42:43]
    v_pk_mul_f32 v[188:189], v[188:189], s[42:43]
    v_pk_mul_f32 v[190:191], v[190:191], s[42:43]
    v_cvt_pk_bf16_f32 v36, v172, v173
    v_cvt_pk_bf16_f32 v37, v174, v175
    v_cvt_pk_bf16_f32 v38, v188, v189
    v_cvt_pk_bf16_f32 v39, v190, v191
    buffer_store_dwordx4 v[36:39], v8, s[24:27], s41 offen offset:2304 sc1
    s_cmp_eq_u32 s46, 0
    s_cbranch_scc1 K2_SIDE
    s_add_u32 s41, s47, s39
    s_lshl_b32 s41, s41, 12
    s_add_u32 s41, s41, 0x80000
    s_and_b32 s44, s37, 1
    s_lshl_b32 s45, s40, 12
    s_lshl_b32 s54, s39, 11
    s_add_u32 s45, s45, s54
    s_add_u32 s45, s45, 32768
    s_cmp_ge_u32 s37, 8
    s_cbranch_scc1 K2_EXTV
    v_lshlrev_b32 v7, 6, v6
    v_lshl_add_u32 v7, v23, 4, v7
    v_add_u32 v7, s45, v7
    ds_read_b128 v[48:51], v7 offset:0
    ds_read_b128 v[52:55], v7 offset:1024
    ds_read_b128 v[56:59], v7 offset:8192
    ds_read_b128 v[60:63], v7 offset:9216
    v_lshrrev_b32 v9, 3, v6
    v_and_b32 v10, 7, v6
    v_lshl_add_u32 v9, v9, 4, v10
    v_lshlrev_b32 v9, 4, v9
    v_lshl_add_u32 v9, v23, 9, v9
    s_lshl_b32 s44, s44, 3
    s_add_u32 s41, s41, s44
    s_waitcnt lgkmcnt(0)
    v_pk_add_f32 v[48:49], v[48:49], v[56:57]
    v_pk_add_f32 v[50:51], v[50:51], v[58:59]
    v_pk_add_f32 v[52:53], v[52:53], v[60:61]
    v_pk_add_f32 v[54:55], v[54:55], v[62:63]
    v_cvt_pk_bf16_f32 v64, v48, v49
    v_cvt_pk_bf16_f32 v65, v50, v51
    v_cvt_pk_bf16_f32 v66, v52, v53
    v_cvt_pk_bf16_f32 v67, v54, v55
    buffer_store_dwordx2 v[64:65], v9, s[24:27], s41 offen offset:0 sc1
    buffer_store_dwordx2 v[66:67], v9, s[24:27], s41 offen offset:128 sc1
    s_branch K2_SIDE
K2_EXTV:
    v_lshlrev_b32 v9, 8, v23
    v_lshl_add_u32 v9, v6, 2, v9
    v_add_u32 v9, s45, v9
    ds_read_b32 v48, v9 offset:0
    ds_read_b32 v49, v9 offset:64
    ds_read_b32 v50, v9 offset:128
    ds_read_b32 v51, v9 offset:192
    ds_read_b32 v52, v9 offset:1024
    ds_read_b32 v53, v9 offset:1088
    ds_read_b32 v54, v9 offset:1152
    ds_read_b32 v55, v9 offset:1216
    ds_read_b32 v56, v9 offset:8192
    ds_read_b32 v57, v9 offset:8256
    ds_read_b32 v58, v9 offset:8320
    ds_read_b32 v59, v9 offset:8384
    ds_read_b32 v60, v9 offset:9216
    ds_read_b32 v61, v9 offset:9280
    ds_read_b32 v62, v9 offset:9344
    ds_read_b32 v63, v9 offset:9408
    s_lshl_b32 s44, s44, 8
    s_add_u32 s41, s41, s44
    s_waitcnt lgkmcnt(0)
    v_pk_add_f32 v[48:49], v[48:49], v[56:57]
    v_pk_add_f32 v[50:51], v[50:51], v[58:59]
    v_pk_add_f32 v[52:53], v[52:53], v[60:61]
    v_pk_add_f32 v[54:55], v[54:55], v[62:63]
    v_cvt_pk_bf16_f32 v64, v48, v49
    v_cvt_pk_bf16_f32 v65, v50, v51
    v_cvt_pk_bf16_f32 v66, v52, v53
    v_cvt_pk_bf16_f32 v67, v54, v55
    buffer_store_dwordx4 v[64:67], v8, s[24:27], s41 offen offset:2048 sc1
K2_SIDE:
K2_END:
    s_endpgm
.text
.globl k3_attn_kernel
.p2align 8
.type k3_attn_kernel,@function
k3_attn_kernel:
    s_cmp_ge_u32 s2, 256
    s_cbranch_scc1 K3_END
    s_load_dwordx2 s[10:11], s[0:1], 96
    s_load_dwordx4 s[4:7], s[0:1], 48
    s_load_dwordx2 s[8:9], s[0:1], 32
    s_load_dwordx2 s[46:47], s[0:1], 72
    s_load_dwordx2 s[50:51], s[0:1], 0
    v_and_b32 v1, 63, v0
    v_lshrrev_b32 v3, 6, v0
    v_lshlrev_b32 v2, 4, v1
    v_readfirstlane_b32 s36, v3
    s_lshr_b32 s39, s2, 3
    s_and_b32 s45, s2, 7
    s_lshl_b32 s40, s45, 3
    s_lshl_b32 s45, s36, 1
    s_add_u32 s40, s40, s45
    s_lshl_b32 s45, s39, 6
    s_add_u32 s45, s45, s40
    s_lshl_b32 s45, s45, 11
    s_add_u32 s45, s45, 0x500000
    s_mov_b32 s42, 0
    s_lshr_b32 s48, s2, 6
    s_lshl_b32 s48, s48, 2
    s_add_u32 s48, s48, s36
    s_lshl_b32 s49, s48, 7
    s_add_u32 s49, s49, 98304
    v_lshrrev_b32 v4, 4, v1
    v_lshlrev_b32 v5, 3, v4
    s_waitcnt lgkmcnt(0)
    s_mov_b32 s24, s10
    s_and_b32 s25, s11, 0xffff
    s_mov_b32 s26, 0x3400000
    s_mov_b32 s27, 0x20000
    s_add_u32 s28, s10, 0x80000
    s_addc_u32 s29, s11, 0
    s_and_b32 s29, s29, 0xffff
    s_mov_b32 s30, 0x40000
    s_mov_b32 s31, 0x20000
    buffer_load_dwordx4 a[0:3], v2, s[28:31], 0 offen
    buffer_load_dwordx4 a[4:7], v2, s[28:31], 0 offen offset:1024
    buffer_load_dwordx4 v[12:15], v2, s[24:27], s45 offen offset:0
    buffer_load_dwordx4 v[16:19], v2, s[24:27], s45 offen offset:1024
    buffer_load_dwordx4 v[20:23], v2, s[24:27], s45 offen offset:2048
    buffer_load_dwordx4 v[24:27], v2, s[24:27], s45 offen offset:3072
    s_lshl_b32 s38, s36, 10
    s_cmp_lt_u32 s36, 2
    s_cselect_b32 s41, 4096, 0
    s_add_u32 s41, s41, s38
    s_mov_b32 m0, s38
    s_xor_b32 s38, s38, 0x8000
    buffer_load_dwordx4 v2, s[28:31], s41 offen lds
    s_add_u32 m0, m0, 4096
    s_add_u32 s41, s41, 4096
    buffer_load_dwordx4 v2, s[28:31], s41 offen lds
    s_add_u32 m0, m0, 4096
    s_add_u32 s41, s41, 4096
    buffer_load_dwordx4 v2, s[28:31], s41 offen lds
    s_add_u32 m0, m0, 4096
    s_add_u32 s41, s41, 4096
    buffer_load_dwordx4 v2, s[28:31], s41 offen lds
    s_add_u32 m0, m0, 4096
    s_add_u32 s41, s41, 4096
    buffer_load_dwordx4 v2, s[28:31], s41 offen lds
    s_add_u32 m0, m0, 4096
    s_add_u32 s41, s41, 4096
    buffer_load_dwordx4 v2, s[28:31], s41 offen lds
    s_add_u32 m0, m0, 4096
    s_add_u32 s41, s41, 4096
    buffer_load_dwordx4 v2, s[28:31], s41 offen lds
    s_add_u32 m0, m0, 4096
    s_add_u32 s41, s41, 4096
    buffer_load_dwordx4 v2, s[28:31], s41 offen lds
    s_add_u32 m0, m0, 4096
    s_add_u32 s41, s41, 4096
    s_mov_b32 s45, s49
    s_mov_b32 s16, s46
    s_and_b32 s17, s47, 0xffff
    s_mov_b32 s18, 0xc00000
    s_mov_b32 s19, 0x20000
    s_mov_b32 s12, s8
    s_and_b32 s13, s9, 0xffff
    s_mov_b32 s14, 0x200000
    s_mov_b32 s15, 0x20000
    s_mov_b32 s32, s10
    s_and_b32 s33, s11, 0xffff
    s_mov_b32 s34, 0x3400000
    s_mov_b32 s35, 0x20000
    s_lshl_b32 s57, s2, 2
    s_add_u32 s57, s57, s36
    s_mov_b32 s23, 0x20000
    s_cmp_lt_u32 s57, 512
    s_cbranch_scc0 K3_RW2
    s_mov_b32 s20, s4
    s_and_b32 s21, s5, 0xffff
    s_mov_b32 s22, 7340032
    s_lshr_b32 s58, s57, 4
    s_and_b32 s59, s57, 15
    s_mul_i32 s52, s59, 458752
    s_mul_i32 s60, s58, 224
    s_add_u32 s52, s52, s60
    s_mul_i32 s53, s57, 14336
    s_add_u32 s53, s53, 0x2400000
    s_mov_b32 s54, 57344
    s_movk_i32 s55, 1792
    s_movk_i32 s61, 1792
    s_mov_b32 s62, 0
    v_mul_u32_u24 v8, 4682, v1
    v_lshrrev_b32 v8, 16, v8
    v_mul_u32_u24 v9, 14, v8
    v_sub_u32 v9, v1, v9
    v_mul_u32_u24 v8, 7168, v8
    v_lshl_add_u32 v8, v9, 4, v8
    v_cmp_lt_u32 vcc, 55, v1
    v_mov_b32 v9, 0x7f000000
    s_nop 0
    v_cndmask_b32 v3, v8, v9, vcc
    v_cndmask_b32 v6, v2, v9, vcc
    v_add_u32 v153, 28672, v3
    v_add_u32 v154, 896, v6
    s_branch K3_RDONE
K3_RW2:
    s_mov_b32 s20, s6
    s_and_b32 s21, s7, 0xffff
    s_mov_b32 s22, 7340032
    s_sub_u32 s57, s57, 512
    s_lshr_b32 s58, s57, 6
    s_and_b32 s59, s57, 63
    s_mul_i32 s52, s59, 114688
    s_lshl_b32 s60, s58, 8
    s_add_u32 s52, s52, s60
    s_mul_i32 s53, s58, 917504
    s_lshr_b32 s60, s59, 5
    s_mul_i32 s60, s60, 458752
    s_add_u32 s53, s53, s60
    s_bfe_u32 s58, s59, 0x40001
    s_mul_i32 s60, s58, 24576
    s_add_u32 s53, s53, s60
    s_and_b32 s59, s59, 1
    s_mul_i32 s60, s59, 14336
    s_add_u32 s53, s53, s60
    s_add_u32 s53, s53, 0x2c00000
    s_mul_i32 s60, s58, 20480
    s_sub_u32 s61, 370688, s60
    s_cmp_eq_u32 s59, 0
    s_cselect_b32 s61, 2048, s61
    s_movk_i32 s54, 16384
    s_movk_i32 s55, 2048
    s_mov_b32 s62, 1
    v_lshlrev_b32 v8, 11, v4
    v_lshlrev_b32 v9, 1, v4
    v_and_b32 v10, 15, v1
    v_xor_b32 v9, v9, v10
    v_lshl_add_u32 v3, v9, 4, v8
    v_xor_b32 v153, 128, v3
    v_add_u32 v153, 8192, v153
    v_mov_b32 v6, v2
    v_add_u32 v154, 1024, v2
K3_RDONE:
    s_mul_i32 s63, s48, 786432
    s_and_b32 s49, s2, 63
    s_lshl_b32 s49, s49, 7
    s_add_u32 s63, s63, s49
    s_add_u32 s63, s63, 4096
    s_lshl_b32 s44, s36, 13
    s_add_u32 s44, s44, 131072
    v_lshrrev_b32 v9, 3, v1
    v_lshlrev_b32 v8, 1, v4
    v_and_b32 v10, 7, v1
    v_xor_b32 v8, v8, v10
    v_lshlrev_b32 v8, 4, v8
    v_mul_u32_u24 v10, 12288, v9
    v_add_u32 v155, v10, v8
    v_lshl_add_u32 v9, v9, 11, v8
    s_bfe_u32 s49, s2, 0x30003
    s_lshl_b32 s49, s49, 1
    s_and_b32 s57, s2, 1
    s_add_u32 s49, s49, s57
    s_lshl_b32 s49, s49, 7
    v_add_u32 v248, s49, v9
    v_add_u32 v249, 15360, v248
    v_add_u32 v250, 30720, v248
    v_add_u32 v251, 46080, v248
    s_lshl_b32 s56, s36, 18
    s_lshl_b32 s37, s36, 14
    s_add_u32 s37, s37, 65536
    s_lshl_b32 s49, s39, 2
    s_add_u32 s49, s49, s36
    s_lshl_b32 s58, s49, 13
    s_add_u32 s58, s58, 0x100000
    s_lshl_b32 s57, s57, 7
    s_add_u32 s58, s58, s57
    v_and_b32 v177, 3, v1
    v_lshlrev_b32 v177, 8, v177
    v_add_u32 v176, 4096, v2
    s_mov_b32 s60, 0x30000
    s_mov_b32 m0, s44
    buffer_load_dwordx4 v[156:159], v3, s[20:23], s52 offen sc1 nt
    buffer_load_dwordx4 v[160:163], v153, s[20:23], s52 offen sc1 nt
    buffer_load_dwordx4 v155, s[16:19], s63 offen sc1 nt lds
    buffer_load_dword v164, v177, s[12:15], s58 offen sc1
    buffer_load_dwordx2 v[168:169], v5, s[24:27], s45 offen offset:0
    buffer_load_dwordx2 v[170:171], v5, s[24:27], s45 offen offset:32
    buffer_load_dwordx2 v[172:173], v5, s[24:27], s45 offen offset:64
    buffer_load_dwordx2 v[174:175], v5, s[24:27], s45 offen offset:96
    s_add_u32 s52, s52, s54
    s_add_u32 s63, s63, 98304
    v_and_b32 v9, 6, v1
    v_mov_b32 v8, 0x3f803f80
    v_cmp_eq_u32 vcc, 0, v9
    v_mov_b32 v10, 0xeeee
    v_mov_b32 v11, 0x4444
    v_cndmask_b32 v148, 0, v8, vcc
    v_cndmask_b32 v149, 0, v8, vcc
    v_cmp_eq_u32 vcc, 4, v9
    v_and_b32 v9, 1, v1
    s_nop 0
    v_cndmask_b32 v150, 0, v8, vcc
    v_cndmask_b32 v151, 0, v8, vcc
    v_cmp_eq_u32 vcc, 0, v9
    s_nop 1
    v_cndmask_b32 v152, v10, v11, vcc
    v_mov_b64 v[60:61], 0
    v_mov_b64 v[62:63], 0
    v_mov_b64 v[64:65], 0
    v_mov_b64 v[66:67], 0
    v_mov_b64 v[68:69], 0
    v_mov_b64 v[70:71], 0
    v_mov_b64 v[72:73], 0
    v_mov_b64 v[74:75], 0
    v_mov_b64 v[76:77], 0
    v_mov_b64 v[78:79], 0
    v_mov_b64 v[80:81], 0
    v_mov_b64 v[82:83], 0
    v_mov_b64 v[84:85], 0
    v_mov_b64 v[86:87], 0
    v_mov_b64 v[88:89], 0
    v_mov_b64 v[90:91], 0
    v_mov_b64 v[92:93], 0
    v_mov_b64 v[94:95], 0
    v_mov_b64 v[96:97], 0
    v_mov_b64 v[98:99], 0
    v_accvgpr_write_b32 a8, 0
    v_accvgpr_write_b32 a9, 0
    v_accvgpr_write_b32 a10, 0
    v_accvgpr_write_b32 a11, 0
    v_accvgpr_write_b32 a12, 0
    v_accvgpr_write_b32 a13, 0
    v_accvgpr_write_b32 a14, 0
    v_accvgpr_write_b32 a15, 0
    v_mov_b64 v[140:141], 0
    v_mov_b64 v[142:143], 0
    v_mov_b64 v[144:145], 0
    v_mov_b64 v[146:147], 0
    v_mov_b32 v7, v2
    s_waitcnt vmcnt(16)
    v_mfma_f32_32x32x16_bf16 v[100:115], a[0:3], v[12:15], 0
    v_mfma_f32_32x32x16_bf16 v[100:115], a[4:7], v[16:19], v[100:115]
    v_mfma_f32_32x32x16_bf16 v[116:131], a[0:3], v[20:23], 0
    v_mfma_f32_32x32x16_bf16 v[116:131], a[4:7], v[24:27], v[116:131]
    s_nop 9
    v_max3_f32 v8, v100, v101, v102
    v_max_f32 v8, v8, v103
    v_max3_f32 v8, v8, v104, v105
    v_max3_f32 v8, v8, v106, v107
    v_max3_f32 v8, v8, v108, v109
    v_max3_f32 v8, v8, v110, v111
    v_max3_f32 v8, v8, v112, v113
    v_max3_f32 v8, v8, v114, v115
    v_max3_f32 v9, v116, v117, v118
    v_max_f32 v9, v9, v119
    v_max3_f32 v9, v9, v120, v121
    v_max3_f32 v9, v9, v122, v123
    v_max3_f32 v9, v9, v124, v125
    v_max3_f32 v9, v9, v126, v127
    v_max3_f32 v9, v9, v128, v129
    v_max3_f32 v9, v9, v130, v131
K3_SETMAX:
    v_mov_b32 v10, v8
    v_mov_b32 v11, v9
    s_nop 1
    v_permlane32_swap_b32 v8, v10
    v_permlane32_swap_b32 v9, v11
    v_max_f32 v8, v8, v10
    v_max_f32 v9, v9, v11
    v_sub_f32 v28, 0, v8
    v_sub_f32 v29, 0, v8
    v_mov_b64 v[30:31], v[28:29]
    v_mov_b64 v[32:33], v[28:29]
    v_mov_b64 v[34:35], v[28:29]
    v_mov_b64 v[36:37], v[28:29]
    v_mov_b64 v[38:39], v[28:29]
    v_mov_b64 v[40:41], v[28:29]
    v_mov_b64 v[42:43], v[28:29]
    s_mov_b32 s43, 8
    s_nop 0
    v_mfma_f32_32x32x16_bf16 v[100:115], a[0:3], v[12:15], v[28:43]
    v_mfma_f32_32x32x16_bf16 v[100:115], a[4:7], v[16:19], v[100:115]
    v_sub_f32 v44, 0, v9
    v_sub_f32 v45, 0, v9
    v_mov_b64 v[46:47], v[44:45]
    v_mov_b64 v[48:49], v[44:45]
    v_mov_b64 v[50:51], v[44:45]
    v_mov_b64 v[52:53], v[44:45]
    v_mov_b64 v[54:55], v[44:45]
    v_mov_b64 v[56:57], v[44:45]
    v_mov_b64 v[58:59], v[44:45]
    s_nop 1
    .p2align 6
K3_LOOP:
    v_mfma_f32_32x32x16_bf16 v[116:131], a[0:3], v[20:23], v[44:59]
    s_waitcnt vmcnt(8)
    s_barrier
    v_exp_f32 v100, v100
    v_exp_f32 v101, v101
    v_exp_f32 v102, v102
    v_cvt_pk_bf16_f32 v132, v100, v101
    v_exp_f32 v103, v103
    v_mfma_f32_32x32x16_bf16 v[116:131], a[4:7], v[24:27], v[116:131]
    ds_read_b128 a[0:3], v7 offset:0
    v_exp_f32 v104, v104
    v_cvt_pk_bf16_f32 v133, v102, v103
    v_exp_f32 v105, v105
    v_exp_f32 v106, v106
    v_cvt_pk_bf16_f32 v134, v104, v105
    v_mfma_f32_32x32x16_bf16 v[76:91], a[8:11], v[140:143], v[76:91]
    ds_read_b128 a[4:7], v7 offset:1024
    v_exp_f32 v107, v107
    v_exp_f32 v108, v108
    v_cvt_pk_bf16_f32 v135, v106, v107
    v_exp_f32 v109, v109
    v_mfma_f32_32x32x16_bf16 v[76:91], a[12:15], v[144:147], v[76:91]
    ds_read_b128 a[8:11], v7 offset:2048
    v_exp_f32 v110, v110
    v_cvt_pk_bf16_f32 v136, v108, v109
    v_exp_f32 v111, v111
    v_exp_f32 v112, v112
    v_cvt_pk_bf16_f32 v137, v110, v111
    v_smfmac_f32_16x16x64_bf16 v[96:99], v[148:151], v[140:147], v152
    s_waitcnt lgkmcnt(1)
    ds_read_b128 a[12:15], v7 offset:3072
    v_exp_f32 v113, v113
    v_exp_f32 v114, v114
    v_exp_f32 v115, v115
    v_cvt_pk_bf16_f32 v138, v112, v113
    v_cvt_pk_bf16_f32 v139, v114, v115
    v_mfma_f32_32x32x16_bf16 v[100:115], a[0:3], v[12:15], v[28:43]
    s_add_u32 m0, s38, 0
    v_exp_f32 v116, v116
    v_exp_f32 v117, v117
    v_exp_f32 v118, v118
    v_cvt_pk_bf16_f32 v140, v116, v117
    v_exp_f32 v119, v119
    v_mfma_f32_32x32x16_bf16 v[100:115], a[4:7], v[16:19], v[100:115]
    s_waitcnt lgkmcnt(0)
    v_exp_f32 v120, v120
    v_cvt_pk_bf16_f32 v141, v118, v119
    v_exp_f32 v121, v121
    v_exp_f32 v122, v122
    v_cvt_pk_bf16_f32 v142, v120, v121
    v_mfma_f32_32x32x16_bf16 v[60:75], a[8:11], v[132:135], v[60:75]
    buffer_load_dwordx4 v2, s[28:31], s41 offen lds
    s_add_u32 m0, m0, 4096
    v_exp_f32 v123, v123
    v_exp_f32 v124, v124
    v_cvt_pk_bf16_f32 v143, v122, v123
    v_exp_f32 v125, v125
    v_mfma_f32_32x32x16_bf16 v[60:75], a[12:15], v[136:139], v[60:75]
    buffer_load_dwordx4 v176, s[28:31], s41 offen lds
    v_exp_f32 v126, v126
    v_cvt_pk_bf16_f32 v144, v124, v125
    v_exp_f32 v127, v127
    v_exp_f32 v128, v128
    v_cvt_pk_bf16_f32 v145, v126, v127
    v_smfmac_f32_16x16x64_bf16 v[92:95], v[148:151], v[132:139], v152
    s_add_u32 s41, s41, 8192
    v_exp_f32 v129, v129
    v_exp_f32 v130, v130
    v_exp_f32 v131, v131
    v_cvt_pk_bf16_f32 v146, v128, v129
    v_cvt_pk_bf16_f32 v147, v130, v131
    v_mfma_f32_32x32x16_bf16 v[116:131], a[0:3], v[20:23], v[44:59]
    s_add_u32 s44, s44, 1024
    v_exp_f32 v100, v100
    v_exp_f32 v101, v101
    v_exp_f32 v102, v102
    v_cvt_pk_bf16_f32 v132, v100, v101
    v_exp_f32 v103, v103
    v_mfma_f32_32x32x16_bf16 v[116:131], a[4:7], v[24:27], v[116:131]
    ds_read_b128 a[0:3], v7 offset:4096
    v_exp_f32 v104, v104
    v_cvt_pk_bf16_f32 v133, v102, v103
    v_exp_f32 v105, v105
    v_exp_f32 v106, v106
    v_cvt_pk_bf16_f32 v134, v104, v105
    v_mfma_f32_32x32x16_bf16 v[76:91], a[8:11], v[140:143], v[76:91]
    ds_read_b128 a[4:7], v7 offset:5120
    v_exp_f32 v107, v107
    v_exp_f32 v108, v108
    v_cvt_pk_bf16_f32 v135, v106, v107
    v_exp_f32 v109, v109
    v_mfma_f32_32x32x16_bf16 v[76:91], a[12:15], v[144:147], v[76:91]
    ds_read_b128 a[8:11], v7 offset:6144
    v_exp_f32 v110, v110
    v_cvt_pk_bf16_f32 v136, v108, v109
    v_exp_f32 v111, v111
    v_exp_f32 v112, v112
    v_cvt_pk_bf16_f32 v137, v110, v111
    v_smfmac_f32_16x16x64_bf16 v[96:99], v[148:151], v[140:147], v152
    s_waitcnt lgkmcnt(1)
    ds_read_b128 a[12:15], v7 offset:7168
    v_exp_f32 v113, v113
    v_exp_f32 v114, v114
    v_exp_f32 v115, v115
    v_cvt_pk_bf16_f32 v138, v112, v113
    v_cvt_pk_bf16_f32 v139, v114, v115
    v_mfma_f32_32x32x16_bf16 v[100:115], a[0:3], v[12:15], v[28:43]
    s_add_u32 m0, s38, 8192
    v_exp_f32 v116, v116
    v_exp_f32 v117, v117
    v_exp_f32 v118, v118
    v_cvt_pk_bf16_f32 v140, v116, v117
    v_exp_f32 v119, v119
    v_mfma_f32_32x32x16_bf16 v[100:115], a[4:7], v[16:19], v[100:115]
    s_waitcnt lgkmcnt(0)
    v_exp_f32 v120, v120
    v_cvt_pk_bf16_f32 v141, v118, v119
    v_exp_f32 v121, v121
    v_exp_f32 v122, v122
    v_cvt_pk_bf16_f32 v142, v120, v121
    v_mfma_f32_32x32x16_bf16 v[60:75], a[8:11], v[132:135], v[60:75]
    buffer_load_dwordx4 v2, s[28:31], s41 offen lds
    s_add_u32 m0, m0, 4096
    v_exp_f32 v123, v123
    v_exp_f32 v124, v124
    v_cvt_pk_bf16_f32 v143, v122, v123
    v_exp_f32 v125, v125
    v_mfma_f32_32x32x16_bf16 v[60:75], a[12:15], v[136:139], v[60:75]
    buffer_load_dwordx4 v176, s[28:31], s41 offen lds
    v_exp_f32 v126, v126
    v_cvt_pk_bf16_f32 v144, v124, v125
    v_exp_f32 v127, v127
    v_exp_f32 v128, v128
    v_cvt_pk_bf16_f32 v145, v126, v127
    v_smfmac_f32_16x16x64_bf16 v[92:95], v[148:151], v[132:139], v152
    s_add_u32 s41, s41, 8192
    v_exp_f32 v129, v129
    v_exp_f32 v130, v130
    v_exp_f32 v131, v131
    v_cvt_pk_bf16_f32 v146, v128, v129
    v_cvt_pk_bf16_f32 v147, v130, v131
    v_mfma_f32_32x32x16_bf16 v[116:131], a[0:3], v[20:23], v[44:59]
    s_add_u32 s58, s58, 1024
    v_exp_f32 v100, v100
    v_exp_f32 v101, v101
    v_exp_f32 v102, v102
    v_cvt_pk_bf16_f32 v132, v100, v101
    v_exp_f32 v103, v103
    v_mfma_f32_32x32x16_bf16 v[116:131], a[4:7], v[24:27], v[116:131]
    ds_read_b128 a[0:3], v7 offset:8192
    v_exp_f32 v104, v104
    v_cvt_pk_bf16_f32 v133, v102, v103
    v_exp_f32 v105, v105
    v_exp_f32 v106, v106
    v_cvt_pk_bf16_f32 v134, v104, v105
    v_mfma_f32_32x32x16_bf16 v[76:91], a[8:11], v[140:143], v[76:91]
    ds_read_b128 a[4:7], v7 offset:9216
    v_exp_f32 v107, v107
    v_exp_f32 v108, v108
    v_cvt_pk_bf16_f32 v135, v106, v107
    v_exp_f32 v109, v109
    v_mfma_f32_32x32x16_bf16 v[76:91], a[12:15], v[144:147], v[76:91]
    ds_read_b128 a[8:11], v7 offset:10240
    v_exp_f32 v110, v110
    v_cvt_pk_bf16_f32 v136, v108, v109
    v_exp_f32 v111, v111
    v_exp_f32 v112, v112
    v_cvt_pk_bf16_f32 v137, v110, v111
    v_smfmac_f32_16x16x64_bf16 v[96:99], v[148:151], v[140:147], v152
    s_waitcnt lgkmcnt(1)
    ds_read_b128 a[12:15], v7 offset:11264
    v_exp_f32 v113, v113
    v_exp_f32 v114, v114
    v_exp_f32 v115, v115
    v_cvt_pk_bf16_f32 v138, v112, v113
    v_cvt_pk_bf16_f32 v139, v114, v115
    v_mfma_f32_32x32x16_bf16 v[100:115], a[0:3], v[12:15], v[28:43]
    s_add_u32 m0, s38, 16384
    v_exp_f32 v116, v116
    v_exp_f32 v117, v117
    v_exp_f32 v118, v118
    v_cvt_pk_bf16_f32 v140, v116, v117
    v_exp_f32 v119, v119
    v_mfma_f32_32x32x16_bf16 v[100:115], a[4:7], v[16:19], v[100:115]
    s_waitcnt lgkmcnt(0)
    v_exp_f32 v120, v120
    v_cvt_pk_bf16_f32 v141, v118, v119
    v_exp_f32 v121, v121
    v_exp_f32 v122, v122
    v_cvt_pk_bf16_f32 v142, v120, v121
    v_mfma_f32_32x32x16_bf16 v[60:75], a[8:11], v[132:135], v[60:75]
    buffer_load_dwordx4 v2, s[28:31], s41 offen lds
    s_add_u32 m0, m0, 4096
    v_exp_f32 v123, v123
    v_exp_f32 v124, v124
    v_cvt_pk_bf16_f32 v143, v122, v123
    v_exp_f32 v125, v125
    v_mfma_f32_32x32x16_bf16 v[60:75], a[12:15], v[136:139], v[60:75]
    buffer_load_dwordx4 v176, s[28:31], s41 offen lds
    v_exp_f32 v126, v126
    v_cvt_pk_bf16_f32 v144, v124, v125
    v_exp_f32 v127, v127
    v_exp_f32 v128, v128
    v_cvt_pk_bf16_f32 v145, v126, v127
    v_smfmac_f32_16x16x64_bf16 v[92:95], v[148:151], v[132:139], v152
    s_add_u32 s41, s41, 8192
    v_exp_f32 v129, v129
    v_exp_f32 v130, v130
    v_exp_f32 v131, v131
    v_cvt_pk_bf16_f32 v146, v128, v129
    v_cvt_pk_bf16_f32 v147, v130, v131
    v_mfma_f32_32x32x16_bf16 v[116:131], a[0:3], v[20:23], v[44:59]
    s_cmp_eq_u32 s43, 4
    v_exp_f32 v100, v100
    v_exp_f32 v101, v101
    v_exp_f32 v102, v102
    v_cvt_pk_bf16_f32 v132, v100, v101
    v_exp_f32 v103, v103
    v_mfma_f32_32x32x16_bf16 v[116:131], a[4:7], v[24:27], v[116:131]
    s_cselect_b32 s57, s61, s55
    ds_read_b128 a[0:3], v7 offset:12288
    v_exp_f32 v104, v104
    v_cvt_pk_bf16_f32 v133, v102, v103
    v_exp_f32 v105, v105
    v_exp_f32 v106, v106
    v_cvt_pk_bf16_f32 v134, v104, v105
    v_mfma_f32_32x32x16_bf16 v[76:91], a[8:11], v[140:143], v[76:91]
    ds_read_b128 a[4:7], v7 offset:13312
    v_exp_f32 v107, v107
    v_exp_f32 v108, v108
    v_cvt_pk_bf16_f32 v135, v106, v107
    v_exp_f32 v109, v109
    v_mfma_f32_32x32x16_bf16 v[76:91], a[12:15], v[144:147], v[76:91]
    ds_read_b128 a[8:11], v7 offset:14336
    v_exp_f32 v110, v110
    v_cvt_pk_bf16_f32 v136, v108, v109
    v_exp_f32 v111, v111
    v_exp_f32 v112, v112
    v_cvt_pk_bf16_f32 v137, v110, v111
    v_smfmac_f32_16x16x64_bf16 v[96:99], v[148:151], v[140:147], v152
    s_waitcnt lgkmcnt(1)
    ds_read_b128 a[12:15], v7 offset:15360
    v_exp_f32 v113, v113
    v_exp_f32 v114, v114
    v_exp_f32 v115, v115
    v_cvt_pk_bf16_f32 v138, v112, v113
    v_cvt_pk_bf16_f32 v139, v114, v115
    v_mfma_f32_32x32x16_bf16 v[100:115], a[0:3], v[12:15], v[28:43]
    s_add_u32 m0, s38, 24576
    v_exp_f32 v116, v116
    v_exp_f32 v117, v117
    v_exp_f32 v118, v118
    v_cvt_pk_bf16_f32 v140, v116, v117
    v_exp_f32 v119, v119
    v_mfma_f32_32x32x16_bf16 v[100:115], a[4:7], v[16:19], v[100:115]
    s_waitcnt lgkmcnt(0)
    v_exp_f32 v120, v120
    v_cvt_pk_bf16_f32 v141, v118, v119
    v_exp_f32 v121, v121
    v_exp_f32 v122, v122
    v_cvt_pk_bf16_f32 v142, v120, v121
    v_mfma_f32_32x32x16_bf16 v[60:75], a[8:11], v[132:135], v[60:75]
    buffer_load_dwordx4 v2, s[28:31], s41 offen lds
    s_add_u32 m0, m0, 4096
    v_exp_f32 v123, v123
    v_exp_f32 v124, v124
    v_cvt_pk_bf16_f32 v143, v122, v123
    v_exp_f32 v125, v125
    v_mfma_f32_32x32x16_bf16 v[60:75], a[12:15], v[136:139], v[60:75]
    buffer_load_dwordx4 v176, s[28:31], s41 offen lds
    v_exp_f32 v126, v126
    v_cvt_pk_bf16_f32 v144, v124, v125
    v_exp_f32 v127, v127
    v_exp_f32 v128, v128
    v_cvt_pk_bf16_f32 v145, v126, v127
    v_smfmac_f32_16x16x64_bf16 v[92:95], v[148:151], v[132:139], v152
    s_add_u32 s41, s41, 8192
    v_exp_f32 v129, v129
    v_exp_f32 v130, v130
    v_exp_f32 v131, v131
    v_cvt_pk_bf16_f32 v146, v128, v129
    v_cvt_pk_bf16_f32 v147, v130, v131
    v_mfma_f32_32x32x16_bf16 v[116:131], a[0:3], v[20:23], v[44:59]
    s_cmp_gt_u32 s43, s62
    v_exp_f32 v100, v100
    v_exp_f32 v101, v101
    v_exp_f32 v102, v102
    v_cvt_pk_bf16_f32 v132, v100, v101
    v_exp_f32 v103, v103
    v_mfma_f32_32x32x16_bf16 v[116:131], a[4:7], v[24:27], v[116:131]
    s_cselect_b32 s34, s34, 0
    ds_read_b128 a[0:3], v7 offset:16384
    v_exp_f32 v104, v104
    v_cvt_pk_bf16_f32 v133, v102, v103
    v_exp_f32 v105, v105
    v_exp_f32 v106, v106
    v_cvt_pk_bf16_f32 v134, v104, v105
    v_mfma_f32_32x32x16_bf16 v[76:91], a[8:11], v[140:143], v[76:91]
    s_cmp_gt_u32 s43, 1
    ds_read_b128 a[4:7], v7 offset:17408
    v_exp_f32 v107, v107
    v_exp_f32 v108, v108
    v_cvt_pk_bf16_f32 v135, v106, v107
    v_exp_f32 v109, v109
    v_mfma_f32_32x32x16_bf16 v[76:91], a[12:15], v[144:147], v[76:91]
    s_cselect_b32 s22, s22, 0
    ds_read_b128 a[8:11], v7 offset:18432
    v_exp_f32 v110, v110
    v_cvt_pk_bf16_f32 v136, v108, v109
    v_exp_f32 v111, v111
    v_exp_f32 v112, v112
    v_cvt_pk_bf16_f32 v137, v110, v111
    v_smfmac_f32_16x16x64_bf16 v[96:99], v[148:151], v[140:147], v152
    s_waitcnt lgkmcnt(1)
    ds_read_b128 a[12:15], v7 offset:19456
    v_exp_f32 v113, v113
    v_exp_f32 v114, v114
    v_exp_f32 v115, v115
    v_cvt_pk_bf16_f32 v138, v112, v113
    v_cvt_pk_bf16_f32 v139, v114, v115
    v_mfma_f32_32x32x16_bf16 v[100:115], a[0:3], v[12:15], v[28:43]
    s_cselect_b32 s18, s18, 0
    v_exp_f32 v116, v116
    v_exp_f32 v117, v117
    v_exp_f32 v118, v118
    v_cvt_pk_bf16_f32 v140, v116, v117
    v_exp_f32 v119, v119
    v_mfma_f32_32x32x16_bf16 v[100:115], a[4:7], v[16:19], v[100:115]
    s_waitcnt vmcnt(12) lgkmcnt(0)
    v_exp_f32 v120, v120
    v_cvt_pk_bf16_f32 v141, v118, v119
    v_exp_f32 v121, v121
    v_exp_f32 v122, v122
    v_cvt_pk_bf16_f32 v142, v120, v121
    v_mfma_f32_32x32x16_bf16 v[60:75], a[8:11], v[132:135], v[60:75]
    s_cselect_b32 s44, s44, s60
    buffer_store_dwordx4 v[156:159], v6, s[32:35], s53 offen sc1
    buffer_store_dwordx4 v[160:163], v154, s[32:35], s53 offen sc1
    v_exp_f32 v123, v123
    v_exp_f32 v124, v124
    v_cvt_pk_bf16_f32 v143, v122, v123
    v_exp_f32 v125, v125
    v_mfma_f32_32x32x16_bf16 v[60:75], a[12:15], v[136:139], v[60:75]
    s_add_u32 s53, s53, s57
    v_exp_f32 v126, v126
    v_cvt_pk_bf16_f32 v144, v124, v125
    v_exp_f32 v127, v127
    v_exp_f32 v128, v128
    v_cvt_pk_bf16_f32 v145, v126, v127
    v_smfmac_f32_16x16x64_bf16 v[92:95], v[148:151], v[132:139], v152
    v_exp_f32 v129, v129
    v_exp_f32 v130, v130
    v_exp_f32 v131, v131
    v_cvt_pk_bf16_f32 v146, v128, v129
    v_cvt_pk_bf16_f32 v147, v130, v131
    v_mfma_f32_32x32x16_bf16 v[116:131], a[0:3], v[20:23], v[44:59]
    v_exp_f32 v100, v100
    v_exp_f32 v101, v101
    v_exp_f32 v102, v102
    v_cvt_pk_bf16_f32 v132, v100, v101
    v_exp_f32 v103, v103
    v_mfma_f32_32x32x16_bf16 v[116:131], a[4:7], v[24:27], v[116:131]
    ds_read_b128 a[0:3], v7 offset:20480
    v_exp_f32 v104, v104
    v_cvt_pk_bf16_f32 v133, v102, v103
    v_exp_f32 v105, v105
    v_exp_f32 v106, v106
    v_cvt_pk_bf16_f32 v134, v104, v105
    v_mfma_f32_32x32x16_bf16 v[76:91], a[8:11], v[140:143], v[76:91]
    ds_read_b128 a[4:7], v7 offset:21504
    v_exp_f32 v107, v107
    v_exp_f32 v108, v108
    v_cvt_pk_bf16_f32 v135, v106, v107
    v_exp_f32 v109, v109
    v_mfma_f32_32x32x16_bf16 v[76:91], a[12:15], v[144:147], v[76:91]
    ds_read_b128 a[8:11], v7 offset:22528
    v_exp_f32 v110, v110
    v_cvt_pk_bf16_f32 v136, v108, v109
    v_exp_f32 v111, v111
    v_exp_f32 v112, v112
    v_cvt_pk_bf16_f32 v137, v110, v111
    v_smfmac_f32_16x16x64_bf16 v[96:99], v[148:151], v[140:147], v152
    s_waitcnt lgkmcnt(1)
    ds_read_b128 a[12:15], v7 offset:23552
    v_exp_f32 v113, v113
    v_exp_f32 v114, v114
    v_exp_f32 v115, v115
    v_cvt_pk_bf16_f32 v138, v112, v113
    v_cvt_pk_bf16_f32 v139, v114, v115
    v_mfma_f32_32x32x16_bf16 v[100:115], a[0:3], v[12:15], v[28:43]
    v_exp_f32 v116, v116
    v_exp_f32 v117, v117
    v_exp_f32 v118, v118
    v_cvt_pk_bf16_f32 v140, v116, v117
    v_exp_f32 v119, v119
    v_mfma_f32_32x32x16_bf16 v[100:115], a[4:7], v[16:19], v[100:115]
    s_waitcnt lgkmcnt(0)
    v_exp_f32 v120, v120
    v_cvt_pk_bf16_f32 v141, v118, v119
    v_exp_f32 v121, v121
    v_exp_f32 v122, v122
    v_cvt_pk_bf16_f32 v142, v120, v121
    v_mfma_f32_32x32x16_bf16 v[60:75], a[8:11], v[132:135], v[60:75]
    buffer_load_dwordx4 v[156:159], v3, s[20:23], s52 offen sc1 nt
    buffer_load_dwordx4 v[160:163], v153, s[20:23], s52 offen sc1 nt
    v_exp_f32 v123, v123
    v_exp_f32 v124, v124
    v_cvt_pk_bf16_f32 v143, v122, v123
    v_exp_f32 v125, v125
    v_mfma_f32_32x32x16_bf16 v[60:75], a[12:15], v[136:139], v[60:75]
    s_add_u32 s52, s52, s54
    v_exp_f32 v126, v126
    v_cvt_pk_bf16_f32 v144, v124, v125
    v_exp_f32 v127, v127
    v_exp_f32 v128, v128
    v_cvt_pk_bf16_f32 v145, v126, v127
    v_smfmac_f32_16x16x64_bf16 v[92:95], v[148:151], v[132:139], v152
    s_xor_b32 s38, s38, 0x8000
    v_exp_f32 v129, v129
    v_exp_f32 v130, v130
    v_exp_f32 v131, v131
    v_cvt_pk_bf16_f32 v146, v128, v129
    v_cvt_pk_bf16_f32 v147, v130, v131
    v_mfma_f32_32x32x16_bf16 v[116:131], a[0:3], v[20:23], v[44:59]
    s_sub_u32 s43, s43, 1
    v_exp_f32 v100, v100
    v_exp_f32 v101, v101
    v_exp_f32 v102, v102
    v_cvt_pk_bf16_f32 v132, v100, v101
    v_exp_f32 v103, v103
    v_mfma_f32_32x32x16_bf16 v[116:131], a[4:7], v[24:27], v[116:131]
    ds_read_b128 a[0:3], v7 offset:24576
    v_exp_f32 v104, v104
    v_cvt_pk_bf16_f32 v133, v102, v103
    v_exp_f32 v105, v105
    v_exp_f32 v106, v106
    v_cvt_pk_bf16_f32 v134, v104, v105
    v_mfma_f32_32x32x16_bf16 v[76:91], a[8:11], v[140:143], v[76:91]
    ds_read_b128 a[4:7], v7 offset:25600
    v_exp_f32 v107, v107
    v_exp_f32 v108, v108
    v_cvt_pk_bf16_f32 v135, v106, v107
    v_exp_f32 v109, v109
    v_mfma_f32_32x32x16_bf16 v[76:91], a[12:15], v[144:147], v[76:91]
    ds_read_b128 a[8:11], v7 offset:26624
    v_exp_f32 v110, v110
    v_cvt_pk_bf16_f32 v136, v108, v109
    v_exp_f32 v111, v111
    v_exp_f32 v112, v112
    v_cvt_pk_bf16_f32 v137, v110, v111
    v_smfmac_f32_16x16x64_bf16 v[96:99], v[148:151], v[140:147], v152
    s_waitcnt lgkmcnt(1)
    ds_read_b128 a[12:15], v7 offset:27648
    v_exp_f32 v113, v113
    v_exp_f32 v114, v114
    v_exp_f32 v115, v115
    v_cvt_pk_bf16_f32 v138, v112, v113
    v_cvt_pk_bf16_f32 v139, v114, v115
    v_mfma_f32_32x32x16_bf16 v[100:115], a[0:3], v[12:15], v[28:43]
    s_mov_b32 m0, s37
    v_exp_f32 v116, v116
    v_exp_f32 v117, v117
    v_exp_f32 v118, v118
    v_cvt_pk_bf16_f32 v140, v116, v117
    v_exp_f32 v119, v119
    v_mfma_f32_32x32x16_bf16 v[100:115], a[4:7], v[16:19], v[100:115]
    s_waitcnt lgkmcnt(0)
    v_exp_f32 v120, v120
    v_cvt_pk_bf16_f32 v141, v118, v119
    v_exp_f32 v121, v121
    v_exp_f32 v122, v122
    v_cvt_pk_bf16_f32 v142, v120, v121
    v_mfma_f32_32x32x16_bf16 v[60:75], a[8:11], v[132:135], v[60:75]
    buffer_load_dwordx4 v248, s[12:15], s56 offen offset:0 sc1 lds
    buffer_load_dwordx4 v249, s[12:15], s56 offen offset:1024 sc1 lds
    v_exp_f32 v123, v123
    v_exp_f32 v124, v124
    v_cvt_pk_bf16_f32 v143, v122, v123
    v_exp_f32 v125, v125
    v_mfma_f32_32x32x16_bf16 v[60:75], a[12:15], v[136:139], v[60:75]
    s_add_u32 s37, s37, 2048
    v_exp_f32 v126, v126
    v_cvt_pk_bf16_f32 v144, v124, v125
    v_exp_f32 v127, v127
    v_exp_f32 v128, v128
    v_cvt_pk_bf16_f32 v145, v126, v127
    v_smfmac_f32_16x16x64_bf16 v[92:95], v[148:151], v[132:139], v152
    s_add_u32 s56, s56, 0x8000
    v_exp_f32 v129, v129
    v_exp_f32 v130, v130
    v_exp_f32 v131, v131
    v_cvt_pk_bf16_f32 v146, v128, v129
    v_cvt_pk_bf16_f32 v147, v130, v131
    v_mfma_f32_32x32x16_bf16 v[116:131], a[0:3], v[20:23], v[44:59]
    v_exp_f32 v100, v100
    v_exp_f32 v101, v101
    v_exp_f32 v102, v102
    v_cvt_pk_bf16_f32 v132, v100, v101
    v_exp_f32 v103, v103
    v_mfma_f32_32x32x16_bf16 v[116:131], a[4:7], v[24:27], v[116:131]
    ds_read_b128 a[0:3], v7 offset:28672
    v_exp_f32 v104, v104
    v_cvt_pk_bf16_f32 v133, v102, v103
    v_exp_f32 v105, v105
    v_exp_f32 v106, v106
    v_cvt_pk_bf16_f32 v134, v104, v105
    v_mfma_f32_32x32x16_bf16 v[76:91], a[8:11], v[140:143], v[76:91]
    ds_read_b128 a[4:7], v7 offset:29696
    v_exp_f32 v107, v107
    v_exp_f32 v108, v108
    v_cvt_pk_bf16_f32 v135, v106, v107
    v_exp_f32 v109, v109
    v_mfma_f32_32x32x16_bf16 v[76:91], a[12:15], v[144:147], v[76:91]
    ds_read_b128 a[8:11], v7 offset:30720
    v_exp_f32 v110, v110
    v_cvt_pk_bf16_f32 v136, v108, v109
    v_exp_f32 v111, v111
    v_exp_f32 v112, v112
    v_cvt_pk_bf16_f32 v137, v110, v111
    v_smfmac_f32_16x16x64_bf16 v[96:99], v[148:151], v[140:147], v152
    s_waitcnt lgkmcnt(1)
    ds_read_b128 a[12:15], v7 offset:31744
    v_exp_f32 v113, v113
    v_exp_f32 v114, v114
    v_exp_f32 v115, v115
    v_cvt_pk_bf16_f32 v138, v112, v113
    v_cvt_pk_bf16_f32 v139, v114, v115
    v_mfma_f32_32x32x16_bf16 v[100:115], a[0:3], v[12:15], v[28:43]
    s_mov_b32 m0, s44
    v_exp_f32 v116, v116
    v_exp_f32 v117, v117
    v_exp_f32 v118, v118
    v_cvt_pk_bf16_f32 v140, v116, v117
    v_exp_f32 v119, v119
    v_mfma_f32_32x32x16_bf16 v[100:115], a[4:7], v[16:19], v[100:115]
    s_waitcnt lgkmcnt(0)
    v_exp_f32 v120, v120
    v_cvt_pk_bf16_f32 v141, v118, v119
    v_exp_f32 v121, v121
    v_exp_f32 v122, v122
    v_cvt_pk_bf16_f32 v142, v120, v121
    v_mfma_f32_32x32x16_bf16 v[60:75], a[8:11], v[132:135], v[60:75]
    buffer_load_dwordx4 v155, s[16:19], s63 offen sc1 nt lds
    buffer_load_dword v164, v177, s[12:15], s58 offen sc1
    v_exp_f32 v123, v123
    v_exp_f32 v124, v124
    v_cvt_pk_bf16_f32 v143, v122, v123
    v_exp_f32 v125, v125
    v_mfma_f32_32x32x16_bf16 v[60:75], a[12:15], v[136:139], v[60:75]
    s_add_u32 s63, s63, 98304
    v_xor_b32 v7, 0x8000, v7
    v_exp_f32 v126, v126
    v_cvt_pk_bf16_f32 v144, v124, v125
    v_exp_f32 v127, v127
    v_exp_f32 v128, v128
    v_cvt_pk_bf16_f32 v145, v126, v127
    v_smfmac_f32_16x16x64_bf16 v[92:95], v[148:151], v[132:139], v152
    s_cmp_lg_u32 s43, 0
    v_exp_f32 v129, v129
    v_exp_f32 v130, v130
    v_exp_f32 v131, v131
    v_cvt_pk_bf16_f32 v146, v128, v129
    v_cvt_pk_bf16_f32 v147, v130, v131
    s_cbranch_scc1 K3_LOOP
    s_nop 0
    v_smfmac_f32_16x16x64_bf16 v[96:99], v[148:151], v[140:147], v152
    v_mfma_f32_32x32x16_bf16 v[76:91], a[8:11], v[140:143], v[76:91]
    v_mfma_f32_32x32x16_bf16 v[76:91], a[12:15], v[144:147], v[76:91]
    s_mov_b32 s48, 0x53800000
    v_bfe_u32 v8, v1, 4, 1
    v_lshlrev_b32 v8, 10, v8
    v_lshrrev_b32 v9, 5, v1
    v_lshl_add_u32 v8, v9, 8, v8
    v_and_b32 v9, 15, v1
    v_lshl_add_u32 v8, v9, 4, v8
    s_nop 2
    v_add_f32 v92, v92, v93
    v_add_f32 v96, v96, v97
    v_add_f32 v11, v92, v96
    v_cmp_nle_f32 vcc, v11, s48
    v_rcp_f32 v92, v92
    v_rcp_f32 v96, v96
    s_cmp_lg_u64 vcc, 0
    s_cselect_b32 s59, 1, 0
    s_andn2_b32 s59, s59, s42
    s_lshl_b32 s48, s40, 11
    s_lshl_b32 s49, s39, 17
    s_add_u32 s48, s48, s49
    s_add_u32 s48, s48, 0x900000
    v_pk_mul_f32 v[60:61], v[60:61], v[92:93] op_sel_hi:[1,0]
    v_pk_mul_f32 v[62:63], v[62:63], v[92:93] op_sel_hi:[1,0]
    v_pk_mul_f32 v[64:65], v[64:65], v[92:93] op_sel_hi:[1,0]
    v_pk_mul_f32 v[66:67], v[66:67], v[92:93] op_sel_hi:[1,0]
    v_pk_mul_f32 v[68:69], v[68:69], v[92:93] op_sel_hi:[1,0]
    v_pk_mul_f32 v[70:71], v[70:71], v[92:93] op_sel_hi:[1,0]
    v_pk_mul_f32 v[72:73], v[72:73], v[92:93] op_sel_hi:[1,0]
    v_pk_mul_f32 v[74:75], v[74:75], v[92:93] op_sel_hi:[1,0]
    v_cvt_pk_bf16_f32 v132, v60, v61
    v_cvt_pk_bf16_f32 v133, v62, v63
    v_cvt_pk_bf16_f32 v134, v68, v69
    v_cvt_pk_bf16_f32 v135, v70, v71
    buffer_store_dwordx4 v[132:135], v8, s[24:27], s48 offen offset:0 sc1
    v_cvt_pk_bf16_f32 v136, v64, v65
    v_cvt_pk_bf16_f32 v137, v66, v67
    v_cvt_pk_bf16_f32 v138, v72, v73
    v_cvt_pk_bf16_f32 v139, v74, v75
    buffer_store_dwordx4 v[136:139], v8, s[24:27], s48 offen offset:512 sc1
    v_pk_mul_f32 v[76:77], v[76:77], v[96:97] op_sel_hi:[1,0]
    v_pk_mul_f32 v[78:79], v[78:79], v[96:97] op_sel_hi:[1,0]
    v_pk_mul_f32 v[80:81], v[80:81], v[96:97] op_sel_hi:[1,0]
    v_pk_mul_f32 v[82:83], v[82:83], v[96:97] op_sel_hi:[1,0]
    v_pk_mul_f32 v[84:85], v[84:85], v[96:97] op_sel_hi:[1,0]
    v_pk_mul_f32 v[86:87], v[86:87], v[96:97] op_sel_hi:[1,0]
    v_pk_mul_f32 v[88:89], v[88:89], v[96:97] op_sel_hi:[1,0]
    v_pk_mul_f32 v[90:91], v[90:91], v[96:97] op_sel_hi:[1,0]
    v_cvt_pk_bf16_f32 v140, v76, v77
    v_cvt_pk_bf16_f32 v141, v78, v79
    v_cvt_pk_bf16_f32 v142, v84, v85
    v_cvt_pk_bf16_f32 v143, v86, v87
    buffer_store_dwordx4 v[140:143], v8, s[24:27], s48 offen offset:2048 sc1
    v_cvt_pk_bf16_f32 v144, v80, v81
    v_cvt_pk_bf16_f32 v145, v82, v83
    v_cvt_pk_bf16_f32 v146, v88, v89
    v_cvt_pk_bf16_f32 v147, v90, v91
    buffer_store_dwordx4 v[144:147], v8, s[24:27], s48 offen offset:2560 sc1
    s_lshl_b32 s45, s36, 13
    s_add_u32 s45, s45, 131072
    v_bfe_u32 v9, v1, 2, 2
    v_lshl_add_u32 v9, v4, 2, v9
    v_and_b32 v10, 3, v1
    v_lshlrev_b32 v10, 3, v10
    v_lshl_add_u32 v10, v9, 7, v10
    v_bfe_u32 v9, v9, 1, 2
    v_lshl_add_u32 v178, v9, 5, v10
    s_waitcnt vmcnt(20)
    s_cmp_lg_u32 s42, 0
    s_cbranch_scc1 K4_NOMJ
    v_add_u32 v10, s45, v178
    ds_read_b64_tr_b16 v[184:185], v10 offset:0
    ds_read_b64_tr_b16 v[186:187], v10 offset:2048
    ds_read_b64_tr_b16 v[188:189], v10 offset:4096
    ds_read_b64_tr_b16 v[190:191], v10 offset:6144
    v_xor_b32 v9, 32, v10
    ds_read_b64_tr_b16 v[192:193], v9 offset:0
    ds_read_b64_tr_b16 v[194:195], v9 offset:2048
    ds_read_b64_tr_b16 v[196:197], v9 offset:4096
    ds_read_b64_tr_b16 v[198:199], v9 offset:6144
    v_xor_b32 v9, 64, v10
    ds_read_b64_tr_b16 v[200:201], v9 offset:0
    ds_read_b64_tr_b16 v[202:203], v9 offset:2048
    ds_read_b64_tr_b16 v[204:205], v9 offset:4096
    ds_read_b64_tr_b16 v[206:207], v9 offset:6144
    v_xor_b32 v9, 96, v10
    ds_read_b64_tr_b16 v[208:209], v9 offset:0
    ds_read_b64_tr_b16 v[210:211], v9 offset:2048
    ds_read_b64_tr_b16 v[212:213], v9 offset:4096
    ds_read_b64_tr_b16 v[214:215], v9 offset:6144
    v_lshlrev_b32 v9, 4, v4
    v_add_u32 v9, s45, v9
    s_waitcnt lgkmcnt(0)
    v_mfma_f32_16x16x32_bf16 v[216:219], v[184:187], v[168:171], 0
    v_mfma_f32_16x16x32_bf16 v[220:223], v[192:195], v[168:171], 0
    v_mfma_f32_16x16x32_bf16 v[224:227], v[200:203], v[168:171], 0
    v_mfma_f32_16x16x32_bf16 v[228:231], v[208:211], v[168:171], 0
    v_mfma_f32_16x16x32_bf16 v[216:219], v[188:191], v[172:175], v[216:219]
    v_mfma_f32_16x16x32_bf16 v[220:223], v[196:199], v[172:175], v[220:223]
    v_mfma_f32_16x16x32_bf16 v[224:227], v[204:207], v[172:175], v[224:227]
    v_mfma_f32_16x16x32_bf16 v[228:231], v[212:215], v[172:175], v[228:231]
    s_mov_b32 exec_lo, 0x00010001
    s_mov_b32 exec_hi, 0x00010001
    s_nop 5
    ds_write_b128 v9, v[216:219] offset:6144
    ds_write_b128 v9, v[220:223] offset:6208
    ds_write_b128 v9, v[224:227] offset:6272
    ds_write_b128 v9, v[228:231] offset:6336
    s_mov_b64 exec, -1
K4_NOMJ:
    v_mov_b32 v10, s45
    v_mov_b32 v11, s59
    ds_write_b32 v10, v11 offset:7168
    s_and_b32 s48, s2, 7
    s_lshl_b32 s49, s48, 2
    s_add_u32 s49, s49, s36
    s_lshl_b32 s49, s49, 5
    s_add_u32 s49, s49, s39
    s_lshl_b32 s49, s49, 7
    s_add_u32 s49, s49, 25165824
    v_and_b32 v10, 3, v1
    v_lshlrev_b32 v10, 13, v10
    v_add_u32 v10, 138240, v10
    s_cmp_lg_u32 s59, 0
    s_waitcnt vmcnt(0) lgkmcnt(0)
    s_cbranch_scc1 K4_NOFLAG
    v_mov_b32 v8, 0
    v_mov_b32 v9, 1
    s_mov_b64 exec, 1
    buffer_store_dword v9, v8, s[24:27], s49 offen sc1
    s_mov_b64 exec, -1
K4_NOFLAG:
    s_barrier
    ds_read_b32 v11, v10
    s_waitcnt lgkmcnt(0)
    v_cmp_ne_u32 vcc, 0, v11
    s_nop 1
    s_cmp_lg_u64 vcc, 0
    s_cbranch_scc1 K3_SLOW
    s_lshl_b32 s43, s36, 18
    s_add_u32 s62, s43, 0x100000
    s_lshl_b32 s63, s36, 14
    s_mov_b32 m0, s63
    s_nop 0
    buffer_load_dwordx4 v248, s[12:15], s62 offen offset:0 sc1 lds
    buffer_load_dwordx4 v249, s[12:15], s62 offen offset:1024 sc1 lds
    buffer_load_dwordx4 v250, s[12:15], s62 offen offset:2048 sc1 lds
    buffer_load_dwordx4 v251, s[12:15], s62 offen offset:3072 sc1 lds
    s_add_u32 m0, m0, 4096
    s_add_u32 s62, s62, 0x10000
    buffer_load_dwordx4 v248, s[12:15], s62 offen offset:0 sc1 lds
    buffer_load_dwordx4 v249, s[12:15], s62 offen offset:1024 sc1 lds
    buffer_load_dwordx4 v250, s[12:15], s62 offen offset:2048 sc1 lds
    buffer_load_dwordx4 v251, s[12:15], s62 offen offset:3072 sc1 lds
    s_add_u32 m0, m0, 4096
    s_add_u32 s62, s62, 0x10000
    buffer_load_dwordx4 v248, s[12:15], s62 offen offset:0 sc1 lds
    buffer_load_dwordx4 v249, s[12:15], s62 offen offset:1024 sc1 lds
    buffer_load_dwordx4 v250, s[12:15], s62 offen offset:2048 sc1 lds
    buffer_load_dwordx4 v251, s[12:15], s62 offen offset:3072 sc1 lds
    s_add_u32 m0, m0, 4096
    s_add_u32 s62, s62, 0x10000
    buffer_load_dwordx4 v248, s[12:15], s62 offen offset:0 sc1 lds
    buffer_load_dwordx4 v249, s[12:15], s62 offen offset:1024 sc1 lds
    buffer_load_dwordx4 v250, s[12:15], s62 offen offset:2048 sc1 lds
    buffer_load_dwordx4 v251, s[12:15], s62 offen offset:3072 sc1 lds
    s_add_u32 m0, m0, 4096
    s_add_u32 s62, s62, 0x10000
    s_cmp_lg_u32 s36, 0
    s_cbranch_scc1 K4_NOMOD
    v_lshlrev_b32 v10, 2, v1
    v_add_u32 v11, 137216, v10
    ds_read_b32 v20, v11 offset:0
    ds_read_b32 v21, v11 offset:8192
    ds_read_b32 v22, v11 offset:16384
    ds_read_b32 v23, v11 offset:24576
    s_lshr_b32 s43, s2, 6
    s_mul_i32 s43, s43, 24576
    s_and_b32 s47, s2, 63
    s_lshl_b32 s47, s47, 8
    s_add_u32 s43, s43, s47
    s_add_u32 s43, s43, 8192
    s_waitcnt lgkmcnt(0)
    v_add_f32 v20, v20, v21
    v_add_f32 v22, v22, v23
    v_add_f32 v20, v20, v22
    buffer_store_dword v20, v10, s[24:27], s43 offen sc1
K4_NOMOD:
    v_mov_b32 v15, v4
    v_add_u32 v16, 65536, v178
    v_xor_b32 v17, 32, v16
    v_xor_b32 v18, 64, v16
    v_xor_b32 v19, 96, v16
    s_lshr_b32 s40, s48, 1
    s_lshl_b32 s40, s40, 2
    s_lshr_b32 s43, s2, 6
    s_add_u32 s40, s40, s43
    s_bfe_u32 s41, s2, 0x30003
    s_lshl_b32 s41, s41, 1
    s_and_b32 s43, s2, 1
    s_add_u32 s41, s41, s43
    s_lshl_b32 s47, s40, 2
    s_add_u32 s47, s47, s36
    s_lshr_b32 s52, s47, 1
    s_lshl_b32 s52, s52, 12
    s_add_u32 s52, s52, 25165824
    s_lshl_b32 s43, s47, 11
    v_add_u32 v12, s43, v2
    s_add_u32 s28, s10, 0x900000
    s_addc_u32 s29, s11, 0
    s_and_b32 s29, s29, 0xffff
    s_mov_b32 s30, 0x400000
    s_mov_b32 s31, 0x20000
    s_mov_b32 s20, s50
    s_and_b32 s21, s51, 0xffff
    s_mov_b32 s22, 0x400000
    s_mov_b32 s23, 0x20000
    v_lshrrev_b32 v6, 3, v1
    v_xor_b32 v5, v6, v1
    s_lshl_b32 s43, s47, 5
    v_add_u32 v6, s43, v6
    v_lshlrev_b32 v6, 11, v6
    v_and_b32 v5, 7, v5
    v_lshl_add_u32 v6, v5, 4, v6
    s_lshl_b32 s43, s41, 7
    v_add_u32 v6, s43, v6
    v_add_u32 v7, 15360, v6
    v_add_u32 v8, 30720, v6
    v_add_u32 v9, 46080, v6
    v_and_b32 v13, 31, v1
    v_lshlrev_b32 v13, 7, v13
    ds_read_b64_tr_b16 v[24:25], v16 offset:0
    ds_read_b64_tr_b16 v[26:27], v16 offset:2048
    ds_read_b64_tr_b16 v[28:29], v17 offset:0
    ds_read_b64_tr_b16 v[30:31], v17 offset:2048
    ds_read_b64_tr_b16 v[32:33], v18 offset:0
    ds_read_b64_tr_b16 v[34:35], v18 offset:2048
    ds_read_b64_tr_b16 v[36:37], v19 offset:0
    ds_read_b64_tr_b16 v[38:39], v19 offset:2048
    v_mov_b64 v[40:41], 0
    v_mov_b64 v[42:43], 0
    v_mov_b64 v[44:45], 0
    v_mov_b64 v[46:47], 0
    v_mov_b64 v[48:49], 0
    v_mov_b64 v[50:51], 0
    v_mov_b64 v[52:53], 0
    v_mov_b64 v[54:55], 0
    v_mov_b64 v[56:57], 0
    v_mov_b64 v[58:59], 0
    v_mov_b64 v[60:61], 0
    v_mov_b64 v[62:63], 0
    v_mov_b64 v[64:65], 0
    v_mov_b64 v[66:67], 0
    v_mov_b64 v[68:69], 0
    v_mov_b64 v[70:71], 0
    s_lshl_b32 s43, s41, 8
    v_lshlrev_b32 v10, 2, v1
    v_add_u32 v10, s43, v10
    v_add_u32 v11, 16384, v10
    v_add_u32 v10, 8192, v10
    s_mov_b32 s54, 0
    s_mov_b32 s55, 24576
    s_mov_b32 s56, 49152
    s_mov_b32 s57, 73728
    s_and_b32 s43, s2, 7
    s_lshr_b32 s38, s43, 2
    s_lshl_b32 s38, s38, 2
    s_lshr_b32 s39, s2, 6
    s_add_u32 s38, s38, s39
    s_and_b32 s43, s43, 3
    s_lshl_b32 s43, s43, 3
    s_bfe_u32 s39, s2, 0x30003
    s_add_u32 s39, s39, s43
    s_mul_i32 s43, s39, 229376
    s_add_u32 s4, s10, s43
    s_addc_u32 s5, s11, 0
    s_add_u32 s16, s4, 0x2400000
    s_addc_u32 s17, s5, 0
    s_and_b32 s17, s17, 0xffff
    s_mov_b32 s18, 0x38000
    s_mov_b32 s19, 0x20000
    s_mul_i32 s58, s38, 28672
    s_lshl_b32 s59, s36, 10
    s_add_u32 s59, s59, 65536
    v_lshlrev_b32 v252, 4, v0
    s_mul_i32 s61, s36, 7168
    s_add_u32 s61, s61, 65536
    s_lshl_b32 s43, s38, 2
    s_add_u32 s43, s43, s36
    s_lshr_b32 s42, s43, 1
    v_bfe_u32 v20, v1, 2, 2
    v_mov_b32 v21, s41
    v_mov_b32 v22, s42
    v_cmp_lt_u32 vcc, 1, v20
    v_mov_b32 v23, 0x10202000
    v_lshlrev_b32 v20, 3, v20
    v_cndmask_b32 v21, v21, v22, vcc
    v_bfe_u32 v23, v23, v20, 8
    v_add_u32 v21, v21, v23
    v_and_b32 v20, 3, v1
    v_lshl_add_u32 v21, v20, 6, v21
    s_lshl_b32 s42, s39, 2
    v_and_b32 v23, 16, v1
    v_add_u32 v22, s42, v20
    v_cmp_ne_u32 vcc, 0, v23
    s_lshl_b32 s44, s2, 2
    s_add_u32 s44, s44, s36
    v_cndmask_b32 v21, v21, v22, vcc
    v_lshlrev_b32 v253, 7, v21
    s_lshl_b32 s44, s44, 12
    s_add_u32 s44, s44, 0x1000000
    s_lshl_b32 s43, s43, 7
    s_add_u32 s43, s43, 16384
    v_and_b32 v3, 31, v1
    v_lshlrev_b32 v3, 2, v3
    v_lshrrev_b32 v4, 5, v1
    v_lshlrev_b32 v4, 12, v4
    v_sub_u32 v3, v3, v4
    v_add_u32 v3, s43, v3
    s_mul_i32 s48, s41, 0
    s_and_b32 s48, s48, 0x3fffff
    s_mov_b32 s53, 25559040
    s_mov_b32 s60, 0x200000
POLL_O:
    buffer_load_dword v14, v13, s[24:27], s52 offen sc1
    s_sub_u32 s60, s60, 1
    s_waitcnt vmcnt(0)
    v_cmp_eq_u32 vcc, 0, v14
    s_cmp_eq_u32 s60, 0
    s_cbranch_scc1 POLLX_O
    s_cmp_eq_u64 vcc, 0
    s_cbranch_scc1 POLLX_O
    s_sleep 4
    s_branch POLL_O
POLLX_O:
    buffer_load_dwordx4 v[120:123], v12, s[28:31], s48 offen offset:0 sc1
    buffer_load_dwordx4 v[124:127], v12, s[28:31], s48 offen offset:1024 sc1
    s_add_u32 s48, s48, 0x20000
    buffer_load_dwordx4 v[128:131], v12, s[28:31], s48 offen offset:0 sc1
    buffer_load_dwordx4 v[132:135], v12, s[28:31], s48 offen offset:1024 sc1
    s_add_u32 s48, s48, 0x20000
    buffer_load_dwordx4 v[136:139], v12, s[28:31], s48 offen offset:0 sc1
    buffer_load_dwordx4 v[140:143], v12, s[28:31], s48 offen offset:1024 sc1
    s_add_u32 s48, s48, 0x20000
    buffer_load_dwordx4 v[144:147], v12, s[28:31], s48 offen offset:0 sc1
    buffer_load_dwordx4 v[148:151], v12, s[28:31], s48 offen offset:1024 sc1
    s_add_u32 s48, s48, 0x20000
    buffer_load_dwordx4 v[152:155], v12, s[28:31], s48 offen offset:0 sc1
    buffer_load_dwordx4 v[156:159], v12, s[28:31], s48 offen offset:1024 sc1
    s_add_u32 s48, s48, 0x20000
    s_cmp_lg_u32 s36, 0
    s_cbranch_scc1 K4_NOFX
    s_lshl_b32 s43, s2, 7
    s_add_u32 s43, s43, 25559040
    v_mov_b32 v20, 0
    v_mov_b32 v21, 1
    s_mov_b64 exec, 1
    buffer_store_dword v21, v20, s[24:27], s43 offen sc1
    s_mov_b64 exec, -1
K4_NOFX:
    s_waitcnt vmcnt(8) lgkmcnt(0)
    v_mfma_f32_16x16x32_bf16 v[40:43], v[24:27], v[120:123], v[40:43]
    buffer_load_dwordx4 v[160:163], v12, s[28:31], s48 offen offset:0 sc1
    v_mfma_f32_16x16x32_bf16 v[44:47], v[24:27], v[124:127], v[44:47]
    s_waitcnt lgkmcnt(4)
    ds_read_b64_tr_b16 v[24:25], v16 offset:4096
    v_mfma_f32_16x16x32_bf16 v[48:51], v[28:31], v[120:123], v[48:51]
    ds_read_b64_tr_b16 v[26:27], v16 offset:6144
    buffer_load_dwordx4 v[164:167], v12, s[28:31], s48 offen offset:1024 sc1
    v_mfma_f32_16x16x32_bf16 v[52:55], v[28:31], v[124:127], v[52:55]
    s_waitcnt lgkmcnt(4)
    s_add_u32 s48, s48, 0x20000
    ds_read_b64_tr_b16 v[28:29], v17 offset:4096
    v_mfma_f32_16x16x32_bf16 v[56:59], v[32:35], v[120:123], v[56:59]
    ds_read_b64_tr_b16 v[30:31], v17 offset:6144
    buffer_load_dwordx4 v[168:171], v12, s[28:31], s48 offen offset:0 sc1
    v_mfma_f32_16x16x32_bf16 v[60:63], v[32:35], v[124:127], v[60:63]
    s_waitcnt lgkmcnt(4)
    ds_read_b64_tr_b16 v[32:33], v18 offset:4096
    v_mfma_f32_16x16x32_bf16 v[64:67], v[36:39], v[120:123], v[64:67]
    ds_read_b64_tr_b16 v[34:35], v18 offset:6144
    buffer_load_dwordx4 v[172:175], v12, s[28:31], s48 offen offset:1024 sc1
    v_mfma_f32_16x16x32_bf16 v[68:71], v[36:39], v[124:127], v[68:71]
    s_waitcnt vmcnt(10) lgkmcnt(4)
    s_add_u32 s48, s48, 0x20000
    ds_read_b64_tr_b16 v[36:37], v19 offset:4096
    v_mfma_f32_16x16x32_bf16 v[40:43], v[24:27], v[128:131], v[40:43]
    ds_read_b64_tr_b16 v[38:39], v19 offset:6144
    buffer_load_dwordx4 v[176:179], v12, s[28:31], s48 offen offset:0 sc1
    v_mfma_f32_16x16x32_bf16 v[44:47], v[24:27], v[132:135], v[44:47]
    s_waitcnt lgkmcnt(4)
    ds_read_b64_tr_b16 v[24:25], v16 offset:8192
    v_mfma_f32_16x16x32_bf16 v[48:51], v[28:31], v[128:131], v[48:51]
    ds_read_b64_tr_b16 v[26:27], v16 offset:10240
    buffer_load_dwordx4 v[180:183], v12, s[28:31], s48 offen offset:1024 sc1
    v_mfma_f32_16x16x32_bf16 v[52:55], v[28:31], v[132:135], v[52:55]
    s_waitcnt lgkmcnt(4)
    s_add_u32 s48, s48, 0x20000
    ds_read_b64_tr_b16 v[28:29], v17 offset:8192
    v_mfma_f32_16x16x32_bf16 v[56:59], v[32:35], v[128:131], v[56:59]
    ds_read_b64_tr_b16 v[30:31], v17 offset:10240
    buffer_load_dwordx4 v[184:187], v12, s[28:31], s48 offen offset:0 sc1
    v_mfma_f32_16x16x32_bf16 v[60:63], v[32:35], v[132:135], v[60:63]
    s_waitcnt lgkmcnt(4)
    ds_read_b64_tr_b16 v[32:33], v18 offset:8192
    v_mfma_f32_16x16x32_bf16 v[64:67], v[36:39], v[128:131], v[64:67]
    ds_read_b64_tr_b16 v[34:35], v18 offset:10240
    buffer_load_dwordx4 v[188:191], v12, s[28:31], s48 offen offset:1024 sc1
    v_mfma_f32_16x16x32_bf16 v[68:71], v[36:39], v[132:135], v[68:71]
    s_waitcnt vmcnt(12) lgkmcnt(4)
    s_add_u32 s48, s48, 0x20000
    ds_read_b64_tr_b16 v[36:37], v19 offset:8192
    v_mfma_f32_16x16x32_bf16 v[40:43], v[24:27], v[136:139], v[40:43]
    ds_read_b64_tr_b16 v[38:39], v19 offset:10240
    buffer_load_dwordx4 v[192:195], v12, s[28:31], s48 offen offset:0 sc1
    v_mfma_f32_16x16x32_bf16 v[44:47], v[24:27], v[140:143], v[44:47]
    s_waitcnt lgkmcnt(4)
    ds_read_b64_tr_b16 v[24:25], v16 offset:12288
    v_mfma_f32_16x16x32_bf16 v[48:51], v[28:31], v[136:139], v[48:51]
    ds_read_b64_tr_b16 v[26:27], v16 offset:14336
    buffer_load_dwordx4 v[196:199], v12, s[28:31], s48 offen offset:1024 sc1
    v_mfma_f32_16x16x32_bf16 v[52:55], v[28:31], v[140:143], v[52:55]
    s_waitcnt lgkmcnt(4)
    s_add_u32 s48, s48, 0x20000
    ds_read_b64_tr_b16 v[28:29], v17 offset:12288
    v_mfma_f32_16x16x32_bf16 v[56:59], v[32:35], v[136:139], v[56:59]
    ds_read_b64_tr_b16 v[30:31], v17 offset:14336
    buffer_load_dwordx4 v[200:203], v12, s[28:31], s48 offen offset:0 sc1
    v_mfma_f32_16x16x32_bf16 v[60:63], v[32:35], v[140:143], v[60:63]
    s_waitcnt lgkmcnt(4)
    ds_read_b64_tr_b16 v[32:33], v18 offset:12288
    v_mfma_f32_16x16x32_bf16 v[64:67], v[36:39], v[136:139], v[64:67]
    ds_read_b64_tr_b16 v[34:35], v18 offset:14336
    buffer_load_dwordx4 v[204:207], v12, s[28:31], s48 offen offset:1024 sc1
    v_mfma_f32_16x16x32_bf16 v[68:71], v[36:39], v[140:143], v[68:71]
    s_waitcnt vmcnt(14) lgkmcnt(4)
    s_add_u32 s48, s48, 0x20000
    ds_read_b64_tr_b16 v[36:37], v19 offset:12288
    v_mfma_f32_16x16x32_bf16 v[40:43], v[24:27], v[144:147], v[40:43]
    ds_read_b64_tr_b16 v[38:39], v19 offset:14336
    buffer_load_dwordx4 v[208:211], v12, s[28:31], s48 offen offset:0 sc1
    v_mfma_f32_16x16x32_bf16 v[44:47], v[24:27], v[148:151], v[44:47]
    s_waitcnt lgkmcnt(4)
    ds_read_b64_tr_b16 v[24:25], v16 offset:16384
    v_mfma_f32_16x16x32_bf16 v[48:51], v[28:31], v[144:147], v[48:51]
    ds_read_b64_tr_b16 v[26:27], v16 offset:18432
    buffer_load_dwordx4 v[212:215], v12, s[28:31], s48 offen offset:1024 sc1
    v_mfma_f32_16x16x32_bf16 v[52:55], v[28:31], v[148:151], v[52:55]
    s_waitcnt lgkmcnt(4)
    s_add_u32 s48, s48, 0x20000
    ds_read_b64_tr_b16 v[28:29], v17 offset:16384
    v_mfma_f32_16x16x32_bf16 v[56:59], v[32:35], v[144:147], v[56:59]
    ds_read_b64_tr_b16 v[30:31], v17 offset:18432
    buffer_load_dwordx4 v[216:219], v12, s[28:31], s48 offen offset:0 sc1
    v_mfma_f32_16x16x32_bf16 v[60:63], v[32:35], v[148:151], v[60:63]
    s_waitcnt lgkmcnt(4)
    ds_read_b64_tr_b16 v[32:33], v18 offset:16384
    v_mfma_f32_16x16x32_bf16 v[64:67], v[36:39], v[144:147], v[64:67]
    ds_read_b64_tr_b16 v[34:35], v18 offset:18432
    buffer_load_dwordx4 v[220:223], v12, s[28:31], s48 offen offset:1024 sc1
    v_mfma_f32_16x16x32_bf16 v[68:71], v[36:39], v[148:151], v[68:71]
    s_waitcnt vmcnt(16) lgkmcnt(4)
    s_add_u32 s48, s48, 0x20000
    ds_read_b64_tr_b16 v[36:37], v19 offset:16384
    v_mfma_f32_16x16x32_bf16 v[40:43], v[24:27], v[152:155], v[40:43]
    ds_read_b64_tr_b16 v[38:39], v19 offset:18432
    buffer_load_dwordx4 v[224:227], v12, s[28:31], s48 offen offset:0 sc1
    v_mfma_f32_16x16x32_bf16 v[44:47], v[24:27], v[156:159], v[44:47]
    s_waitcnt lgkmcnt(4)
    ds_read_b64_tr_b16 v[24:25], v16 offset:20480
    v_mfma_f32_16x16x32_bf16 v[48:51], v[28:31], v[152:155], v[48:51]
    ds_read_b64_tr_b16 v[26:27], v16 offset:22528
    buffer_load_dwordx4 v[228:231], v12, s[28:31], s48 offen offset:1024 sc1
    v_mfma_f32_16x16x32_bf16 v[52:55], v[28:31], v[156:159], v[52:55]
    s_waitcnt lgkmcnt(4)
    s_add_u32 s48, s48, 0x20000
    ds_read_b64_tr_b16 v[28:29], v17 offset:20480
    v_mfma_f32_16x16x32_bf16 v[56:59], v[32:35], v[152:155], v[56:59]
    ds_read_b64_tr_b16 v[30:31], v17 offset:22528
    v_mfma_f32_16x16x32_bf16 v[60:63], v[32:35], v[156:159], v[60:63]
    s_waitcnt lgkmcnt(4)
    ds_read_b64_tr_b16 v[32:33], v18 offset:20480
    v_mfma_f32_16x16x32_bf16 v[64:67], v[36:39], v[152:155], v[64:67]
    ds_read_b64_tr_b16 v[34:35], v18 offset:22528
    v_mfma_f32_16x16x32_bf16 v[68:71], v[36:39], v[156:159], v[68:71]
    s_waitcnt vmcnt(16) lgkmcnt(4)
    ds_read_b64_tr_b16 v[36:37], v19 offset:20480
    v_mfma_f32_16x16x32_bf16 v[40:43], v[24:27], v[160:163], v[40:43]
    ds_read_b64_tr_b16 v[38:39], v19 offset:22528
    buffer_load_dwordx4 v[232:235], v12, s[28:31], s48 offen offset:0 sc1
    v_mfma_f32_16x16x32_bf16 v[44:47], v[24:27], v[164:167], v[44:47]
    s_waitcnt lgkmcnt(4)
    ds_read_b64_tr_b16 v[24:25], v16 offset:24576
    v_mfma_f32_16x16x32_bf16 v[48:51], v[28:31], v[160:163], v[48:51]
    ds_read_b64_tr_b16 v[26:27], v16 offset:26624
    buffer_load_dwordx4 v[236:239], v12, s[28:31], s48 offen offset:1024 sc1
    v_mfma_f32_16x16x32_bf16 v[52:55], v[28:31], v[164:167], v[52:55]
    s_waitcnt lgkmcnt(4)
    s_add_u32 s48, s48, 0x20000
    ds_read_b64_tr_b16 v[28:29], v17 offset:24576
    v_mfma_f32_16x16x32_bf16 v[56:59], v[32:35], v[160:163], v[56:59]
    ds_read_b64_tr_b16 v[30:31], v17 offset:26624
    v_mfma_f32_16x16x32_bf16 v[60:63], v[32:35], v[164:167], v[60:63]
    s_waitcnt lgkmcnt(4)
    ds_read_b64_tr_b16 v[32:33], v18 offset:24576
    v_mfma_f32_16x16x32_bf16 v[64:67], v[36:39], v[160:163], v[64:67]
    ds_read_b64_tr_b16 v[34:35], v18 offset:26624
    v_mfma_f32_16x16x32_bf16 v[68:71], v[36:39], v[164:167], v[68:71]
    s_waitcnt vmcnt(16) lgkmcnt(4)
    ds_read_b64_tr_b16 v[36:37], v19 offset:24576
    v_mfma_f32_16x16x32_bf16 v[40:43], v[24:27], v[168:171], v[40:43]
    ds_read_b64_tr_b16 v[38:39], v19 offset:26624
    buffer_load_dwordx4 v[240:243], v12, s[28:31], s48 offen offset:0 sc1
    v_mfma_f32_16x16x32_bf16 v[44:47], v[24:27], v[172:175], v[44:47]
    s_waitcnt lgkmcnt(4)
    ds_read_b64_tr_b16 v[24:25], v16 offset:28672
    v_mfma_f32_16x16x32_bf16 v[48:51], v[28:31], v[168:171], v[48:51]
    ds_read_b64_tr_b16 v[26:27], v16 offset:30720
    buffer_load_dwordx4 v[244:247], v12, s[28:31], s48 offen offset:1024 sc1
    v_mfma_f32_16x16x32_bf16 v[52:55], v[28:31], v[172:175], v[52:55]
    s_waitcnt lgkmcnt(4)
    s_add_u32 s48, s48, 0x20000
    ds_read_b64_tr_b16 v[28:29], v17 offset:28672
    v_mfma_f32_16x16x32_bf16 v[56:59], v[32:35], v[168:171], v[56:59]
    ds_read_b64_tr_b16 v[30:31], v17 offset:30720
    v_mfma_f32_16x16x32_bf16 v[60:63], v[32:35], v[172:175], v[60:63]
    s_waitcnt lgkmcnt(4)
    ds_read_b64_tr_b16 v[32:33], v18 offset:28672
    v_mfma_f32_16x16x32_bf16 v[64:67], v[36:39], v[168:171], v[64:67]
    ds_read_b64_tr_b16 v[34:35], v18 offset:30720
    v_mfma_f32_16x16x32_bf16 v[68:71], v[36:39], v[172:175], v[68:71]
    s_waitcnt vmcnt(16) lgkmcnt(4)
    ds_read_b64_tr_b16 v[36:37], v19 offset:28672
    v_mfma_f32_16x16x32_bf16 v[40:43], v[24:27], v[176:179], v[40:43]
    ds_read_b64_tr_b16 v[38:39], v19 offset:30720
    buffer_load_dwordx4 v[120:123], v12, s[28:31], s48 offen offset:0 sc1
    v_mfma_f32_16x16x32_bf16 v[44:47], v[24:27], v[180:183], v[44:47]
    s_waitcnt lgkmcnt(4)
    ds_read_b64_tr_b16 v[24:25], v16 offset:32768
    v_mfma_f32_16x16x32_bf16 v[48:51], v[28:31], v[176:179], v[48:51]
    ds_read_b64_tr_b16 v[26:27], v16 offset:34816
    buffer_load_dwordx4 v[124:127], v12, s[28:31], s48 offen offset:1024 sc1
    v_mfma_f32_16x16x32_bf16 v[52:55], v[28:31], v[180:183], v[52:55]
    s_waitcnt lgkmcnt(4)
    s_add_u32 s48, s48, 0x20000
    ds_read_b64_tr_b16 v[28:29], v17 offset:32768
    v_mfma_f32_16x16x32_bf16 v[56:59], v[32:35], v[176:179], v[56:59]
    ds_read_b64_tr_b16 v[30:31], v17 offset:34816
    v_mfma_f32_16x16x32_bf16 v[60:63], v[32:35], v[180:183], v[60:63]
    s_waitcnt lgkmcnt(4)
    ds_read_b64_tr_b16 v[32:33], v18 offset:32768
    v_mfma_f32_16x16x32_bf16 v[64:67], v[36:39], v[176:179], v[64:67]
    ds_read_b64_tr_b16 v[34:35], v18 offset:34816
    v_mfma_f32_16x16x32_bf16 v[68:71], v[36:39], v[180:183], v[68:71]
    s_waitcnt vmcnt(16) lgkmcnt(4)
    ds_read_b64_tr_b16 v[36:37], v19 offset:32768
    v_mfma_f32_16x16x32_bf16 v[40:43], v[24:27], v[184:187], v[40:43]
    ds_read_b64_tr_b16 v[38:39], v19 offset:34816
    buffer_load_dwordx4 v[128:131], v12, s[28:31], s48 offen offset:0 sc1
    v_mfma_f32_16x16x32_bf16 v[44:47], v[24:27], v[188:191], v[44:47]
    s_waitcnt lgkmcnt(4)
    ds_read_b64_tr_b16 v[24:25], v16 offset:36864
    v_mfma_f32_16x16x32_bf16 v[48:51], v[28:31], v[184:187], v[48:51]
    ds_read_b64_tr_b16 v[26:27], v16 offset:38912
    buffer_load_dwordx4 v[132:135], v12, s[28:31], s48 offen offset:1024 sc1
    v_mfma_f32_16x16x32_bf16 v[52:55], v[28:31], v[188:191], v[52:55]
    s_waitcnt lgkmcnt(4)
    s_add_u32 s48, s48, 0x20000
    ds_read_b64_tr_b16 v[28:29], v17 offset:36864
    v_mfma_f32_16x16x32_bf16 v[56:59], v[32:35], v[184:187], v[56:59]
    ds_read_b64_tr_b16 v[30:31], v17 offset:38912
    v_mfma_f32_16x16x32_bf16 v[60:63], v[32:35], v[188:191], v[60:63]
    s_waitcnt lgkmcnt(4)
    ds_read_b64_tr_b16 v[32:33], v18 offset:36864
    v_mfma_f32_16x16x32_bf16 v[64:67], v[36:39], v[184:187], v[64:67]
    ds_read_b64_tr_b16 v[34:35], v18 offset:38912
    v_mfma_f32_16x16x32_bf16 v[68:71], v[36:39], v[188:191], v[68:71]
    s_waitcnt vmcnt(16) lgkmcnt(4)
    ds_read_b64_tr_b16 v[36:37], v19 offset:36864
    v_mfma_f32_16x16x32_bf16 v[40:43], v[24:27], v[192:195], v[40:43]
    ds_read_b64_tr_b16 v[38:39], v19 offset:38912
    buffer_load_dwordx4 v[136:139], v12, s[28:31], s48 offen offset:0 sc1
    v_mfma_f32_16x16x32_bf16 v[44:47], v[24:27], v[196:199], v[44:47]
    s_waitcnt lgkmcnt(4)
    ds_read_b64_tr_b16 v[24:25], v16 offset:40960
    v_mfma_f32_16x16x32_bf16 v[48:51], v[28:31], v[192:195], v[48:51]
    ds_read_b64_tr_b16 v[26:27], v16 offset:43008
    buffer_load_dwordx4 v[140:143], v12, s[28:31], s48 offen offset:1024 sc1
    v_mfma_f32_16x16x32_bf16 v[52:55], v[28:31], v[196:199], v[52:55]
    s_waitcnt lgkmcnt(4)
    s_add_u32 s48, s48, 0x20000
    ds_read_b64_tr_b16 v[28:29], v17 offset:40960
    v_mfma_f32_16x16x32_bf16 v[56:59], v[32:35], v[192:195], v[56:59]
    ds_read_b64_tr_b16 v[30:31], v17 offset:43008
    v_mfma_f32_16x16x32_bf16 v[60:63], v[32:35], v[196:199], v[60:63]
    s_waitcnt lgkmcnt(4)
    ds_read_b64_tr_b16 v[32:33], v18 offset:40960
    v_mfma_f32_16x16x32_bf16 v[64:67], v[36:39], v[192:195], v[64:67]
    ds_read_b64_tr_b16 v[34:35], v18 offset:43008
    v_mfma_f32_16x16x32_bf16 v[68:71], v[36:39], v[196:199], v[68:71]
    s_waitcnt vmcnt(16) lgkmcnt(4)
    ds_read_b64_tr_b16 v[36:37], v19 offset:40960
    s_mov_b32 m0, s45
    v_mfma_f32_16x16x32_bf16 v[40:43], v[24:27], v[200:203], v[40:43]
    ds_read_b64_tr_b16 v[38:39], v19 offset:43008
    buffer_load_dwordx4 v[144:147], v12, s[28:31], s48 offen offset:0 sc1
    v_mfma_f32_16x16x32_bf16 v[44:47], v[24:27], v[204:207], v[44:47]
    s_waitcnt lgkmcnt(4)
    ds_read_b64_tr_b16 v[24:25], v16 offset:45056
    v_mfma_f32_16x16x32_bf16 v[48:51], v[28:31], v[200:203], v[48:51]
    ds_read_b64_tr_b16 v[26:27], v16 offset:47104
    buffer_load_dwordx4 v[148:151], v12, s[28:31], s48 offen offset:1024 sc1
    v_mfma_f32_16x16x32_bf16 v[52:55], v[28:31], v[204:207], v[52:55]
    s_waitcnt lgkmcnt(4)
    s_add_u32 s48, s48, 0x20000
    ds_read_b64_tr_b16 v[28:29], v17 offset:45056
    v_mfma_f32_16x16x32_bf16 v[56:59], v[32:35], v[200:203], v[56:59]
    ds_read_b64_tr_b16 v[30:31], v17 offset:47104
    buffer_load_dword v20, v253, s[24:27], s53 offen sc1
    v_mfma_f32_16x16x32_bf16 v[60:63], v[32:35], v[204:207], v[60:63]
    s_waitcnt lgkmcnt(4)
    ds_read_b64_tr_b16 v[32:33], v18 offset:45056
    v_mfma_f32_16x16x32_bf16 v[64:67], v[36:39], v[200:203], v[64:67]
    ds_read_b64_tr_b16 v[34:35], v18 offset:47104
    v_mfma_f32_16x16x32_bf16 v[68:71], v[36:39], v[204:207], v[68:71]
    s_waitcnt vmcnt(17) lgkmcnt(4)
    ds_read_b64_tr_b16 v[36:37], v19 offset:45056
    v_mfma_f32_16x16x32_bf16 v[40:43], v[24:27], v[208:211], v[40:43]
    ds_read_b64_tr_b16 v[38:39], v19 offset:47104
    buffer_load_dwordx4 v[152:155], v12, s[28:31], s48 offen offset:0 sc1
    v_mfma_f32_16x16x32_bf16 v[44:47], v[24:27], v[212:215], v[44:47]
    s_waitcnt lgkmcnt(4)
    ds_read_b64_tr_b16 v[24:25], v16 offset:49152
    v_mfma_f32_16x16x32_bf16 v[48:51], v[28:31], v[208:211], v[48:51]
    ds_read_b64_tr_b16 v[26:27], v16 offset:51200
    buffer_load_dwordx4 v[156:159], v12, s[28:31], s48 offen offset:1024 sc1
    v_mfma_f32_16x16x32_bf16 v[52:55], v[28:31], v[212:215], v[52:55]
    s_waitcnt lgkmcnt(4)
    s_add_u32 s48, s48, 0x20000
    ds_read_b64_tr_b16 v[28:29], v17 offset:49152
    v_mfma_f32_16x16x32_bf16 v[56:59], v[32:35], v[208:211], v[56:59]
    ds_read_b64_tr_b16 v[30:31], v17 offset:51200
    buffer_load_dwordx4 v6, s[20:23], 0 offen offset:0 lds
    v_mfma_f32_16x16x32_bf16 v[60:63], v[32:35], v[212:215], v[60:63]
    s_waitcnt lgkmcnt(4)
    ds_read_b64_tr_b16 v[32:33], v18 offset:49152
    v_mfma_f32_16x16x32_bf16 v[64:67], v[36:39], v[208:211], v[64:67]
    ds_read_b64_tr_b16 v[34:35], v18 offset:51200
    v_mfma_f32_16x16x32_bf16 v[68:71], v[36:39], v[212:215], v[68:71]
    s_waitcnt vmcnt(18) lgkmcnt(4)
    ds_read_b64_tr_b16 v[36:37], v19 offset:49152
    v_mfma_f32_16x16x32_bf16 v[40:43], v[24:27], v[216:219], v[40:43]
    ds_read_b64_tr_b16 v[38:39], v19 offset:51200
    buffer_load_dwordx4 v[160:163], v12, s[28:31], s48 offen offset:0 sc1
    v_mfma_f32_16x16x32_bf16 v[44:47], v[24:27], v[220:223], v[44:47]
    s_waitcnt lgkmcnt(4)
    ds_read_b64_tr_b16 v[24:25], v16 offset:53248
    v_mfma_f32_16x16x32_bf16 v[48:51], v[28:31], v[216:219], v[48:51]
    ds_read_b64_tr_b16 v[26:27], v16 offset:55296
    buffer_load_dwordx4 v[164:167], v12, s[28:31], s48 offen offset:1024 sc1
    v_mfma_f32_16x16x32_bf16 v[52:55], v[28:31], v[220:223], v[52:55]
    s_waitcnt lgkmcnt(4)
    s_add_u32 s48, s48, 0x20000
    ds_read_b64_tr_b16 v[28:29], v17 offset:53248
    v_mfma_f32_16x16x32_bf16 v[56:59], v[32:35], v[216:219], v[56:59]
    ds_read_b64_tr_b16 v[30:31], v17 offset:55296
    buffer_load_dwordx4 v7, s[20:23], 0 offen offset:1024 lds
    v_mfma_f32_16x16x32_bf16 v[60:63], v[32:35], v[220:223], v[60:63]
    s_waitcnt lgkmcnt(4)
    ds_read_b64_tr_b16 v[32:33], v18 offset:53248
    v_mfma_f32_16x16x32_bf16 v[64:67], v[36:39], v[216:219], v[64:67]
    ds_read_b64_tr_b16 v[34:35], v18 offset:55296
    v_mfma_f32_16x16x32_bf16 v[68:71], v[36:39], v[220:223], v[68:71]
    s_waitcnt vmcnt(19) lgkmcnt(4)
    ds_read_b64_tr_b16 v[36:37], v19 offset:53248
    v_mfma_f32_16x16x32_bf16 v[40:43], v[24:27], v[224:227], v[40:43]
    ds_read_b64_tr_b16 v[38:39], v19 offset:55296
    buffer_load_dwordx4 v[168:171], v12, s[28:31], s48 offen offset:0 sc1
    v_mfma_f32_16x16x32_bf16 v[44:47], v[24:27], v[228:231], v[44:47]
    s_waitcnt lgkmcnt(4)
    ds_read_b64_tr_b16 v[24:25], v16 offset:57344
    v_mfma_f32_16x16x32_bf16 v[48:51], v[28:31], v[224:227], v[48:51]
    ds_read_b64_tr_b16 v[26:27], v16 offset:59392
    buffer_load_dwordx4 v[172:175], v12, s[28:31], s48 offen offset:1024 sc1
    v_mfma_f32_16x16x32_bf16 v[52:55], v[28:31], v[228:231], v[52:55]
    s_waitcnt lgkmcnt(4)
    s_add_u32 s48, s48, 0x20000
    ds_read_b64_tr_b16 v[28:29], v17 offset:57344
    v_mfma_f32_16x16x32_bf16 v[56:59], v[32:35], v[224:227], v[56:59]
    ds_read_b64_tr_b16 v[30:31], v17 offset:59392
    buffer_load_dwordx4 v8, s[20:23], 0 offen offset:2048 lds
    v_mfma_f32_16x16x32_bf16 v[60:63], v[32:35], v[228:231], v[60:63]
    s_waitcnt lgkmcnt(4)
    ds_read_b64_tr_b16 v[32:33], v18 offset:57344
    v_mfma_f32_16x16x32_bf16 v[64:67], v[36:39], v[224:227], v[64:67]
    ds_read_b64_tr_b16 v[34:35], v18 offset:59392
    v_mfma_f32_16x16x32_bf16 v[68:71], v[36:39], v[228:231], v[68:71]
    s_waitcnt vmcnt(20) lgkmcnt(4)
    ds_read_b64_tr_b16 v[36:37], v19 offset:57344
    v_mfma_f32_16x16x32_bf16 v[40:43], v[24:27], v[232:235], v[40:43]
    ds_read_b64_tr_b16 v[38:39], v19 offset:59392
    buffer_load_dwordx4 v[176:179], v12, s[28:31], s48 offen offset:0 sc1
    v_mfma_f32_16x16x32_bf16 v[44:47], v[24:27], v[236:239], v[44:47]
    s_waitcnt lgkmcnt(4)
    ds_read_b64_tr_b16 v[24:25], v16 offset:61440
    v_mfma_f32_16x16x32_bf16 v[48:51], v[28:31], v[232:235], v[48:51]
    ds_read_b64_tr_b16 v[26:27], v16 offset:63488
    buffer_load_dwordx4 v[180:183], v12, s[28:31], s48 offen offset:1024 sc1
    v_mfma_f32_16x16x32_bf16 v[52:55], v[28:31], v[236:239], v[52:55]
    s_waitcnt lgkmcnt(4)
    s_add_u32 s48, s48, 0x20000
    ds_read_b64_tr_b16 v[28:29], v17 offset:61440
    v_mfma_f32_16x16x32_bf16 v[56:59], v[32:35], v[232:235], v[56:59]
    ds_read_b64_tr_b16 v[30:31], v17 offset:63488
    buffer_load_dwordx4 v9, s[20:23], 0 offen offset:3072 lds
    v_mfma_f32_16x16x32_bf16 v[60:63], v[32:35], v[236:239], v[60:63]
    s_waitcnt lgkmcnt(4)
    ds_read_b64_tr_b16 v[32:33], v18 offset:61440
    v_mfma_f32_16x16x32_bf16 v[64:67], v[36:39], v[232:235], v[64:67]
    ds_read_b64_tr_b16 v[34:35], v18 offset:63488
    v_mfma_f32_16x16x32_bf16 v[68:71], v[36:39], v[236:239], v[68:71]
    s_waitcnt vmcnt(21) lgkmcnt(4)
    ds_read_b64_tr_b16 v[36:37], v19 offset:61440
    v_mfma_f32_16x16x32_bf16 v[40:43], v[24:27], v[240:243], v[40:43]
    ds_read_b64_tr_b16 v[38:39], v19 offset:63488
    buffer_load_dwordx4 v[184:187], v12, s[28:31], s48 offen offset:0 sc1
    s_barrier
    v_xor_b32 v16, 0x10000, v16
    v_xor_b32 v17, 0x10000, v17
    v_xor_b32 v18, 0x10000, v18
    v_xor_b32 v19, 0x10000, v19
    v_mfma_f32_16x16x32_bf16 v[44:47], v[24:27], v[244:247], v[44:47]
    s_waitcnt lgkmcnt(4)
    ds_read_b64_tr_b16 v[24:25], v16 offset:0
    v_mfma_f32_16x16x32_bf16 v[48:51], v[28:31], v[240:243], v[48:51]
    ds_read_b64_tr_b16 v[26:27], v16 offset:2048
    buffer_load_dwordx4 v[188:191], v12, s[28:31], s48 offen offset:1024 sc1
    v_mfma_f32_16x16x32_bf16 v[52:55], v[28:31], v[244:247], v[52:55]
    s_waitcnt lgkmcnt(4)
    s_add_u32 s48, s48, 0x20000
    ds_read_b64_tr_b16 v[28:29], v17 offset:0
    v_mfma_f32_16x16x32_bf16 v[56:59], v[32:35], v[240:243], v[56:59]
    ds_read_b64_tr_b16 v[30:31], v17 offset:2048
    v_mfma_f32_16x16x32_bf16 v[60:63], v[32:35], v[244:247], v[60:63]
    s_waitcnt lgkmcnt(4)
    ds_read_b64_tr_b16 v[32:33], v18 offset:0
    v_mfma_f32_16x16x32_bf16 v[64:67], v[36:39], v[240:243], v[64:67]
    ds_read_b64_tr_b16 v[34:35], v18 offset:2048
    v_mfma_f32_16x16x32_bf16 v[68:71], v[36:39], v[244:247], v[68:71]
    s_waitcnt vmcnt(21) lgkmcnt(4)
    ds_read_b64_tr_b16 v[36:37], v19 offset:0
    v_mfma_f32_16x16x32_bf16 v[40:43], v[24:27], v[120:123], v[40:43]
    ds_read_b64_tr_b16 v[38:39], v19 offset:2048
    buffer_load_dwordx4 v[192:195], v12, s[28:31], s48 offen offset:0 sc1
    v_mfma_f32_16x16x32_bf16 v[44:47], v[24:27], v[124:127], v[44:47]
    s_waitcnt lgkmcnt(4)
    ds_read_b64_tr_b16 v[24:25], v16 offset:4096
    v_mfma_f32_16x16x32_bf16 v[48:51], v[28:31], v[120:123], v[48:51]
    ds_read_b64_tr_b16 v[26:27], v16 offset:6144
    buffer_load_dwordx4 v[196:199], v12, s[28:31], s48 offen offset:1024 sc1
    v_mfma_f32_16x16x32_bf16 v[52:55], v[28:31], v[124:127], v[52:55]
    s_waitcnt lgkmcnt(4)
    s_add_u32 s48, s48, 0x20000
    ds_read_b64_tr_b16 v[28:29], v17 offset:4096
    v_mfma_f32_16x16x32_bf16 v[56:59], v[32:35], v[120:123], v[56:59]
    ds_read_b64_tr_b16 v[30:31], v17 offset:6144
    v_mfma_f32_16x16x32_bf16 v[60:63], v[32:35], v[124:127], v[60:63]
    s_waitcnt lgkmcnt(4)
    ds_read_b64_tr_b16 v[32:33], v18 offset:4096
    v_mfma_f32_16x16x32_bf16 v[64:67], v[36:39], v[120:123], v[64:67]
    ds_read_b64_tr_b16 v[34:35], v18 offset:6144
    v_mfma_f32_16x16x32_bf16 v[68:71], v[36:39], v[124:127], v[68:71]
    s_waitcnt vmcnt(21) lgkmcnt(4)
    ds_read_b64_tr_b16 v[36:37], v19 offset:4096
    v_mfma_f32_16x16x32_bf16 v[40:43], v[24:27], v[128:131], v[40:43]
    ds_read_b64_tr_b16 v[38:39], v19 offset:6144
    buffer_load_dwordx4 v[200:203], v12, s[28:31], s48 offen offset:0 sc1
    v_mfma_f32_16x16x32_bf16 v[44:47], v[24:27], v[132:135], v[44:47]
    s_waitcnt lgkmcnt(4)
    ds_read_b64_tr_b16 v[24:25], v16 offset:8192
    v_mfma_f32_16x16x32_bf16 v[48:51], v[28:31], v[128:131], v[48:51]
    ds_read_b64_tr_b16 v[26:27], v16 offset:10240
    buffer_load_dwordx4 v[204:207], v12, s[28:31], s48 offen offset:1024 sc1
    v_mfma_f32_16x16x32_bf16 v[52:55], v[28:31], v[132:135], v[52:55]
    s_waitcnt lgkmcnt(4)
    s_add_u32 s48, s48, 0x20000
    ds_read_b64_tr_b16 v[28:29], v17 offset:8192
    v_mfma_f32_16x16x32_bf16 v[56:59], v[32:35], v[128:131], v[56:59]
    ds_read_b64_tr_b16 v[30:31], v17 offset:10240
    v_mfma_f32_16x16x32_bf16 v[60:63], v[32:35], v[132:135], v[60:63]
    s_waitcnt lgkmcnt(4)
    ds_read_b64_tr_b16 v[32:33], v18 offset:8192
    v_mfma_f32_16x16x32_bf16 v[64:67], v[36:39], v[128:131], v[64:67]
    ds_read_b64_tr_b16 v[34:35], v18 offset:10240
    v_mfma_f32_16x16x32_bf16 v[68:71], v[36:39], v[132:135], v[68:71]
    s_waitcnt vmcnt(21) lgkmcnt(4)
    ds_read_b64_tr_b16 v[36:37], v19 offset:8192
    v_mfma_f32_16x16x32_bf16 v[40:43], v[24:27], v[136:139], v[40:43]
    ds_read_b64_tr_b16 v[38:39], v19 offset:10240
    buffer_load_dwordx4 v[208:211], v12, s[28:31], s48 offen offset:0 sc1
    v_mfma_f32_16x16x32_bf16 v[44:47], v[24:27], v[140:143], v[44:47]
    s_waitcnt lgkmcnt(4)
    ds_read_b64_tr_b16 v[24:25], v16 offset:12288
    v_mfma_f32_16x16x32_bf16 v[48:51], v[28:31], v[136:139], v[48:51]
    ds_read_b64_tr_b16 v[26:27], v16 offset:14336
    buffer_load_dwordx4 v[212:215], v12, s[28:31], s48 offen offset:1024 sc1
    v_mfma_f32_16x16x32_bf16 v[52:55], v[28:31], v[140:143], v[52:55]
    s_waitcnt lgkmcnt(4)
    s_add_u32 s48, s48, 0x20000
    ds_read_b64_tr_b16 v[28:29], v17 offset:12288
    v_mfma_f32_16x16x32_bf16 v[56:59], v[32:35], v[136:139], v[56:59]
    ds_read_b64_tr_b16 v[30:31], v17 offset:14336
    v_mfma_f32_16x16x32_bf16 v[60:63], v[32:35], v[140:143], v[60:63]
    s_waitcnt lgkmcnt(4)
    ds_read_b64_tr_b16 v[32:33], v18 offset:12288
    v_mfma_f32_16x16x32_bf16 v[64:67], v[36:39], v[136:139], v[64:67]
    ds_read_b64_tr_b16 v[34:35], v18 offset:14336
    v_mfma_f32_16x16x32_bf16 v[68:71], v[36:39], v[140:143], v[68:71]
    s_waitcnt vmcnt(21) lgkmcnt(4)
    ds_read_b64_tr_b16 v[36:37], v19 offset:12288
    v_mfma_f32_16x16x32_bf16 v[40:43], v[24:27], v[144:147], v[40:43]
    ds_read_b64_tr_b16 v[38:39], v19 offset:14336
    buffer_load_dwordx4 v[216:219], v12, s[28:31], s48 offen offset:0 sc1
    v_mfma_f32_16x16x32_bf16 v[44:47], v[24:27], v[148:151], v[44:47]
    s_waitcnt lgkmcnt(4)
    ds_read_b64_tr_b16 v[24:25], v16 offset:16384
    v_mfma_f32_16x16x32_bf16 v[48:51], v[28:31], v[144:147], v[48:51]
    ds_read_b64_tr_b16 v[26:27], v16 offset:18432
    buffer_load_dwordx4 v[220:223], v12, s[28:31], s48 offen offset:1024 sc1
    v_mfma_f32_16x16x32_bf16 v[52:55], v[28:31], v[148:151], v[52:55]
    s_waitcnt lgkmcnt(4)
    s_add_u32 s48, s48, 0x20000
    ds_read_b64_tr_b16 v[28:29], v17 offset:16384
    v_mfma_f32_16x16x32_bf16 v[56:59], v[32:35], v[144:147], v[56:59]
    ds_read_b64_tr_b16 v[30:31], v17 offset:18432
    v_mfma_f32_16x16x32_bf16 v[60:63], v[32:35], v[148:151], v[60:63]
    s_waitcnt lgkmcnt(4)
    ds_read_b64_tr_b16 v[32:33], v18 offset:16384
    v_mfma_f32_16x16x32_bf16 v[64:67], v[36:39], v[144:147], v[64:67]
    ds_read_b64_tr_b16 v[34:35], v18 offset:18432
    v_mfma_f32_16x16x32_bf16 v[68:71], v[36:39], v[148:151], v[68:71]
    s_waitcnt vmcnt(20) lgkmcnt(4)
    ds_read_b64_tr_b16 v[36:37], v19 offset:16384
    v_mfma_f32_16x16x32_bf16 v[40:43], v[24:27], v[152:155], v[40:43]
    ds_read_b64_tr_b16 v[38:39], v19 offset:18432
    buffer_load_dwordx4 v[224:227], v12, s[28:31], s48 offen offset:0 sc1
    v_mfma_f32_16x16x32_bf16 v[44:47], v[24:27], v[156:159], v[44:47]
    s_waitcnt lgkmcnt(4)
    ds_read_b64_tr_b16 v[24:25], v16 offset:20480
    v_mfma_f32_16x16x32_bf16 v[48:51], v[28:31], v[152:155], v[48:51]
    ds_read_b64_tr_b16 v[26:27], v16 offset:22528
    buffer_load_dwordx4 v[228:231], v12, s[28:31], s48 offen offset:1024 sc1
    v_mfma_f32_16x16x32_bf16 v[52:55], v[28:31], v[156:159], v[52:55]
    s_waitcnt lgkmcnt(4)
    s_add_u32 s48, s48, 0x20000
    ds_read_b64_tr_b16 v[28:29], v17 offset:20480
    v_mfma_f32_16x16x32_bf16 v[56:59], v[32:35], v[152:155], v[56:59]
    ds_read_b64_tr_b16 v[30:31], v17 offset:22528
    v_mfma_f32_16x16x32_bf16 v[60:63], v[32:35], v[156:159], v[60:63]
    s_waitcnt lgkmcnt(4)
    ds_read_b64_tr_b16 v[32:33], v18 offset:20480
    v_mfma_f32_16x16x32_bf16 v[64:67], v[36:39], v[152:155], v[64:67]
    ds_read_b64_tr_b16 v[34:35], v18 offset:22528
    v_mfma_f32_16x16x32_bf16 v[68:71], v[36:39], v[156:159], v[68:71]
    s_waitcnt vmcnt(19) lgkmcnt(4)
    ds_read_b64_tr_b16 v[36:37], v19 offset:20480
    v_cmp_eq_u32 vcc, 0, v20
    s_mov_b32 m0, s59
    s_cmp_eq_u64 vcc, 0
    s_cbranch_scc1 K4_XOK
    s_mov_b32 s60, 0x200000
POLL_X:
    buffer_load_dword v20, v253, s[24:27], s53 offen sc1
    s_sub_u32 s60, s60, 1
    s_waitcnt vmcnt(0)
    v_cmp_eq_u32 vcc, 0, v20
    s_cmp_eq_u32 s60, 0
    s_cbranch_scc1 POLLX_X
    s_cmp_eq_u64 vcc, 0
    s_cbranch_scc1 POLLX_X
    s_sleep 4
    s_branch POLL_X
POLLX_X:
K4_XOK:
    v_mov_b64 v[20:21], -1
    v_mov_b64 v[22:23], -1
    v_mfma_f32_16x16x32_bf16 v[40:43], v[24:27], v[160:163], v[40:43]
    ds_read_b64_tr_b16 v[38:39], v19 offset:22528
    buffer_load_dwordx4 v[232:235], v12, s[28:31], s48 offen offset:0 sc1
    v_mfma_f32_16x16x32_bf16 v[44:47], v[24:27], v[164:167], v[44:47]
    s_waitcnt lgkmcnt(4)
    ds_read_b64_tr_b16 v[24:25], v16 offset:24576
    v_mfma_f32_16x16x32_bf16 v[48:51], v[28:31], v[160:163], v[48:51]
    ds_read_b64_tr_b16 v[26:27], v16 offset:26624
    buffer_load_dwordx4 v[236:239], v12, s[28:31], s48 offen offset:1024 sc1
    v_mfma_f32_16x16x32_bf16 v[52:55], v[28:31], v[164:167], v[52:55]
    s_waitcnt lgkmcnt(4)
    s_add_u32 s48, s48, 0x20000
    ds_read_b64_tr_b16 v[28:29], v17 offset:24576
    v_mfma_f32_16x16x32_bf16 v[56:59], v[32:35], v[160:163], v[56:59]
    ds_read_b64_tr_b16 v[30:31], v17 offset:26624
    buffer_load_dword v104, v10, s[24:27], s54 offen sc1
    v_mfma_f32_16x16x32_bf16 v[60:63], v[32:35], v[164:167], v[60:63]
    s_waitcnt lgkmcnt(4)
    ds_read_b64_tr_b16 v[32:33], v18 offset:24576
    v_mfma_f32_16x16x32_bf16 v[64:67], v[36:39], v[160:163], v[64:67]
    ds_read_b64_tr_b16 v[34:35], v18 offset:26624
    buffer_load_dword v105, v10, s[24:27], s55 offen sc1
    v_mfma_f32_16x16x32_bf16 v[68:71], v[36:39], v[164:167], v[68:71]
    s_waitcnt vmcnt(20) lgkmcnt(4)
    ds_read_b64_tr_b16 v[36:37], v19 offset:24576
    v_mfma_f32_16x16x32_bf16 v[40:43], v[24:27], v[168:171], v[40:43]
    ds_read_b64_tr_b16 v[38:39], v19 offset:26624
    buffer_load_dwordx4 v[240:243], v12, s[28:31], s48 offen offset:0 sc1
    v_mfma_f32_16x16x32_bf16 v[44:47], v[24:27], v[172:175], v[44:47]
    s_waitcnt lgkmcnt(4)
    ds_read_b64_tr_b16 v[24:25], v16 offset:28672
    v_mfma_f32_16x16x32_bf16 v[48:51], v[28:31], v[168:171], v[48:51]
    ds_read_b64_tr_b16 v[26:27], v16 offset:30720
    buffer_load_dwordx4 v[244:247], v12, s[28:31], s48 offen offset:1024 sc1
    v_mfma_f32_16x16x32_bf16 v[52:55], v[28:31], v[172:175], v[52:55]
    s_waitcnt lgkmcnt(4)
    s_add_u32 s48, s48, 0x20000
    ds_read_b64_tr_b16 v[28:29], v17 offset:28672
    v_mfma_f32_16x16x32_bf16 v[56:59], v[32:35], v[168:171], v[56:59]
    ds_read_b64_tr_b16 v[30:31], v17 offset:30720
    buffer_load_dword v106, v10, s[24:27], s56 offen sc1
    v_mfma_f32_16x16x32_bf16 v[60:63], v[32:35], v[172:175], v[60:63]
    s_waitcnt lgkmcnt(4)
    ds_read_b64_tr_b16 v[32:33], v18 offset:28672
    v_mfma_f32_16x16x32_bf16 v[64:67], v[36:39], v[168:171], v[64:67]
    ds_read_b64_tr_b16 v[34:35], v18 offset:30720
    buffer_load_dword v107, v10, s[24:27], s57 offen sc1
    v_mfma_f32_16x16x32_bf16 v[68:71], v[36:39], v[172:175], v[68:71]
    s_waitcnt vmcnt(21) lgkmcnt(4)
    ds_read_b64_tr_b16 v[36:37], v19 offset:28672
    v_mfma_f32_16x16x32_bf16 v[40:43], v[24:27], v[176:179], v[40:43]
    ds_read_b64_tr_b16 v[38:39], v19 offset:30720
    buffer_load_dword v108, v11, s[24:27], s54 offen sc1
    v_mfma_f32_16x16x32_bf16 v[44:47], v[24:27], v[180:183], v[44:47]
    s_waitcnt lgkmcnt(4)
    ds_read_b64_tr_b16 v[24:25], v16 offset:32768
    v_mfma_f32_16x16x32_bf16 v[48:51], v[28:31], v[176:179], v[48:51]
    ds_read_b64_tr_b16 v[26:27], v16 offset:34816
    buffer_load_dword v109, v11, s[24:27], s55 offen sc1
    v_mfma_f32_16x16x32_bf16 v[52:55], v[28:31], v[180:183], v[52:55]
    s_waitcnt lgkmcnt(4)
    ds_read_b64_tr_b16 v[28:29], v17 offset:32768
    v_mfma_f32_16x16x32_bf16 v[56:59], v[32:35], v[176:179], v[56:59]
    ds_read_b64_tr_b16 v[30:31], v17 offset:34816
    buffer_load_dword v110, v11, s[24:27], s56 offen sc1
    v_mfma_f32_16x16x32_bf16 v[60:63], v[32:35], v[180:183], v[60:63]
    s_waitcnt lgkmcnt(4)
    ds_read_b64_tr_b16 v[32:33], v18 offset:32768
    v_mfma_f32_16x16x32_bf16 v[64:67], v[36:39], v[176:179], v[64:67]
    ds_read_b64_tr_b16 v[34:35], v18 offset:34816
    buffer_load_dword v111, v11, s[24:27], s57 offen sc1
    v_mfma_f32_16x16x32_bf16 v[68:71], v[36:39], v[180:183], v[68:71]
    s_waitcnt vmcnt(22) lgkmcnt(4)
    ds_read_b64_tr_b16 v[36:37], v19 offset:32768
    v_mfma_f32_16x16x32_bf16 v[40:43], v[24:27], v[184:187], v[40:43]
    ds_read_b64_tr_b16 v[38:39], v19 offset:34816
    buffer_load_dword v112, v3, s[24:27], s54 offen sc1
    v_mfma_f32_16x16x32_bf16 v[44:47], v[24:27], v[188:191], v[44:47]
    s_waitcnt lgkmcnt(4)
    ds_read_b64_tr_b16 v[24:25], v16 offset:36864
    v_mfma_f32_16x16x32_bf16 v[48:51], v[28:31], v[184:187], v[48:51]
    ds_read_b64_tr_b16 v[26:27], v16 offset:38912
    buffer_load_dword v113, v3, s[24:27], s55 offen sc1
    v_mfma_f32_16x16x32_bf16 v[52:55], v[28:31], v[188:191], v[52:55]
    s_waitcnt lgkmcnt(4)
    ds_read_b64_tr_b16 v[28:29], v17 offset:36864
    v_mfma_f32_16x16x32_bf16 v[56:59], v[32:35], v[184:187], v[56:59]
    ds_read_b64_tr_b16 v[30:31], v17 offset:38912
    buffer_load_dword v114, v3, s[24:27], s56 offen sc1
    v_mfma_f32_16x16x32_bf16 v[60:63], v[32:35], v[188:191], v[60:63]
    s_waitcnt lgkmcnt(4)
    ds_read_b64_tr_b16 v[32:33], v18 offset:36864
    v_mfma_f32_16x16x32_bf16 v[64:67], v[36:39], v[184:187], v[64:67]
    ds_read_b64_tr_b16 v[34:35], v18 offset:38912
    buffer_load_dword v115, v3, s[24:27], s57 offen sc1
    v_mfma_f32_16x16x32_bf16 v[68:71], v[36:39], v[188:191], v[68:71]
    s_waitcnt vmcnt(24) lgkmcnt(4)
    ds_read_b64_tr_b16 v[36:37], v19 offset:36864
    v_mfma_f32_16x16x32_bf16 v[40:43], v[24:27], v[192:195], v[40:43]
    ds_read_b64_tr_b16 v[38:39], v19 offset:38912
    buffer_load_dwordx4 v252, s[16:19], s58 offen sc1 lds
    s_add_u32 m0, m0, 4096
    s_add_u32 s58, s58, 4096
    v_mfma_f32_16x16x32_bf16 v[44:47], v[24:27], v[196:199], v[44:47]
    s_waitcnt lgkmcnt(4)
    ds_read_b64_tr_b16 v[24:25], v16 offset:40960
    v_mfma_f32_16x16x32_bf16 v[48:51], v[28:31], v[192:195], v[48:51]
    ds_read_b64_tr_b16 v[26:27], v16 offset:43008
    buffer_load_dwordx4 v252, s[16:19], s58 offen sc1 lds
    s_add_u32 m0, m0, 4096
    s_add_u32 s58, s58, 4096
    v_mfma_f32_16x16x32_bf16 v[52:55], v[28:31], v[196:199], v[52:55]
    s_waitcnt lgkmcnt(4)
    ds_read_b64_tr_b16 v[28:29], v17 offset:40960
    v_mfma_f32_16x16x32_bf16 v[56:59], v[32:35], v[192:195], v[56:59]
    ds_read_b64_tr_b16 v[30:31], v17 offset:43008
    buffer_load_dwordx4 v252, s[16:19], s58 offen sc1 lds
    s_add_u32 m0, m0, 4096
    s_add_u32 s58, s58, 4096
    v_mfma_f32_16x16x32_bf16 v[60:63], v[32:35], v[196:199], v[60:63]
    s_waitcnt lgkmcnt(4)
    ds_read_b64_tr_b16 v[32:33], v18 offset:40960
    v_mfma_f32_16x16x32_bf16 v[64:67], v[36:39], v[192:195], v[64:67]
    ds_read_b64_tr_b16 v[34:35], v18 offset:43008
    buffer_load_dwordx4 v252, s[16:19], s58 offen sc1 lds
    s_add_u32 m0, m0, 4096
    s_add_u32 s58, s58, 4096
    v_mfma_f32_16x16x32_bf16 v[68:71], v[36:39], v[196:199], v[68:71]
    s_waitcnt vmcnt(26) lgkmcnt(4)
    ds_read_b64_tr_b16 v[36:37], v19 offset:40960
    v_mfma_f32_16x16x32_bf16 v[40:43], v[24:27], v[200:203], v[40:43]
    ds_read_b64_tr_b16 v[38:39], v19 offset:43008
    buffer_load_dwordx4 v252, s[16:19], s58 offen sc1 lds
    s_add_u32 m0, m0, 4096
    s_add_u32 s58, s58, 4096
    v_mfma_f32_16x16x32_bf16 v[44:47], v[24:27], v[204:207], v[44:47]
    s_waitcnt lgkmcnt(4)
    ds_read_b64_tr_b16 v[24:25], v16 offset:45056
    v_mfma_f32_16x16x32_bf16 v[48:51], v[28:31], v[200:203], v[48:51]
    ds_read_b64_tr_b16 v[26:27], v16 offset:47104
    buffer_load_dwordx4 v252, s[16:19], s58 offen sc1 lds
    s_add_u32 m0, m0, 4096
    s_add_u32 s58, s58, 4096
    v_mfma_f32_16x16x32_bf16 v[52:55], v[28:31], v[204:207], v[52:55]
    s_waitcnt lgkmcnt(4)
    ds_read_b64_tr_b16 v[28:29], v17 offset:45056
    v_mfma_f32_16x16x32_bf16 v[56:59], v[32:35], v[200:203], v[56:59]
    ds_read_b64_tr_b16 v[30:31], v17 offset:47104
    buffer_load_dwordx4 v252, s[16:19], s58 offen sc1 lds
    s_add_u32 m0, m0, 4096
    s_add_u32 s58, s58, 4096
    s_cmp_eq_u32 s58, 229376
    s_cselect_b32 s58, 0, s58
    v_mfma_f32_16x16x32_bf16 v[60:63], v[32:35], v[204:207], v[60:63]
    s_waitcnt lgkmcnt(4)
    ds_read_b64_tr_b16 v[32:33], v18 offset:45056
    v_mfma_f32_16x16x32_bf16 v[64:67], v[36:39], v[200:203], v[64:67]
    ds_read_b64_tr_b16 v[34:35], v18 offset:47104
    buffer_load_dwordx4 v252, s[16:19], s58 offen sc1 lds
    s_add_u32 m0, m0, 4096
    s_add_u32 s58, s58, 4096
    v_mfma_f32_16x16x32_bf16 v[68:71], v[36:39], v[204:207], v[68:71]
    s_waitcnt vmcnt(28) lgkmcnt(4)
    ds_read_b64_tr_b16 v[36:37], v19 offset:45056
    v_mfma_f32_16x16x32_bf16 v[40:43], v[24:27], v[208:211], v[40:43]
    ds_read_b64_tr_b16 v[38:39], v19 offset:47104
    buffer_load_dwordx4 v252, s[16:19], s58 offen sc1 lds
    s_add_u32 m0, m0, 4096
    s_add_u32 s58, s58, 4096
    v_mfma_f32_16x16x32_bf16 v[44:47], v[24:27], v[212:215], v[44:47]
    s_waitcnt lgkmcnt(4)
    ds_read_b64_tr_b16 v[24:25], v16 offset:49152
    v_mfma_f32_16x16x32_bf16 v[48:51], v[28:31], v[208:211], v[48:51]
    ds_read_b64_tr_b16 v[26:27], v16 offset:51200
    buffer_load_dwordx4 v252, s[16:19], s58 offen sc1 lds
    s_add_u32 m0, m0, 4096
    s_add_u32 s58, s58, 4096
    v_mfma_f32_16x16x32_bf16 v[52:55], v[28:31], v[212:215], v[52:55]
    s_waitcnt lgkmcnt(4)
    ds_read_b64_tr_b16 v[28:29], v17 offset:49152
    v_mfma_f32_16x16x32_bf16 v[56:59], v[32:35], v[208:211], v[56:59]
    ds_read_b64_tr_b16 v[30:31], v17 offset:51200
    buffer_load_dwordx4 v252, s[16:19], s58 offen sc1 lds
    s_add_u32 m0, m0, 4096
    s_add_u32 s58, s58, 4096
    v_mfma_f32_16x16x32_bf16 v[60:63], v[32:35], v[212:215], v[60:63]
    s_waitcnt lgkmcnt(4)
    ds_read_b64_tr_b16 v[32:33], v18 offset:49152
    v_mfma_f32_16x16x32_bf16 v[64:67], v[36:39], v[208:211], v[64:67]
    ds_read_b64_tr_b16 v[34:35], v18 offset:51200
    buffer_load_dwordx4 v252, s[16:19], s58 offen sc1 lds
    s_add_u32 m0, m0, 4096
    s_add_u32 s58, s58, 4096
    v_mfma_f32_16x16x32_bf16 v[68:71], v[36:39], v[212:215], v[68:71]
    s_waitcnt vmcnt(30) lgkmcnt(4)
    ds_read_b64_tr_b16 v[36:37], v19 offset:49152
    v_mfma_f32_16x16x32_bf16 v[40:43], v[24:27], v[216:219], v[40:43]
    ds_read_b64_tr_b16 v[38:39], v19 offset:51200
    buffer_load_dwordx4 v252, s[16:19], s58 offen sc1 lds
    s_add_u32 m0, m0, 4096
    s_add_u32 s58, s58, 4096
    v_mfma_f32_16x16x32_bf16 v[44:47], v[24:27], v[220:223], v[44:47]
    s_waitcnt lgkmcnt(4)
    ds_read_b64_tr_b16 v[24:25], v16 offset:53248
    v_mfma_f32_16x16x32_bf16 v[48:51], v[28:31], v[216:219], v[48:51]
    ds_read_b64_tr_b16 v[26:27], v16 offset:55296
    buffer_load_dwordx4 v252, s[16:19], s58 offen sc1 lds
    s_add_u32 m0, m0, 4096
    s_add_u32 s58, s58, 4096
    s_cmp_eq_u32 s58, 229376
    s_cselect_b32 s58, 0, s58
    v_mfma_f32_16x16x32_bf16 v[52:55], v[28:31], v[220:223], v[52:55]
    s_waitcnt lgkmcnt(4)
    ds_read_b64_tr_b16 v[28:29], v17 offset:53248
    v_mfma_f32_16x16x32_bf16 v[56:59], v[32:35], v[216:219], v[56:59]
    ds_read_b64_tr_b16 v[30:31], v17 offset:55296
    buffer_store_dwordx4 v[20:23], v2, s[24:27], s44 offen offset:0 sc1
    v_mfma_f32_16x16x32_bf16 v[60:63], v[32:35], v[220:223], v[60:63]
    s_waitcnt lgkmcnt(4)
    ds_read_b64_tr_b16 v[32:33], v18 offset:53248
    v_mfma_f32_16x16x32_bf16 v[64:67], v[36:39], v[216:219], v[64:67]
    ds_read_b64_tr_b16 v[34:35], v18 offset:55296
    buffer_store_dwordx4 v[20:23], v2, s[24:27], s44 offen offset:1024 sc1
    v_mfma_f32_16x16x32_bf16 v[68:71], v[36:39], v[220:223], v[68:71]
    s_waitcnt vmcnt(32) lgkmcnt(4)
    ds_read_b64_tr_b16 v[36:37], v19 offset:53248
    v_mfma_f32_16x16x32_bf16 v[40:43], v[24:27], v[224:227], v[40:43]
    ds_read_b64_tr_b16 v[38:39], v19 offset:55296
    buffer_store_dwordx4 v[20:23], v2, s[24:27], s44 offen offset:2048 sc1
    v_mfma_f32_16x16x32_bf16 v[44:47], v[24:27], v[228:231], v[44:47]
    s_waitcnt lgkmcnt(4)
    ds_read_b64_tr_b16 v[24:25], v16 offset:57344
    v_mfma_f32_16x16x32_bf16 v[48:51], v[28:31], v[224:227], v[48:51]
    ds_read_b64_tr_b16 v[26:27], v16 offset:59392
    buffer_store_dwordx4 v[20:23], v2, s[24:27], s44 offen offset:3072 sc1
    v_mfma_f32_16x16x32_bf16 v[52:55], v[28:31], v[228:231], v[52:55]
    s_waitcnt lgkmcnt(4)
    ds_read_b64_tr_b16 v[28:29], v17 offset:57344
    v_mfma_f32_16x16x32_bf16 v[56:59], v[32:35], v[224:227], v[56:59]
    ds_read_b64_tr_b16 v[30:31], v17 offset:59392
    v_mfma_f32_16x16x32_bf16 v[60:63], v[32:35], v[228:231], v[60:63]
    s_waitcnt lgkmcnt(4)
    ds_read_b64_tr_b16 v[32:33], v18 offset:57344
    v_mfma_f32_16x16x32_bf16 v[64:67], v[36:39], v[224:227], v[64:67]
    ds_read_b64_tr_b16 v[34:35], v18 offset:59392
    v_mfma_f32_16x16x32_bf16 v[68:71], v[36:39], v[228:231], v[68:71]
    s_waitcnt vmcnt(32) lgkmcnt(4)
    ds_read_b64_tr_b16 v[36:37], v19 offset:57344
    v_mfma_f32_16x16x32_bf16 v[40:43], v[24:27], v[232:235], v[40:43]
    ds_read_b64_tr_b16 v[38:39], v19 offset:59392
    v_mfma_f32_16x16x32_bf16 v[44:47], v[24:27], v[236:239], v[44:47]
    s_waitcnt lgkmcnt(4)
    ds_read_b64_tr_b16 v[24:25], v16 offset:61440
    v_mfma_f32_16x16x32_bf16 v[48:51], v[28:31], v[232:235], v[48:51]
    ds_read_b64_tr_b16 v[26:27], v16 offset:63488
    v_mfma_f32_16x16x32_bf16 v[52:55], v[28:31], v[236:239], v[52:55]
    s_waitcnt lgkmcnt(4)
    ds_read_b64_tr_b16 v[28:29], v17 offset:61440
    v_mfma_f32_16x16x32_bf16 v[56:59], v[32:35], v[232:235], v[56:59]
    ds_read_b64_tr_b16 v[30:31], v17 offset:63488
    v_mfma_f32_16x16x32_bf16 v[60:63], v[32:35], v[236:239], v[60:63]
    s_waitcnt lgkmcnt(4)
    ds_read_b64_tr_b16 v[32:33], v18 offset:61440
    v_mfma_f32_16x16x32_bf16 v[64:67], v[36:39], v[232:235], v[64:67]
    ds_read_b64_tr_b16 v[34:35], v18 offset:63488
    v_mfma_f32_16x16x32_bf16 v[68:71], v[36:39], v[236:239], v[68:71]
    s_waitcnt vmcnt(28) lgkmcnt(4)
    ds_read_b64_tr_b16 v[36:37], v19 offset:61440
    v_mfma_f32_16x16x32_bf16 v[40:43], v[24:27], v[240:243], v[40:43]
    ds_read_b64_tr_b16 v[38:39], v19 offset:63488
    v_mfma_f32_16x16x32_bf16 v[44:47], v[24:27], v[244:247], v[44:47]
    s_waitcnt lgkmcnt(4)
    v_mfma_f32_16x16x32_bf16 v[48:51], v[28:31], v[240:243], v[48:51]
    v_mfma_f32_16x16x32_bf16 v[52:55], v[28:31], v[244:247], v[52:55]
    s_waitcnt lgkmcnt(2)
    v_mfma_f32_16x16x32_bf16 v[56:59], v[32:35], v[240:243], v[56:59]
    v_mfma_f32_16x16x32_bf16 v[60:63], v[32:35], v[244:247], v[60:63]
    s_waitcnt lgkmcnt(0)
    v_mfma_f32_16x16x32_bf16 v[64:67], v[36:39], v[240:243], v[64:67]
    v_mfma_f32_16x16x32_bf16 v[68:71], v[36:39], v[244:247], v[68:71]
    v_and_b32 v5, 15, v1
    v_lshrrev_b32 v4, 1, v15
    v_xor_b32 v4, v4, v5
    v_and_b32 v4, 7, v4
    v_lshlrev_b32 v14, 7, v5
    v_lshl_add_u32 v14, v4, 4, v14
    v_and_b32 v4, 1, v15
    v_lshl_add_u32 v14, v4, 3, v14
    v_add_u32 v16, s45, v14
    v_xor_b32 v17, 32, v16
    v_xor_b32 v18, 64, v16
    v_xor_b32 v19, 96, v16
    ds_read_b64 v[120:121], v16 offset:0
    ds_read_b64 v[122:123], v17 offset:0
    ds_read_b64 v[124:125], v18 offset:0
    ds_read_b64 v[126:127], v19 offset:0
    ds_read_b64 v[128:129], v16 offset:2048
    ds_read_b64 v[130:131], v17 offset:2048
    ds_read_b64 v[132:133], v18 offset:2048
    ds_read_b64 v[134:135], v19 offset:2048
    v_lshlrev_b32 v21, 2, v1
    v_add_u32 v21, s45, v21
    v_lshlrev_b32 v22, 4, v15
    v_add_u32 v22, s45, v22
    s_waitcnt vmcnt(18)
    v_add_f32 v104, v104, v105
    v_add_f32 v106, v106, v107
    v_add_f32 v104, v104, v106
    v_cvt_pk_bf16_f32 v104, v104, v104
    v_and_b32 v104, 0xffff0000, v104
    v_add_f32 v108, v108, v109
    v_add_f32 v110, v110, v111
    v_add_f32 v108, v108, v110
    v_cvt_pk_bf16_f32 v108, v108, v108
    v_and_b32 v108, 0xffff0000, v108
    v_add_f32 v112, v112, v113
    v_add_f32 v114, v114, v115
    v_add_f32 v112, v112, v114
    v_cvt_pk_bf16_f32 v112, v112, v112
    v_and_b32 v112, 0xffff0000, v112
    ds_write_b32 v21, v104 offset:4096
    v_add_f32 v108, 1.0, v108
    v_cvt_pk_bf16_f32 v108, v108, v108
    v_and_b32 v108, 0xffff0000, v108
    ds_write_b32 v21, v108 offset:4352
    v_cmp_gt_u32 vcc, 32, v1
    v_add_f32 v113, 1.0, v112
    v_lshlrev_b32 v23, 1, v1
    v_cndmask_b32 v112, v112, v113, vcc
    v_add_u32 v23, s45, v23
    v_cvt_pk_bf16_f32 v112, v112, v112
    ds_write_b16 v23, v112 offset:4608
    s_waitcnt lgkmcnt(0)
    ds_read_b128 v[72:75], v22 offset:4096
    ds_read_b128 v[76:79], v22 offset:4160
    ds_read_b128 v[80:83], v22 offset:4224
    ds_read_b128 v[84:87], v22 offset:4288
    ds_read_b128 v[88:91], v22 offset:4352
    ds_read_b128 v[92:95], v22 offset:4416
    ds_read_b128 v[96:99], v22 offset:4480
    ds_read_b128 v[100:103], v22 offset:4544
    s_lshl_b32 s42, s41, 18
    s_add_u32 s42, s42, 0x1400000
    s_add_u32 s46, s42, 0x20000
    s_waitcnt lgkmcnt(0)
    v_lshlrev_b32 v136, 16, v120
    v_and_b32 v137, 0xffff0000, v120
    v_lshlrev_b32 v138, 16, v121
    v_and_b32 v139, 0xffff0000, v121
    v_pk_fma_f32 v[40:41], v[40:41], v[72:73], v[136:137]
    v_pk_fma_f32 v[42:43], v[42:43], v[74:75], v[138:139]
    v_cvt_pk_bf16_f32 v144, v40, v41
    v_cvt_pk_bf16_f32 v145, v42, v43
    v_lshlrev_b32 v40, 16, v144
    v_and_b32 v41, 0xffff0000, v144
    v_lshlrev_b32 v42, 16, v145
    v_and_b32 v43, 0xffff0000, v145
    v_pk_mul_f32 v[136:137], v[40:41], v[88:89]
    v_pk_mul_f32 v[138:139], v[42:43], v[90:91]
    v_cvt_pk_bf16_f32 v160, v136, v137
    v_cvt_pk_bf16_f32 v161, v138, v139
    v_lshlrev_b32 v136, 16, v122
    v_and_b32 v137, 0xffff0000, v122
    v_lshlrev_b32 v138, 16, v123
    v_and_b32 v139, 0xffff0000, v123
    v_pk_fma_f32 v[48:49], v[48:49], v[76:77], v[136:137]
    v_pk_fma_f32 v[50:51], v[50:51], v[78:79], v[138:139]
    v_cvt_pk_bf16_f32 v146, v48, v49
    v_cvt_pk_bf16_f32 v147, v50, v51
    v_lshlrev_b32 v48, 16, v146
    v_and_b32 v49, 0xffff0000, v146
    v_lshlrev_b32 v50, 16, v147
    v_and_b32 v51, 0xffff0000, v147
    v_pk_mul_f32 v[136:137], v[48:49], v[92:93]
    v_pk_mul_f32 v[138:139], v[50:51], v[94:95]
    v_cvt_pk_bf16_f32 v162, v136, v137
    v_cvt_pk_bf16_f32 v163, v138, v139
    buffer_store_dwordx4 v[160:163], v12, s[24:27], s42 offen offset:0 sc1
    v_lshlrev_b32 v136, 16, v124
    v_and_b32 v137, 0xffff0000, v124
    v_lshlrev_b32 v138, 16, v125
    v_and_b32 v139, 0xffff0000, v125
    v_pk_fma_f32 v[56:57], v[56:57], v[80:81], v[136:137]
    v_pk_fma_f32 v[58:59], v[58:59], v[82:83], v[138:139]
    v_cvt_pk_bf16_f32 v148, v56, v57
    v_cvt_pk_bf16_f32 v149, v58, v59
    v_lshlrev_b32 v56, 16, v148
    v_and_b32 v57, 0xffff0000, v148
    v_lshlrev_b32 v58, 16, v149
    v_and_b32 v59, 0xffff0000, v149
    v_pk_mul_f32 v[136:137], v[56:57], v[96:97]
    v_pk_mul_f32 v[138:139], v[58:59], v[98:99]
    v_cvt_pk_bf16_f32 v164, v136, v137
    v_cvt_pk_bf16_f32 v165, v138, v139
    v_lshlrev_b32 v136, 16, v126
    v_and_b32 v137, 0xffff0000, v126
    v_lshlrev_b32 v138, 16, v127
    v_and_b32 v139, 0xffff0000, v127
    v_pk_fma_f32 v[64:65], v[64:65], v[84:85], v[136:137]
    v_pk_fma_f32 v[66:67], v[66:67], v[86:87], v[138:139]
    v_cvt_pk_bf16_f32 v150, v64, v65
    v_cvt_pk_bf16_f32 v151, v66, v67
    v_lshlrev_b32 v64, 16, v150
    v_and_b32 v65, 0xffff0000, v150
    v_lshlrev_b32 v66, 16, v151
    v_and_b32 v67, 0xffff0000, v151
    v_pk_mul_f32 v[136:137], v[64:65], v[100:101]
    v_pk_mul_f32 v[138:139], v[66:67], v[102:103]
    v_cvt_pk_bf16_f32 v166, v136, v137
    v_cvt_pk_bf16_f32 v167, v138, v139
    buffer_store_dwordx4 v[164:167], v12, s[24:27], s46 offen offset:0 sc1
    v_lshlrev_b32 v136, 16, v128
    v_and_b32 v137, 0xffff0000, v128
    v_lshlrev_b32 v138, 16, v129
    v_and_b32 v139, 0xffff0000, v129
    v_pk_fma_f32 v[44:45], v[44:45], v[72:73], v[136:137]
    v_pk_fma_f32 v[46:47], v[46:47], v[74:75], v[138:139]
    v_cvt_pk_bf16_f32 v152, v44, v45
    v_cvt_pk_bf16_f32 v153, v46, v47
    v_lshlrev_b32 v44, 16, v152
    v_and_b32 v45, 0xffff0000, v152
    v_lshlrev_b32 v46, 16, v153
    v_and_b32 v47, 0xffff0000, v153
    v_pk_mul_f32 v[136:137], v[44:45], v[88:89]
    v_pk_mul_f32 v[138:139], v[46:47], v[90:91]
    v_cvt_pk_bf16_f32 v168, v136, v137
    v_cvt_pk_bf16_f32 v169, v138, v139
    v_lshlrev_b32 v136, 16, v130
    v_and_b32 v137, 0xffff0000, v130
    v_lshlrev_b32 v138, 16, v131
    v_and_b32 v139, 0xffff0000, v131
    v_pk_fma_f32 v[52:53], v[52:53], v[76:77], v[136:137]
    v_pk_fma_f32 v[54:55], v[54:55], v[78:79], v[138:139]
    v_cvt_pk_bf16_f32 v154, v52, v53
    v_cvt_pk_bf16_f32 v155, v54, v55
    v_lshlrev_b32 v52, 16, v154
    v_and_b32 v53, 0xffff0000, v154
    v_lshlrev_b32 v54, 16, v155
    v_and_b32 v55, 0xffff0000, v155
    v_pk_mul_f32 v[136:137], v[52:53], v[92:93]
    v_pk_mul_f32 v[138:139], v[54:55], v[94:95]
    v_cvt_pk_bf16_f32 v170, v136, v137
    v_cvt_pk_bf16_f32 v171, v138, v139
    buffer_store_dwordx4 v[168:171], v12, s[24:27], s42 offen offset:1024 sc1
    v_lshlrev_b32 v136, 16, v132
    v_and_b32 v137, 0xffff0000, v132
    v_lshlrev_b32 v138, 16, v133
    v_and_b32 v139, 0xffff0000, v133
    v_pk_fma_f32 v[60:61], v[60:61], v[80:81], v[136:137]
    v_pk_fma_f32 v[62:63], v[62:63], v[82:83], v[138:139]
    v_cvt_pk_bf16_f32 v156, v60, v61
    v_cvt_pk_bf16_f32 v157, v62, v63
    v_lshlrev_b32 v60, 16, v156
    v_and_b32 v61, 0xffff0000, v156
    v_lshlrev_b32 v62, 16, v157
    v_and_b32 v63, 0xffff0000, v157
    v_pk_mul_f32 v[136:137], v[60:61], v[96:97]
    v_pk_mul_f32 v[138:139], v[62:63], v[98:99]
    v_cvt_pk_bf16_f32 v172, v136, v137
    v_cvt_pk_bf16_f32 v173, v138, v139
    v_lshlrev_b32 v136, 16, v134
    v_and_b32 v137, 0xffff0000, v134
    v_lshlrev_b32 v138, 16, v135
    v_and_b32 v139, 0xffff0000, v135
    v_pk_fma_f32 v[68:69], v[68:69], v[84:85], v[136:137]
    v_pk_fma_f32 v[70:71], v[70:71], v[86:87], v[138:139]
    v_cvt_pk_bf16_f32 v158, v68, v69
    v_cvt_pk_bf16_f32 v159, v70, v71
    v_lshlrev_b32 v68, 16, v158
    v_and_b32 v69, 0xffff0000, v158
    v_lshlrev_b32 v70, 16, v159
    v_and_b32 v71, 0xffff0000, v159
    v_pk_mul_f32 v[136:137], v[68:69], v[100:101]
    v_pk_mul_f32 v[138:139], v[70:71], v[102:103]
    v_cvt_pk_bf16_f32 v174, v136, v137
    v_cvt_pk_bf16_f32 v175, v138, v139
    buffer_store_dwordx4 v[172:175], v12, s[24:27], s46 offen offset:1024 sc1
    v_accvgpr_write_b32 a48, v144
    v_accvgpr_write_b32 a49, v145
    v_accvgpr_write_b32 a50, v146
    v_accvgpr_write_b32 a51, v147
    v_accvgpr_write_b32 a52, v148
    v_accvgpr_write_b32 a53, v149
    v_accvgpr_write_b32 a54, v150
    v_accvgpr_write_b32 a55, v151
    v_accvgpr_write_b32 a56, v152
    v_accvgpr_write_b32 a57, v153
    v_accvgpr_write_b32 a58, v154
    v_accvgpr_write_b32 a59, v155
    v_accvgpr_write_b32 a60, v156
    v_accvgpr_write_b32 a61, v157
    v_accvgpr_write_b32 a62, v158
    v_accvgpr_write_b32 a63, v159
    v_pk_add_f32 v[176:177], v[40:41], v[42:43]
    v_pk_add_f32 v[176:177], v[176:177], v[48:49]
    v_pk_add_f32 v[176:177], v[176:177], v[50:51]
    v_pk_add_f32 v[176:177], v[176:177], v[56:57]
    v_pk_add_f32 v[176:177], v[176:177], v[58:59]
    v_pk_add_f32 v[176:177], v[176:177], v[64:65]
    v_pk_add_f32 v[176:177], v[176:177], v[66:67]
    v_pk_add_f32 v[178:179], v[44:45], v[46:47]
    v_pk_add_f32 v[178:179], v[178:179], v[52:53]
    v_pk_add_f32 v[178:179], v[178:179], v[54:55]
    v_pk_add_f32 v[178:179], v[178:179], v[60:61]
    v_pk_add_f32 v[178:179], v[178:179], v[62:63]
    v_pk_add_f32 v[178:179], v[178:179], v[68:69]
    v_pk_add_f32 v[178:179], v[178:179], v[70:71]
    v_add_f32 v180, v176, v177
    v_add_f32 v182, v178, v179
    v_mov_b32 v184, v180
    v_mov_b32 v185, v182
    s_nop 1
    v_permlane16_swap_b32 v180, v184
    v_permlane16_swap_b32 v182, v185
    v_add_f32 v180, v180, v184
    v_add_f32 v182, v182, v185
    v_mov_b32 v184, v180
    v_mov_b32 v185, v182
    s_nop 1
    v_permlane32_swap_b32 v180, v184
    v_permlane32_swap_b32 v182, v185
    v_add_f32 v180, v180, v184
    v_add_f32 v182, v182, v185
    v_mul_f32 v176, 0xbc800000, v180
    v_mul_f32 v178, 0xbc800000, v182
    v_pk_add_f32 v[40:41], v[40:41], v[176:177] op_sel_hi:[1,0]
    v_pk_mul_f32 v[186:187], v[40:41], v[40:41]
    v_pk_add_f32 v[42:43], v[42:43], v[176:177] op_sel_hi:[1,0]
    v_pk_fma_f32 v[186:187], v[42:43], v[42:43], v[186:187]
    v_pk_add_f32 v[48:49], v[48:49], v[176:177] op_sel_hi:[1,0]
    v_pk_fma_f32 v[186:187], v[48:49], v[48:49], v[186:187]
    v_pk_add_f32 v[50:51], v[50:51], v[176:177] op_sel_hi:[1,0]
    v_pk_fma_f32 v[186:187], v[50:51], v[50:51], v[186:187]
    v_pk_add_f32 v[56:57], v[56:57], v[176:177] op_sel_hi:[1,0]
    v_pk_fma_f32 v[186:187], v[56:57], v[56:57], v[186:187]
    v_pk_add_f32 v[58:59], v[58:59], v[176:177] op_sel_hi:[1,0]
    v_pk_fma_f32 v[186:187], v[58:59], v[58:59], v[186:187]
    v_pk_add_f32 v[64:65], v[64:65], v[176:177] op_sel_hi:[1,0]
    v_pk_fma_f32 v[186:187], v[64:65], v[64:65], v[186:187]
    v_pk_add_f32 v[66:67], v[66:67], v[176:177] op_sel_hi:[1,0]
    v_pk_fma_f32 v[186:187], v[66:67], v[66:67], v[186:187]
    v_pk_add_f32 v[44:45], v[44:45], v[178:179] op_sel_hi:[1,0]
    v_pk_mul_f32 v[188:189], v[44:45], v[44:45]
    v_pk_add_f32 v[46:47], v[46:47], v[178:179] op_sel_hi:[1,0]
    v_pk_fma_f32 v[188:189], v[46:47], v[46:47], v[188:189]
    v_pk_add_f32 v[52:53], v[52:53], v[178:179] op_sel_hi:[1,0]
    v_pk_fma_f32 v[188:189], v[52:53], v[52:53], v[188:189]
    v_pk_add_f32 v[54:55], v[54:55], v[178:179] op_sel_hi:[1,0]
    v_pk_fma_f32 v[188:189], v[54:55], v[54:55], v[188:189]
    v_pk_add_f32 v[60:61], v[60:61], v[178:179] op_sel_hi:[1,0]
    v_pk_fma_f32 v[188:189], v[60:61], v[60:61], v[188:189]
    v_pk_add_f32 v[62:63], v[62:63], v[178:179] op_sel_hi:[1,0]
    v_pk_fma_f32 v[188:189], v[62:63], v[62:63], v[188:189]
    v_pk_add_f32 v[68:69], v[68:69], v[178:179] op_sel_hi:[1,0]
    v_pk_fma_f32 v[188:189], v[68:69], v[68:69], v[188:189]
    v_pk_add_f32 v[70:71], v[70:71], v[178:179] op_sel_hi:[1,0]
    v_pk_fma_f32 v[188:189], v[70:71], v[70:71], v[188:189]
    v_add_f32 v181, v186, v187
    v_add_f32 v183, v188, v189
    v_mov_b32 v184, v181
    v_mov_b32 v185, v183
    s_nop 1
    v_permlane16_swap_b32 v181, v184
    v_permlane16_swap_b32 v183, v185
    v_add_f32 v181, v181, v184
    v_add_f32 v183, v183, v185
    v_mov_b32 v184, v181
    v_mov_b32 v185, v183
    s_nop 1
    v_permlane32_swap_b32 v181, v184
    v_permlane32_swap_b32 v183, v185
    v_add_f32 v181, v181, v184
    v_add_f32 v183, v183, v185
    s_lshl_b32 s42, s47, 12
    s_lshl_b32 s43, s41, 7
    s_add_u32 s42, s42, s43
    s_add_u32 s42, s42, 0x40000
    v_lshlrev_b32 v5, 3, v5
    s_mov_b64 exec, 0xffff
    buffer_store_dwordx2 v[180:181], v5, s[24:27], s42 offen sc1
    buffer_store_dwordx2 v[182:183], v5, s[24:27], s42 offen offset:2048 sc1
    s_mov_b64 exec, -1
    s_lshl_b32 s49, s47, 4
    s_add_u32 s49, s49, s41
    s_lshl_b32 s49, s49, 7
    s_add_u32 s49, s49, 25296896
    v_and_b32 v4, 1, v1
    v_lshlrev_b32 v7, 6, v4
    v_lshl_add_u32 v7, v15, 3, v7
    v_add_u32 v7, s45, v7
    ds_read_b64 v[24:25], v7 offset:4608
    ds_read_b64 v[26:27], v7 offset:4640
    v_bfe_u32 v7, v1, 2, 2
    v_lshl_add_u32 v5, v15, 2, v7
    v_mul_u32_u24 v5, 224, v5
    v_and_b32 v7, 3, v1
    v_lshl_add_u32 v13, v7, 3, v5
    v_add_u32 v5, s61, v13
    s_waitcnt vmcnt(10)
    s_barrier
    ds_read_b64_tr_b16 v[28:29], v5 offset:0
    ds_read_b64_tr_b16 v[30:31], v5 offset:3584
    ds_read_b64_tr_b16 v[32:33], v5 offset:32
    ds_read_b64_tr_b16 v[34:35], v5 offset:3616
    ds_read_b64_tr_b16 v[36:37], v5 offset:64
    ds_read_b64_tr_b16 v[38:39], v5 offset:3648
    ds_read_b64_tr_b16 v[40:41], v5 offset:96
    ds_read_b64_tr_b16 v[42:43], v5 offset:3680
    ds_read_b64_tr_b16 v[44:45], v5 offset:128
    ds_read_b64_tr_b16 v[46:47], v5 offset:3712
    ds_read_b64_tr_b16 v[48:49], v5 offset:160
    ds_read_b64_tr_b16 v[50:51], v5 offset:3744
    ds_read_b64_tr_b16 v[52:53], v5 offset:192
    ds_read_b64_tr_b16 v[54:55], v5 offset:3776
    v_mul_u32_u24 v4, 448, v4
    v_lshl_add_u32 v4, v15, 4, v4
    v_add_u32 v4, s45, v4
    s_waitcnt lgkmcnt(0)
    v_mfma_f32_16x16x32_bf16 v[56:59], v[28:31], v[24:27], 0
    v_mfma_f32_16x16x32_bf16 v[60:63], v[32:35], v[24:27], 0
    v_mfma_f32_16x16x32_bf16 v[64:67], v[36:39], v[24:27], 0
    v_mfma_f32_16x16x32_bf16 v[68:71], v[40:43], v[24:27], 0
    v_mfma_f32_16x16x32_bf16 v[72:75], v[44:47], v[24:27], 0
    v_mfma_f32_16x16x32_bf16 v[76:79], v[48:51], v[24:27], 0
    v_mfma_f32_16x16x32_bf16 v[80:83], v[52:55], v[24:27], 0
    v_min_u32 v8, 223, v0
    v_lshlrev_b32 v8, 2, v8
    v_add_u32 v10, 136192, v8
    v_cmp_lt_u32 vcc, 447, v8
    v_mov_b32 v7, 13888
    s_mov_b32 exec_lo, 0x00030003
    s_mov_b32 exec_hi, 0x00030003
    s_nop 1
    ds_write_b128 v4, v[56:59] offset:5120
    ds_write_b128 v4, v[60:63] offset:5184
    ds_write_b128 v4, v[64:67] offset:5248
    ds_write_b128 v4, v[68:71] offset:5312
    ds_write_b128 v4, v[72:75] offset:5376
    ds_write_b128 v4, v[76:79] offset:5440
    ds_write_b128 v4, v[80:83] offset:5504
    s_mov_b64 exec, -1
    v_cndmask_b32 v7, 0, v7, vcc
    v_add_u32 v7, v7, v8
    s_mul_i32 s54, s39, 448
    s_add_u32 s54, s54, 786432
    s_mul_i32 s42, s38, 28672
    s_add_u32 s42, s42, s54
    s_waitcnt vmcnt(0) lgkmcnt(0)
    v_mov_b32 v22, 0
    v_mov_b32 v23, 1
    s_mov_b64 exec, 1
    buffer_store_dword v23, v22, s[24:27], s49 offen sc1
    s_mov_b64 exec, -1
    s_barrier
    ds_read_b32 v24, v10 offset:0
    ds_read_b32 v25, v10 offset:8192
    ds_read_b32 v26, v10 offset:16384
    ds_read_b32 v27, v10 offset:24576
    s_waitcnt lgkmcnt(0)
    v_add_f32 v24, v24, v25
    v_add_f32 v26, v26, v27
    v_add_f32 v24, v24, v26
    buffer_store_dword v24, v7, s[24:27], s42 offen sc1
    v_mov_b32 v16, v252
    v_add_u32 v14, 65536, v13
    ds_read_b64_tr_b16 v[92:93], v14 offset:0
    ds_read_b64_tr_b16 v[94:95], v14 offset:3584
    ds_read_b64_tr_b16 v[96:97], v14 offset:32
    ds_read_b64_tr_b16 v[98:99], v14 offset:3616
    ds_read_b64_tr_b16 v[100:101], v14 offset:64
    ds_read_b64_tr_b16 v[102:103], v14 offset:3648
    ds_read_b64_tr_b16 v[104:105], v14 offset:96
    ds_read_b64_tr_b16 v[106:107], v14 offset:3680
    ds_read_b64_tr_b16 v[108:109], v14 offset:128
    ds_read_b64_tr_b16 v[110:111], v14 offset:3712
    ds_read_b64_tr_b16 v[112:113], v14 offset:160
    ds_read_b64_tr_b16 v[114:115], v14 offset:3744
    ds_read_b64_tr_b16 v[116:117], v14 offset:192
    ds_read_b64_tr_b16 v[118:119], v14 offset:3776
    s_lshl_b32 s43, s38, 2
    s_add_u32 s46, s43, s36
    s_lshl_b32 s43, s46, 12
    v_add_u32 v12, s43, v2
    s_add_u32 s49, s43, 25296896
    s_lshl_b32 s48, s38, 19
    s_lshl_b32 s44, s36, 10
    s_mov_b32 m0, s44
    s_mov_b32 s50, 65536
    s_mov_b32 s51, 94208
    s_mov_b32 s52, 0
    s_add_u32 s28, s10, 0x1400000
    s_addc_u32 s29, s11, 0
    s_and_b32 s29, s29, 0xffff
    s_mov_b32 s30, 0x400000
    s_mov_b32 s31, 0x20000
    v_mov_b64 v[120:121], 0
    v_mov_b64 v[122:123], 0
    v_mov_b64 v[124:125], 0
    v_mov_b64 v[126:127], 0
    v_mov_b64 v[128:129], 0
    v_mov_b64 v[130:131], 0
    v_mov_b64 v[132:133], 0
    v_mov_b64 v[134:135], 0
    v_mov_b64 v[136:137], 0
    v_mov_b64 v[138:139], 0
    v_mov_b64 v[140:141], 0
    v_mov_b64 v[142:143], 0
    v_mov_b64 v[144:145], 0
    v_mov_b64 v[146:147], 0
    v_mov_b64 v[148:149], 0
    v_mov_b64 v[150:151], 0
    v_mov_b64 v[152:153], 0
    v_mov_b64 v[154:155], 0
    v_mov_b64 v[156:157], 0
    v_mov_b64 v[158:159], 0
    v_mov_b64 v[160:161], 0
    v_mov_b64 v[162:163], 0
    v_mov_b64 v[164:165], 0
    v_mov_b64 v[166:167], 0
    v_mov_b64 v[168:169], 0
    v_mov_b64 v[170:171], 0
    v_mov_b64 v[172:173], 0
    v_mov_b64 v[174:175], 0
    v_mov_b64 v[176:177], 0
    v_mov_b64 v[178:179], 0
    v_mov_b64 v[180:181], 0
    v_mov_b64 v[182:183], 0
    v_mov_b64 v[184:185], 0
    v_mov_b64 v[186:187], 0
    v_mov_b64 v[188:189], 0
    v_mov_b64 v[190:191], 0
    v_mov_b64 v[192:193], 0
    v_mov_b64 v[194:195], 0
    v_mov_b64 v[196:197], 0
    v_mov_b64 v[198:199], 0
    v_mov_b64 v[200:201], 0
    v_mov_b64 v[202:203], 0
    v_mov_b64 v[204:205], 0
    v_mov_b64 v[206:207], 0
    v_mov_b64 v[208:209], 0
    v_mov_b64 v[210:211], 0
    v_mov_b64 v[212:213], 0
    v_mov_b64 v[214:215], 0
    v_mov_b64 v[216:217], 0
    v_mov_b64 v[218:219], 0
    v_mov_b64 v[220:221], 0
    v_mov_b64 v[222:223], 0
    v_mov_b64 v[224:225], 0
    v_mov_b64 v[226:227], 0
    v_mov_b64 v[228:229], 0
    v_mov_b64 v[230:231], 0
    v_and_b32 v5, 15, v1
    v_lshlrev_b32 v6, 9, v15
    v_lshl_add_u32 v6, v5, 3, v6
    s_lshl_b32 s42, s46, 13
    s_add_u32 s42, s42, 0x40000
    s_add_u32 s43, s42, 4096
    v_add_u32 v8, 143360, v8
    v_lshlrev_b32 v9, 4, v15
    v_add_u32 v9, 143360, v9
    v_and_b32 v10, 31, v1
    v_lshlrev_b32 v10, 7, v10
    s_mov_b32 s62, 0x3c800000
    s_mov_b32 s63, 0x42800000
    s_lshl_b32 s55, s39, 10
    s_add_u32 s55, s55, 25591808
    v_and_b32 v19, 7, v1
    v_lshlrev_b32 v19, 7, v19
    s_mov_b32 s60, 0x200000
POLL_Y:
    buffer_load_dword v11, v10, s[24:27], s49 offen sc1
    s_sub_u32 s60, s60, 1
    s_waitcnt vmcnt(0)
    v_cmp_eq_u32 vcc, 0, v11
    s_cmp_eq_u32 s60, 0
    s_cbranch_scc1 POLLX_Y
    s_cmp_eq_u64 vcc, 0
    s_cbranch_scc1 POLLX_Y
    s_sleep 4
    s_branch POLL_Y
POLLX_Y:
    buffer_load_dwordx4 v[28:31], v12, s[28:31], s48 offen offset:0 sc1
    buffer_load_dwordx4 v[32:35], v12, s[28:31], s48 offen offset:1024 sc1
    buffer_load_dwordx4 v[36:39], v12, s[28:31], s48 offen offset:2048 sc1
    buffer_load_dwordx4 v[40:43], v12, s[28:31], s48 offen offset:3072 sc1
    s_add_u32 s48, s48, 0x20000
    buffer_load_dwordx4 v[44:47], v12, s[28:31], s48 offen offset:0 sc1
    buffer_load_dwordx4 v[48:51], v12, s[28:31], s48 offen offset:1024 sc1
    buffer_load_dwordx4 v[52:55], v12, s[28:31], s48 offen offset:2048 sc1
    buffer_load_dwordx4 v[56:59], v12, s[28:31], s48 offen offset:3072 sc1
    s_add_u32 s48, s48, 0x20000
    buffer_load_dwordx4 v[60:63], v12, s[28:31], s48 offen offset:0 sc1
    buffer_load_dwordx4 v[64:67], v12, s[28:31], s48 offen offset:1024 sc1
    buffer_load_dwordx4 v[68:71], v12, s[28:31], s48 offen offset:2048 sc1
    buffer_load_dwordx4 v[72:75], v12, s[28:31], s48 offen offset:3072 sc1
    s_add_u32 s48, s48, 0x20000
    s_waitcnt vmcnt(8) lgkmcnt(0)
    v_mfma_f32_16x16x32_bf16 v[120:123], v[92:95], v[28:31], v[120:123]
    v_mfma_f32_16x16x32_bf16 v[124:127], v[92:95], v[32:35], v[124:127]
    buffer_load_dwordx4 v[76:79], v12, s[28:31], s48 offen offset:0 sc1
    v_mfma_f32_16x16x32_bf16 v[128:131], v[92:95], v[36:39], v[128:131]
    buffer_load_dwordx4 v[80:83], v12, s[28:31], s48 offen offset:1024 sc1
    v_mfma_f32_16x16x32_bf16 v[132:135], v[92:95], v[40:43], v[132:135]
    ds_read_b64_tr_b16 v[92:93], v14 offset:7168
    v_mfma_f32_16x16x32_bf16 v[136:139], v[96:99], v[28:31], v[136:139]
    ds_read_b64_tr_b16 v[94:95], v14 offset:10752
    v_mfma_f32_16x16x32_bf16 v[140:143], v[96:99], v[32:35], v[140:143]
    buffer_load_dwordx4 v[84:87], v12, s[28:31], s48 offen offset:2048 sc1
    v_mfma_f32_16x16x32_bf16 v[144:147], v[96:99], v[36:39], v[144:147]
    buffer_load_dwordx4 v[88:91], v12, s[28:31], s48 offen offset:3072 sc1
    v_mfma_f32_16x16x32_bf16 v[148:151], v[96:99], v[40:43], v[148:151]
    ds_read_b64_tr_b16 v[96:97], v14 offset:7200
    v_mfma_f32_16x16x32_bf16 v[152:155], v[100:103], v[28:31], v[152:155]
    s_add_u32 s48, s48, 0x20000
    ds_read_b64_tr_b16 v[98:99], v14 offset:10784
    v_mfma_f32_16x16x32_bf16 v[156:159], v[100:103], v[32:35], v[156:159]
    buffer_load_dwordx4 v16, s[16:19], s58 offen sc1 lds
    v_mfma_f32_16x16x32_bf16 v[160:163], v[100:103], v[36:39], v[160:163]
    s_add_u32 s58, s58, 4096
    v_mfma_f32_16x16x32_bf16 v[164:167], v[100:103], v[40:43], v[164:167]
    s_add_u32 m0, m0, 4096
    s_waitcnt lgkmcnt(4)
    ds_read_b64_tr_b16 v[100:101], v14 offset:7232
    v_mfma_f32_16x16x32_bf16 v[168:171], v[104:107], v[28:31], v[168:171]
    s_and_b32 s48, s48, 0x3fffff
    ds_read_b64_tr_b16 v[102:103], v14 offset:10816
    v_mfma_f32_16x16x32_bf16 v[172:175], v[104:107], v[32:35], v[172:175]
    v_mfma_f32_16x16x32_bf16 v[176:179], v[104:107], v[36:39], v[176:179]
    v_mfma_f32_16x16x32_bf16 v[180:183], v[104:107], v[40:43], v[180:183]
    ds_read_b64_tr_b16 v[104:105], v14 offset:7264
    v_mfma_f32_16x16x32_bf16 v[184:187], v[108:111], v[28:31], v[184:187]
    ds_read_b64_tr_b16 v[106:107], v14 offset:10848
    v_mfma_f32_16x16x32_bf16 v[188:191], v[108:111], v[32:35], v[188:191]
    buffer_load_dwordx4 v16, s[16:19], s58 offen sc1 lds
    v_mfma_f32_16x16x32_bf16 v[192:195], v[108:111], v[36:39], v[192:195]
    s_add_u32 s58, s58, 4096
    v_mfma_f32_16x16x32_bf16 v[196:199], v[108:111], v[40:43], v[196:199]
    s_add_u32 m0, m0, 4096
    ds_read_b64_tr_b16 v[108:109], v14 offset:7296
    v_mfma_f32_16x16x32_bf16 v[200:203], v[112:115], v[28:31], v[200:203]
    ds_read_b64_tr_b16 v[110:111], v14 offset:10880
    v_mfma_f32_16x16x32_bf16 v[204:207], v[112:115], v[32:35], v[204:207]
    buffer_load_dwordx4 v16, s[16:19], s58 offen sc1 lds
    v_mfma_f32_16x16x32_bf16 v[208:211], v[112:115], v[36:39], v[208:211]
    s_add_u32 s58, s58, 4096
    v_mfma_f32_16x16x32_bf16 v[212:215], v[112:115], v[40:43], v[212:215]
    s_add_u32 m0, m0, 4096
    ds_read_b64_tr_b16 v[112:113], v14 offset:7328
    v_mfma_f32_16x16x32_bf16 v[216:219], v[116:119], v[28:31], v[216:219]
    ds_read_b64_tr_b16 v[114:115], v14 offset:10912
    v_mfma_f32_16x16x32_bf16 v[220:223], v[116:119], v[32:35], v[220:223]
    v_mfma_f32_16x16x32_bf16 v[224:227], v[116:119], v[36:39], v[224:227]
    v_mfma_f32_16x16x32_bf16 v[228:231], v[116:119], v[40:43], v[228:231]
    s_waitcnt vmcnt(11) lgkmcnt(4)
    ds_read_b64_tr_b16 v[116:117], v14 offset:7360
    v_mfma_f32_16x16x32_bf16 v[120:123], v[92:95], v[44:47], v[120:123]
    ds_read_b64_tr_b16 v[118:119], v14 offset:10944
    v_mfma_f32_16x16x32_bf16 v[124:127], v[92:95], v[48:51], v[124:127]
    buffer_load_dwordx4 v[28:31], v12, s[28:31], s48 offen offset:0 sc1
    v_mfma_f32_16x16x32_bf16 v[128:131], v[92:95], v[52:55], v[128:131]
    buffer_load_dwordx4 v[32:35], v12, s[28:31], s48 offen offset:1024 sc1
    v_mfma_f32_16x16x32_bf16 v[132:135], v[92:95], v[56:59], v[132:135]
    ds_read_b64_tr_b16 v[92:93], v14 offset:14336
    v_mfma_f32_16x16x32_bf16 v[136:139], v[96:99], v[44:47], v[136:139]
    ds_read_b64_tr_b16 v[94:95], v14 offset:17920
    v_mfma_f32_16x16x32_bf16 v[140:143], v[96:99], v[48:51], v[140:143]
    buffer_load_dwordx4 v[36:39], v12, s[28:31], s48 offen offset:2048 sc1
    v_mfma_f32_16x16x32_bf16 v[144:147], v[96:99], v[52:55], v[144:147]
    buffer_load_dwordx4 v[40:43], v12, s[28:31], s48 offen offset:3072 sc1
    v_mfma_f32_16x16x32_bf16 v[148:151], v[96:99], v[56:59], v[148:151]
    ds_read_b64_tr_b16 v[96:97], v14 offset:14368
    v_mfma_f32_16x16x32_bf16 v[152:155], v[100:103], v[44:47], v[152:155]
    s_add_u32 s48, s48, 0x20000
    ds_read_b64_tr_b16 v[98:99], v14 offset:17952
    v_mfma_f32_16x16x32_bf16 v[156:159], v[100:103], v[48:51], v[156:159]
    v_mfma_f32_16x16x32_bf16 v[160:163], v[100:103], v[52:55], v[160:163]
    v_mfma_f32_16x16x32_bf16 v[164:167], v[100:103], v[56:59], v[164:167]
    s_waitcnt lgkmcnt(4)
    ds_read_b64_tr_b16 v[100:101], v14 offset:14400
    v_mfma_f32_16x16x32_bf16 v[168:171], v[104:107], v[44:47], v[168:171]
    s_and_b32 s48, s48, 0x3fffff
    ds_read_b64_tr_b16 v[102:103], v14 offset:17984
    v_mfma_f32_16x16x32_bf16 v[172:175], v[104:107], v[48:51], v[172:175]
    buffer_load_dwordx4 v16, s[16:19], s58 offen sc1 lds
    v_mfma_f32_16x16x32_bf16 v[176:179], v[104:107], v[52:55], v[176:179]
    s_add_u32 s58, s58, 4096
    v_mfma_f32_16x16x32_bf16 v[180:183], v[104:107], v[56:59], v[180:183]
    s_add_u32 m0, m0, 4096
    ds_read_b64_tr_b16 v[104:105], v14 offset:14432
    v_mfma_f32_16x16x32_bf16 v[184:187], v[108:111], v[44:47], v[184:187]
    ds_read_b64_tr_b16 v[106:107], v14 offset:18016
    v_mfma_f32_16x16x32_bf16 v[188:191], v[108:111], v[48:51], v[188:191]
    v_mfma_f32_16x16x32_bf16 v[192:195], v[108:111], v[52:55], v[192:195]
    v_mfma_f32_16x16x32_bf16 v[196:199], v[108:111], v[56:59], v[196:199]
    ds_read_b64_tr_b16 v[108:109], v14 offset:14464
    v_mfma_f32_16x16x32_bf16 v[200:203], v[112:115], v[44:47], v[200:203]
    ds_read_b64_tr_b16 v[110:111], v14 offset:18048
    v_mfma_f32_16x16x32_bf16 v[204:207], v[112:115], v[48:51], v[204:207]
    buffer_load_dwordx4 v16, s[16:19], s58 offen sc1 lds
    v_mfma_f32_16x16x32_bf16 v[208:211], v[112:115], v[52:55], v[208:211]
    s_add_u32 s58, s58, 4096
    v_mfma_f32_16x16x32_bf16 v[212:215], v[112:115], v[56:59], v[212:215]
    s_add_u32 m0, m0, 4096
    ds_read_b64_tr_b16 v[112:113], v14 offset:14496
    v_mfma_f32_16x16x32_bf16 v[216:219], v[116:119], v[44:47], v[216:219]
    ds_read_b64_tr_b16 v[114:115], v14 offset:18080
    v_mfma_f32_16x16x32_bf16 v[220:223], v[116:119], v[48:51], v[220:223]
    v_mfma_f32_16x16x32_bf16 v[224:227], v[116:119], v[52:55], v[224:227]
    v_mfma_f32_16x16x32_bf16 v[228:231], v[116:119], v[56:59], v[228:231]
    s_waitcnt vmcnt(13) lgkmcnt(4)
    ds_read_b64_tr_b16 v[116:117], v14 offset:14528
    v_mfma_f32_16x16x32_bf16 v[120:123], v[92:95], v[60:63], v[120:123]
    ds_read_b64_tr_b16 v[118:119], v14 offset:18112
    v_mfma_f32_16x16x32_bf16 v[124:127], v[92:95], v[64:67], v[124:127]
    buffer_load_dwordx4 v[44:47], v12, s[28:31], s48 offen offset:0 sc1
    v_mfma_f32_16x16x32_bf16 v[128:131], v[92:95], v[68:71], v[128:131]
    buffer_load_dwordx4 v[48:51], v12, s[28:31], s48 offen offset:1024 sc1
    v_mfma_f32_16x16x32_bf16 v[132:135], v[92:95], v[72:75], v[132:135]
    ds_read_b64_tr_b16 v[92:93], v14 offset:21504
    v_mfma_f32_16x16x32_bf16 v[136:139], v[96:99], v[60:63], v[136:139]
    ds_read_b64_tr_b16 v[94:95], v14 offset:25088
    v_mfma_f32_16x16x32_bf16 v[140:143], v[96:99], v[64:67], v[140:143]
    buffer_load_dwordx4 v[52:55], v12, s[28:31], s48 offen offset:2048 sc1
    v_mfma_f32_16x16x32_bf16 v[144:147], v[96:99], v[68:71], v[144:147]
    buffer_load_dwordx4 v[56:59], v12, s[28:31], s48 offen offset:3072 sc1
    v_mfma_f32_16x16x32_bf16 v[148:151], v[96:99], v[72:75], v[148:151]
    ds_read_b64_tr_b16 v[96:97], v14 offset:21536
    v_mfma_f32_16x16x32_bf16 v[152:155], v[100:103], v[60:63], v[152:155]
    s_add_u32 s48, s48, 0x20000
    ds_read_b64_tr_b16 v[98:99], v14 offset:25120
    v_mfma_f32_16x16x32_bf16 v[156:159], v[100:103], v[64:67], v[156:159]
    v_mfma_f32_16x16x32_bf16 v[160:163], v[100:103], v[68:71], v[160:163]
    v_mfma_f32_16x16x32_bf16 v[164:167], v[100:103], v[72:75], v[164:167]
    s_waitcnt lgkmcnt(4)
    ds_read_b64_tr_b16 v[100:101], v14 offset:21568
    v_mfma_f32_16x16x32_bf16 v[168:171], v[104:107], v[60:63], v[168:171]
    s_and_b32 s48, s48, 0x3fffff
    ds_read_b64_tr_b16 v[102:103], v14 offset:25152
    v_mfma_f32_16x16x32_bf16 v[172:175], v[104:107], v[64:67], v[172:175]
    buffer_load_dwordx4 v16, s[16:19], s58 offen sc1 lds
    v_mfma_f32_16x16x32_bf16 v[176:179], v[104:107], v[68:71], v[176:179]
    s_add_u32 s58, s58, 4096
    v_mfma_f32_16x16x32_bf16 v[180:183], v[104:107], v[72:75], v[180:183]
    s_add_u32 m0, m0, 4096
    ds_read_b64_tr_b16 v[104:105], v14 offset:21600
    v_mfma_f32_16x16x32_bf16 v[184:187], v[108:111], v[60:63], v[184:187]
    ds_read_b64_tr_b16 v[106:107], v14 offset:25184
    v_mfma_f32_16x16x32_bf16 v[188:191], v[108:111], v[64:67], v[188:191]
    v_mfma_f32_16x16x32_bf16 v[192:195], v[108:111], v[68:71], v[192:195]
    v_mfma_f32_16x16x32_bf16 v[196:199], v[108:111], v[72:75], v[196:199]
    ds_read_b64_tr_b16 v[108:109], v14 offset:21632
    v_mfma_f32_16x16x32_bf16 v[200:203], v[112:115], v[60:63], v[200:203]
    ds_read_b64_tr_b16 v[110:111], v14 offset:25216
    v_mfma_f32_16x16x32_bf16 v[204:207], v[112:115], v[64:67], v[204:207]
    buffer_load_dwordx4 v16, s[16:19], s58 offen sc1 lds
    v_mfma_f32_16x16x32_bf16 v[208:211], v[112:115], v[68:71], v[208:211]
    s_add_u32 s58, s58, 4096
    v_mfma_f32_16x16x32_bf16 v[212:215], v[112:115], v[72:75], v[212:215]
    s_add_u32 m0, m0, 4096
    ds_read_b64_tr_b16 v[112:113], v14 offset:21664
    v_mfma_f32_16x16x32_bf16 v[216:219], v[116:119], v[60:63], v[216:219]
    s_cmp_eq_u32 s58, 229376
    ds_read_b64_tr_b16 v[114:115], v14 offset:25248
    v_mfma_f32_16x16x32_bf16 v[220:223], v[116:119], v[64:67], v[220:223]
    s_cselect_b32 s58, 0, s58
    v_mfma_f32_16x16x32_bf16 v[224:227], v[116:119], v[68:71], v[224:227]
    v_mfma_f32_16x16x32_bf16 v[228:231], v[116:119], v[72:75], v[228:231]
    s_waitcnt vmcnt(15) lgkmcnt(4)
    ds_read_b64_tr_b16 v[116:117], v14 offset:21696
    v_mfma_f32_16x16x32_bf16 v[120:123], v[92:95], v[76:79], v[120:123]
    s_add_u32 m0, s50, s44
    ds_read_b64_tr_b16 v[118:119], v14 offset:25280
    v_mfma_f32_16x16x32_bf16 v[124:127], v[92:95], v[80:83], v[124:127]
    s_mov_b32 s57, s50
    buffer_load_dwordx4 v[60:63], v12, s[28:31], s48 offen offset:0 sc1
    v_mfma_f32_16x16x32_bf16 v[128:131], v[92:95], v[84:87], v[128:131]
    v_add_u32 v14, s51, v13
    buffer_load_dwordx4 v[64:67], v12, s[28:31], s48 offen offset:1024 sc1
    s_waitcnt lgkmcnt(0)
    s_barrier
    s_cmp_lg_u32 s36, 0
    s_cbranch_scc1 K5_NOFU
    s_lshl_b32 s56, s38, 7
    s_add_u32 s56, s56, s55
    v_mov_b32 v17, 0
    v_mov_b32 v18, 1
    s_mov_b64 exec, 1
    buffer_store_dword v18, v17, s[24:27], s56 offen sc1
    s_mov_b64 exec, -1
K5_NOFU:
    v_mfma_f32_16x16x32_bf16 v[132:135], v[92:95], v[88:91], v[132:135]
    ds_read_b64_tr_b16 v[92:93], v14 offset:0
    v_mfma_f32_16x16x32_bf16 v[136:139], v[96:99], v[76:79], v[136:139]
    s_mov_b32 s50, s51
    ds_read_b64_tr_b16 v[94:95], v14 offset:3584
    v_mfma_f32_16x16x32_bf16 v[140:143], v[96:99], v[80:83], v[140:143]
    s_mov_b32 s51, s52
    buffer_load_dwordx4 v[68:71], v12, s[28:31], s48 offen offset:2048 sc1
    v_mfma_f32_16x16x32_bf16 v[144:147], v[96:99], v[84:87], v[144:147]
    s_mov_b32 s52, s57
    buffer_load_dwordx4 v[72:75], v12, s[28:31], s48 offen offset:3072 sc1
    v_mfma_f32_16x16x32_bf16 v[148:151], v[96:99], v[88:91], v[148:151]
    ds_read_b64_tr_b16 v[96:97], v14 offset:32
    v_mfma_f32_16x16x32_bf16 v[152:155], v[100:103], v[76:79], v[152:155]
    s_add_u32 s48, s48, 0x20000
    ds_read_b64_tr_b16 v[98:99], v14 offset:3616
    v_mfma_f32_16x16x32_bf16 v[156:159], v[100:103], v[80:83], v[156:159]
    v_mfma_f32_16x16x32_bf16 v[160:163], v[100:103], v[84:87], v[160:163]
    v_mfma_f32_16x16x32_bf16 v[164:167], v[100:103], v[88:91], v[164:167]
    s_waitcnt lgkmcnt(4)
    ds_read_b64_tr_b16 v[100:101], v14 offset:64
    v_mfma_f32_16x16x32_bf16 v[168:171], v[104:107], v[76:79], v[168:171]
    s_and_b32 s48, s48, 0x3fffff
    ds_read_b64_tr_b16 v[102:103], v14 offset:3648
    v_mfma_f32_16x16x32_bf16 v[172:175], v[104:107], v[80:83], v[172:175]
    buffer_load_dwordx4 v16, s[16:19], s58 offen sc1 lds
    v_mfma_f32_16x16x32_bf16 v[176:179], v[104:107], v[84:87], v[176:179]
    s_add_u32 s58, s58, 4096
    v_mfma_f32_16x16x32_bf16 v[180:183], v[104:107], v[88:91], v[180:183]
    s_add_u32 m0, m0, 4096
    ds_read_b64_tr_b16 v[104:105], v14 offset:96
    v_mfma_f32_16x16x32_bf16 v[184:187], v[108:111], v[76:79], v[184:187]
    ds_read_b64_tr_b16 v[106:107], v14 offset:3680
    v_mfma_f32_16x16x32_bf16 v[188:191], v[108:111], v[80:83], v[188:191]
    v_mfma_f32_16x16x32_bf16 v[192:195], v[108:111], v[84:87], v[192:195]
    v_mfma_f32_16x16x32_bf16 v[196:199], v[108:111], v[88:91], v[196:199]
    ds_read_b64_tr_b16 v[108:109], v14 offset:128
    v_mfma_f32_16x16x32_bf16 v[200:203], v[112:115], v[76:79], v[200:203]
    ds_read_b64_tr_b16 v[110:111], v14 offset:3712
    v_mfma_f32_16x16x32_bf16 v[204:207], v[112:115], v[80:83], v[204:207]
    buffer_load_dwordx4 v16, s[16:19], s58 offen sc1 lds
    v_mfma_f32_16x16x32_bf16 v[208:211], v[112:115], v[84:87], v[208:211]
    s_add_u32 s58, s58, 4096
    v_mfma_f32_16x16x32_bf16 v[212:215], v[112:115], v[88:91], v[212:215]
    s_add_u32 m0, m0, 4096
    ds_read_b64_tr_b16 v[112:113], v14 offset:160
    v_mfma_f32_16x16x32_bf16 v[216:219], v[116:119], v[76:79], v[216:219]
    ds_read_b64_tr_b16 v[114:115], v14 offset:3744
    v_mfma_f32_16x16x32_bf16 v[220:223], v[116:119], v[80:83], v[220:223]
    v_mfma_f32_16x16x32_bf16 v[224:227], v[116:119], v[84:87], v[224:227]
    v_mfma_f32_16x16x32_bf16 v[228:231], v[116:119], v[88:91], v[228:231]
    s_waitcnt vmcnt(13) lgkmcnt(4)
    ds_read_b64_tr_b16 v[116:117], v14 offset:192
    s_mov_b32 s53, 4
    .p2align 6
K5_LOOP:
    v_mfma_f32_16x16x32_bf16 v[120:123], v[92:95], v[28:31], v[120:123]
    ds_read_b64_tr_b16 v[118:119], v14 offset:3776
    v_mfma_f32_16x16x32_bf16 v[124:127], v[92:95], v[32:35], v[124:127]
    buffer_load_dwordx4 v[76:79], v12, s[28:31], s48 offen offset:0 sc1
    v_mfma_f32_16x16x32_bf16 v[128:131], v[92:95], v[36:39], v[128:131]
    buffer_load_dwordx4 v[80:83], v12, s[28:31], s48 offen offset:1024 sc1
    v_mfma_f32_16x16x32_bf16 v[132:135], v[92:95], v[40:43], v[132:135]
    ds_read_b64_tr_b16 v[92:93], v14 offset:7168
    v_mfma_f32_16x16x32_bf16 v[136:139], v[96:99], v[28:31], v[136:139]
    ds_read_b64_tr_b16 v[94:95], v14 offset:10752
    v_mfma_f32_16x16x32_bf16 v[140:143], v[96:99], v[32:35], v[140:143]
    buffer_load_dwordx4 v[84:87], v12, s[28:31], s48 offen offset:2048 sc1
    v_mfma_f32_16x16x32_bf16 v[144:147], v[96:99], v[36:39], v[144:147]
    buffer_load_dwordx4 v[88:91], v12, s[28:31], s48 offen offset:3072 sc1
    v_mfma_f32_16x16x32_bf16 v[148:151], v[96:99], v[40:43], v[148:151]
    ds_read_b64_tr_b16 v[96:97], v14 offset:7200
    v_mfma_f32_16x16x32_bf16 v[152:155], v[100:103], v[28:31], v[152:155]
    s_add_u32 s48, s48, 0x20000
    ds_read_b64_tr_b16 v[98:99], v14 offset:10784
    v_mfma_f32_16x16x32_bf16 v[156:159], v[100:103], v[32:35], v[156:159]
    v_mfma_f32_16x16x32_bf16 v[160:163], v[100:103], v[36:39], v[160:163]
    v_mfma_f32_16x16x32_bf16 v[164:167], v[100:103], v[40:43], v[164:167]
    s_waitcnt lgkmcnt(4)
    ds_read_b64_tr_b16 v[100:101], v14 offset:7232
    v_mfma_f32_16x16x32_bf16 v[168:171], v[104:107], v[28:31], v[168:171]
    s_and_b32 s48, s48, 0x3fffff
    ds_read_b64_tr_b16 v[102:103], v14 offset:10816
    v_mfma_f32_16x16x32_bf16 v[172:175], v[104:107], v[32:35], v[172:175]
    buffer_load_dwordx4 v16, s[16:19], s58 offen sc1 lds
    v_mfma_f32_16x16x32_bf16 v[176:179], v[104:107], v[36:39], v[176:179]
    s_add_u32 s58, s58, 4096
    v_mfma_f32_16x16x32_bf16 v[180:183], v[104:107], v[40:43], v[180:183]
    s_add_u32 m0, m0, 4096
    ds_read_b64_tr_b16 v[104:105], v14 offset:7264
    v_mfma_f32_16x16x32_bf16 v[184:187], v[108:111], v[28:31], v[184:187]
    ds_read_b64_tr_b16 v[106:107], v14 offset:10848
    v_mfma_f32_16x16x32_bf16 v[188:191], v[108:111], v[32:35], v[188:191]
    v_mfma_f32_16x16x32_bf16 v[192:195], v[108:111], v[36:39], v[192:195]
    v_mfma_f32_16x16x32_bf16 v[196:199], v[108:111], v[40:43], v[196:199]
    ds_read_b64_tr_b16 v[108:109], v14 offset:7296
    v_mfma_f32_16x16x32_bf16 v[200:203], v[112:115], v[28:31], v[200:203]
    ds_read_b64_tr_b16 v[110:111], v14 offset:10880
    v_mfma_f32_16x16x32_bf16 v[204:207], v[112:115], v[32:35], v[204:207]
    buffer_load_dwordx4 v16, s[16:19], s58 offen sc1 lds
    v_mfma_f32_16x16x32_bf16 v[208:211], v[112:115], v[36:39], v[208:211]
    s_add_u32 s58, s58, 4096
    v_mfma_f32_16x16x32_bf16 v[212:215], v[112:115], v[40:43], v[212:215]
    s_add_u32 m0, m0, 4096
    ds_read_b64_tr_b16 v[112:113], v14 offset:7328
    v_mfma_f32_16x16x32_bf16 v[216:219], v[116:119], v[28:31], v[216:219]
    ds_read_b64_tr_b16 v[114:115], v14 offset:10912
    v_mfma_f32_16x16x32_bf16 v[220:223], v[116:119], v[32:35], v[220:223]
    v_mfma_f32_16x16x32_bf16 v[224:227], v[116:119], v[36:39], v[224:227]
    v_mfma_f32_16x16x32_bf16 v[228:231], v[116:119], v[40:43], v[228:231]
    s_waitcnt vmcnt(13) lgkmcnt(4)
    ds_read_b64_tr_b16 v[116:117], v14 offset:7360
    v_mfma_f32_16x16x32_bf16 v[120:123], v[92:95], v[44:47], v[120:123]
    ds_read_b64_tr_b16 v[118:119], v14 offset:10944
    v_mfma_f32_16x16x32_bf16 v[124:127], v[92:95], v[48:51], v[124:127]
    buffer_load_dwordx4 v[28:31], v12, s[28:31], s48 offen offset:0 sc1
    v_mfma_f32_16x16x32_bf16 v[128:131], v[92:95], v[52:55], v[128:131]
    buffer_load_dwordx4 v[32:35], v12, s[28:31], s48 offen offset:1024 sc1
    v_mfma_f32_16x16x32_bf16 v[132:135], v[92:95], v[56:59], v[132:135]
    ds_read_b64_tr_b16 v[92:93], v14 offset:14336
    v_mfma_f32_16x16x32_bf16 v[136:139], v[96:99], v[44:47], v[136:139]
    ds_read_b64_tr_b16 v[94:95], v14 offset:17920
    v_mfma_f32_16x16x32_bf16 v[140:143], v[96:99], v[48:51], v[140:143]
    buffer_load_dwordx4 v[36:39], v12, s[28:31], s48 offen offset:2048 sc1
    v_mfma_f32_16x16x32_bf16 v[144:147], v[96:99], v[52:55], v[144:147]
    buffer_load_dwordx4 v[40:43], v12, s[28:31], s48 offen offset:3072 sc1
    v_mfma_f32_16x16x32_bf16 v[148:151], v[96:99], v[56:59], v[148:151]
    ds_read_b64_tr_b16 v[96:97], v14 offset:14368
    v_mfma_f32_16x16x32_bf16 v[152:155], v[100:103], v[44:47], v[152:155]
    s_add_u32 s48, s48, 0x20000
    ds_read_b64_tr_b16 v[98:99], v14 offset:17952
    v_mfma_f32_16x16x32_bf16 v[156:159], v[100:103], v[48:51], v[156:159]
    v_mfma_f32_16x16x32_bf16 v[160:163], v[100:103], v[52:55], v[160:163]
    v_mfma_f32_16x16x32_bf16 v[164:167], v[100:103], v[56:59], v[164:167]
    s_waitcnt lgkmcnt(4)
    ds_read_b64_tr_b16 v[100:101], v14 offset:14400
    v_mfma_f32_16x16x32_bf16 v[168:171], v[104:107], v[44:47], v[168:171]
    s_and_b32 s48, s48, 0x3fffff
    ds_read_b64_tr_b16 v[102:103], v14 offset:17984
    v_mfma_f32_16x16x32_bf16 v[172:175], v[104:107], v[48:51], v[172:175]
    buffer_load_dwordx4 v16, s[16:19], s58 offen sc1 lds
    v_mfma_f32_16x16x32_bf16 v[176:179], v[104:107], v[52:55], v[176:179]
    s_add_u32 s58, s58, 4096
    v_mfma_f32_16x16x32_bf16 v[180:183], v[104:107], v[56:59], v[180:183]
    s_add_u32 m0, m0, 4096
    ds_read_b64_tr_b16 v[104:105], v14 offset:14432
    v_mfma_f32_16x16x32_bf16 v[184:187], v[108:111], v[44:47], v[184:187]
    ds_read_b64_tr_b16 v[106:107], v14 offset:18016
    v_mfma_f32_16x16x32_bf16 v[188:191], v[108:111], v[48:51], v[188:191]
    v_mfma_f32_16x16x32_bf16 v[192:195], v[108:111], v[52:55], v[192:195]
    v_mfma_f32_16x16x32_bf16 v[196:199], v[108:111], v[56:59], v[196:199]
    ds_read_b64_tr_b16 v[108:109], v14 offset:14464
    v_mfma_f32_16x16x32_bf16 v[200:203], v[112:115], v[44:47], v[200:203]
    ds_read_b64_tr_b16 v[110:111], v14 offset:18048
    v_mfma_f32_16x16x32_bf16 v[204:207], v[112:115], v[48:51], v[204:207]
    buffer_load_dwordx4 v16, s[16:19], s58 offen sc1 lds
    v_mfma_f32_16x16x32_bf16 v[208:211], v[112:115], v[52:55], v[208:211]
    s_add_u32 s58, s58, 4096
    v_mfma_f32_16x16x32_bf16 v[212:215], v[112:115], v[56:59], v[212:215]
    s_add_u32 m0, m0, 4096
    ds_read_b64_tr_b16 v[112:113], v14 offset:14496
    v_mfma_f32_16x16x32_bf16 v[216:219], v[116:119], v[44:47], v[216:219]
    ds_read_b64_tr_b16 v[114:115], v14 offset:18080
    v_mfma_f32_16x16x32_bf16 v[220:223], v[116:119], v[48:51], v[220:223]
    v_mfma_f32_16x16x32_bf16 v[224:227], v[116:119], v[52:55], v[224:227]
    v_mfma_f32_16x16x32_bf16 v[228:231], v[116:119], v[56:59], v[228:231]
    s_waitcnt vmcnt(14) lgkmcnt(4)
    ds_read_b64_tr_b16 v[116:117], v14 offset:14528
    v_mfma_f32_16x16x32_bf16 v[120:123], v[92:95], v[60:63], v[120:123]
    ds_read_b64_tr_b16 v[118:119], v14 offset:18112
    v_mfma_f32_16x16x32_bf16 v[124:127], v[92:95], v[64:67], v[124:127]
    buffer_load_dwordx4 v[44:47], v12, s[28:31], s48 offen offset:0 sc1
    v_mfma_f32_16x16x32_bf16 v[128:131], v[92:95], v[68:71], v[128:131]
    buffer_load_dwordx4 v[48:51], v12, s[28:31], s48 offen offset:1024 sc1
    v_mfma_f32_16x16x32_bf16 v[132:135], v[92:95], v[72:75], v[132:135]
    ds_read_b64_tr_b16 v[92:93], v14 offset:21504
    v_mfma_f32_16x16x32_bf16 v[136:139], v[96:99], v[60:63], v[136:139]
    ds_read_b64_tr_b16 v[94:95], v14 offset:25088
    v_mfma_f32_16x16x32_bf16 v[140:143], v[96:99], v[64:67], v[140:143]
    buffer_load_dwordx4 v[52:55], v12, s[28:31], s48 offen offset:2048 sc1
    v_mfma_f32_16x16x32_bf16 v[144:147], v[96:99], v[68:71], v[144:147]
    buffer_load_dwordx4 v[56:59], v12, s[28:31], s48 offen offset:3072 sc1
    v_mfma_f32_16x16x32_bf16 v[148:151], v[96:99], v[72:75], v[148:151]
    ds_read_b64_tr_b16 v[96:97], v14 offset:21536
    v_mfma_f32_16x16x32_bf16 v[152:155], v[100:103], v[60:63], v[152:155]
    s_add_u32 s48, s48, 0x20000
    ds_read_b64_tr_b16 v[98:99], v14 offset:25120
    v_mfma_f32_16x16x32_bf16 v[156:159], v[100:103], v[64:67], v[156:159]
    v_mfma_f32_16x16x32_bf16 v[160:163], v[100:103], v[68:71], v[160:163]
    v_mfma_f32_16x16x32_bf16 v[164:167], v[100:103], v[72:75], v[164:167]
    s_waitcnt lgkmcnt(4)
    ds_read_b64_tr_b16 v[100:101], v14 offset:21568
    v_mfma_f32_16x16x32_bf16 v[168:171], v[104:107], v[60:63], v[168:171]
    s_and_b32 s48, s48, 0x3fffff
    ds_read_b64_tr_b16 v[102:103], v14 offset:25152
    v_mfma_f32_16x16x32_bf16 v[172:175], v[104:107], v[64:67], v[172:175]
    buffer_load_dwordx4 v16, s[16:19], s58 offen sc1 lds
    v_mfma_f32_16x16x32_bf16 v[176:179], v[104:107], v[68:71], v[176:179]
    s_add_u32 s58, s58, 4096
    v_mfma_f32_16x16x32_bf16 v[180:183], v[104:107], v[72:75], v[180:183]
    s_add_u32 m0, m0, 4096
    ds_read_b64_tr_b16 v[104:105], v14 offset:21600
    v_mfma_f32_16x16x32_bf16 v[184:187], v[108:111], v[60:63], v[184:187]
    ds_read_b64_tr_b16 v[106:107], v14 offset:25184
    v_mfma_f32_16x16x32_bf16 v[188:191], v[108:111], v[64:67], v[188:191]
    v_mfma_f32_16x16x32_bf16 v[192:195], v[108:111], v[68:71], v[192:195]
    v_mfma_f32_16x16x32_bf16 v[196:199], v[108:111], v[72:75], v[196:199]
    ds_read_b64_tr_b16 v[108:109], v14 offset:21632
    v_mfma_f32_16x16x32_bf16 v[200:203], v[112:115], v[60:63], v[200:203]
    ds_read_b64_tr_b16 v[110:111], v14 offset:25216
    v_mfma_f32_16x16x32_bf16 v[204:207], v[112:115], v[64:67], v[204:207]
    v_mfma_f32_16x16x32_bf16 v[208:211], v[112:115], v[68:71], v[208:211]
    v_mfma_f32_16x16x32_bf16 v[212:215], v[112:115], v[72:75], v[212:215]
    ds_read_b64_tr_b16 v[112:113], v14 offset:21664
    v_mfma_f32_16x16x32_bf16 v[216:219], v[116:119], v[60:63], v[216:219]
    s_cmp_eq_u32 s58, 229376
    ds_read_b64_tr_b16 v[114:115], v14 offset:25248
    v_mfma_f32_16x16x32_bf16 v[220:223], v[116:119], v[64:67], v[220:223]
    s_cselect_b32 s58, 0, s58
    v_mfma_f32_16x16x32_bf16 v[224:227], v[116:119], v[68:71], v[224:227]
    v_mfma_f32_16x16x32_bf16 v[228:231], v[116:119], v[72:75], v[228:231]
    s_waitcnt vmcnt(13) lgkmcnt(4)
    ds_read_b64_tr_b16 v[116:117], v14 offset:21696
    v_mfma_f32_16x16x32_bf16 v[120:123], v[92:95], v[76:79], v[120:123]
    s_add_u32 m0, s50, s44
    ds_read_b64_tr_b16 v[118:119], v14 offset:25280
    v_mfma_f32_16x16x32_bf16 v[124:127], v[92:95], v[80:83], v[124:127]
    s_mov_b32 s57, s50
    buffer_load_dwordx4 v[60:63], v12, s[28:31], s48 offen offset:0 sc1
    v_mfma_f32_16x16x32_bf16 v[128:131], v[92:95], v[84:87], v[128:131]
    v_add_u32 v14, s51, v13
    buffer_load_dwordx4 v[64:67], v12, s[28:31], s48 offen offset:1024 sc1
    s_waitcnt lgkmcnt(0)
    s_barrier
    v_mfma_f32_16x16x32_bf16 v[132:135], v[92:95], v[88:91], v[132:135]
    ds_read_b64_tr_b16 v[92:93], v14 offset:0
    v_mfma_f32_16x16x32_bf16 v[136:139], v[96:99], v[76:79], v[136:139]
    s_mov_b32 s50, s51
    ds_read_b64_tr_b16 v[94:95], v14 offset:3584
    v_mfma_f32_16x16x32_bf16 v[140:143], v[96:99], v[80:83], v[140:143]
    s_mov_b32 s51, s52
    buffer_load_dwordx4 v[68:71], v12, s[28:31], s48 offen offset:2048 sc1
    v_mfma_f32_16x16x32_bf16 v[144:147], v[96:99], v[84:87], v[144:147]
    s_mov_b32 s52, s57
    buffer_load_dwordx4 v[72:75], v12, s[28:31], s48 offen offset:3072 sc1
    v_mfma_f32_16x16x32_bf16 v[148:151], v[96:99], v[88:91], v[148:151]
    ds_read_b64_tr_b16 v[96:97], v14 offset:32
    v_mfma_f32_16x16x32_bf16 v[152:155], v[100:103], v[76:79], v[152:155]
    s_add_u32 s48, s48, 0x20000
    ds_read_b64_tr_b16 v[98:99], v14 offset:3616
    v_mfma_f32_16x16x32_bf16 v[156:159], v[100:103], v[80:83], v[156:159]
    v_mfma_f32_16x16x32_bf16 v[160:163], v[100:103], v[84:87], v[160:163]
    v_mfma_f32_16x16x32_bf16 v[164:167], v[100:103], v[88:91], v[164:167]
    s_waitcnt lgkmcnt(4)
    ds_read_b64_tr_b16 v[100:101], v14 offset:64
    v_mfma_f32_16x16x32_bf16 v[168:171], v[104:107], v[76:79], v[168:171]
    s_and_b32 s48, s48, 0x3fffff
    ds_read_b64_tr_b16 v[102:103], v14 offset:3648
    v_mfma_f32_16x16x32_bf16 v[172:175], v[104:107], v[80:83], v[172:175]
    buffer_load_dwordx4 v16, s[16:19], s58 offen sc1 lds
    v_mfma_f32_16x16x32_bf16 v[176:179], v[104:107], v[84:87], v[176:179]
    s_add_u32 s58, s58, 4096
    v_mfma_f32_16x16x32_bf16 v[180:183], v[104:107], v[88:91], v[180:183]
    s_add_u32 m0, m0, 4096
    ds_read_b64_tr_b16 v[104:105], v14 offset:96
    v_mfma_f32_16x16x32_bf16 v[184:187], v[108:111], v[76:79], v[184:187]
    ds_read_b64_tr_b16 v[106:107], v14 offset:3680
    v_mfma_f32_16x16x32_bf16 v[188:191], v[108:111], v[80:83], v[188:191]
    v_mfma_f32_16x16x32_bf16 v[192:195], v[108:111], v[84:87], v[192:195]
    v_mfma_f32_16x16x32_bf16 v[196:199], v[108:111], v[88:91], v[196:199]
    ds_read_b64_tr_b16 v[108:109], v14 offset:128
    v_mfma_f32_16x16x32_bf16 v[200:203], v[112:115], v[76:79], v[200:203]
    ds_read_b64_tr_b16 v[110:111], v14 offset:3712
    v_mfma_f32_16x16x32_bf16 v[204:207], v[112:115], v[80:83], v[204:207]
    buffer_load_dwordx4 v16, s[16:19], s58 offen sc1 lds
    v_mfma_f32_16x16x32_bf16 v[208:211], v[112:115], v[84:87], v[208:211]
    s_add_u32 s58, s58, 4096
    v_mfma_f32_16x16x32_bf16 v[212:215], v[112:115], v[88:91], v[212:215]
    s_add_u32 m0, m0, 4096
    ds_read_b64_tr_b16 v[112:113], v14 offset:160
    v_mfma_f32_16x16x32_bf16 v[216:219], v[116:119], v[76:79], v[216:219]
    ds_read_b64_tr_b16 v[114:115], v14 offset:3744
    v_mfma_f32_16x16x32_bf16 v[220:223], v[116:119], v[80:83], v[220:223]
    v_mfma_f32_16x16x32_bf16 v[224:227], v[116:119], v[84:87], v[224:227]
    v_mfma_f32_16x16x32_bf16 v[228:231], v[116:119], v[88:91], v[228:231]
    s_waitcnt vmcnt(13) lgkmcnt(4)
    ds_read_b64_tr_b16 v[116:117], v14 offset:192
    s_sub_u32 s53, s53, 1
    s_cmp_lg_u32 s53, 0
    s_cbranch_scc1 K5_LOOP
    v_mfma_f32_16x16x32_bf16 v[120:123], v[92:95], v[28:31], v[120:123]
    ds_read_b64_tr_b16 v[118:119], v14 offset:3776
    v_mfma_f32_16x16x32_bf16 v[124:127], v[92:95], v[32:35], v[124:127]
    buffer_load_dwordx4 v[76:79], v12, s[28:31], s48 offen offset:0 sc1
    v_mfma_f32_16x16x32_bf16 v[128:131], v[92:95], v[36:39], v[128:131]
    buffer_load_dwordx4 v[80:83], v12, s[28:31], s48 offen offset:1024 sc1
    v_mfma_f32_16x16x32_bf16 v[132:135], v[92:95], v[40:43], v[132:135]
    ds_read_b64_tr_b16 v[92:93], v14 offset:7168
    v_mfma_f32_16x16x32_bf16 v[136:139], v[96:99], v[28:31], v[136:139]
    ds_read_b64_tr_b16 v[94:95], v14 offset:10752
    v_mfma_f32_16x16x32_bf16 v[140:143], v[96:99], v[32:35], v[140:143]
    buffer_load_dwordx4 v[84:87], v12, s[28:31], s48 offen offset:2048 sc1
    v_mfma_f32_16x16x32_bf16 v[144:147], v[96:99], v[36:39], v[144:147]
    buffer_load_dwordx4 v[88:91], v12, s[28:31], s48 offen offset:3072 sc1
    v_mfma_f32_16x16x32_bf16 v[148:151], v[96:99], v[40:43], v[148:151]
    ds_read_b64_tr_b16 v[96:97], v14 offset:7200
    buffer_load_dword v252, v19, s[24:27], s55 offen sc1
    v_mfma_f32_16x16x32_bf16 v[152:155], v[100:103], v[28:31], v[152:155]
    s_add_u32 s48, s48, 0x20000
    ds_read_b64_tr_b16 v[98:99], v14 offset:10784
    v_mfma_f32_16x16x32_bf16 v[156:159], v[100:103], v[32:35], v[156:159]
    buffer_load_dwordx2 a[0:1], v6, s[24:27], s42 offen offset:0 sc1
    v_mfma_f32_16x16x32_bf16 v[160:163], v[100:103], v[36:39], v[160:163]
    buffer_load_dwordx2 a[2:3], v6, s[24:27], s42 offen offset:128 sc1
    v_mfma_f32_16x16x32_bf16 v[164:167], v[100:103], v[40:43], v[164:167]
    s_waitcnt lgkmcnt(4)
    ds_read_b64_tr_b16 v[100:101], v14 offset:7232
    v_mfma_f32_16x16x32_bf16 v[168:171], v[104:107], v[28:31], v[168:171]
    s_and_b32 s48, s48, 0x3fffff
    ds_read_b64_tr_b16 v[102:103], v14 offset:10816
    v_mfma_f32_16x16x32_bf16 v[172:175], v[104:107], v[32:35], v[172:175]
    buffer_load_dwordx4 v16, s[16:19], s58 offen sc1 lds
    v_mfma_f32_16x16x32_bf16 v[176:179], v[104:107], v[36:39], v[176:179]
    s_add_u32 s58, s58, 4096
    buffer_load_dwordx2 a[4:5], v6, s[24:27], s42 offen offset:256 sc1
    v_mfma_f32_16x16x32_bf16 v[180:183], v[104:107], v[40:43], v[180:183]
    s_add_u32 m0, m0, 4096
    ds_read_b64_tr_b16 v[104:105], v14 offset:7264
    v_mfma_f32_16x16x32_bf16 v[184:187], v[108:111], v[28:31], v[184:187]
    ds_read_b64_tr_b16 v[106:107], v14 offset:10848
    v_mfma_f32_16x16x32_bf16 v[188:191], v[108:111], v[32:35], v[188:191]
    buffer_load_dwordx2 a[6:7], v6, s[24:27], s42 offen offset:384 sc1
    v_mfma_f32_16x16x32_bf16 v[192:195], v[108:111], v[36:39], v[192:195]
    buffer_load_dwordx2 a[8:9], v6, s[24:27], s42 offen offset:2048 sc1
    v_mfma_f32_16x16x32_bf16 v[196:199], v[108:111], v[40:43], v[196:199]
    ds_read_b64_tr_b16 v[108:109], v14 offset:7296
    v_mfma_f32_16x16x32_bf16 v[200:203], v[112:115], v[28:31], v[200:203]
    ds_read_b64_tr_b16 v[110:111], v14 offset:10880
    v_mfma_f32_16x16x32_bf16 v[204:207], v[112:115], v[32:35], v[204:207]
    buffer_load_dwordx4 v16, s[16:19], s58 offen sc1 lds
    v_mfma_f32_16x16x32_bf16 v[208:211], v[112:115], v[36:39], v[208:211]
    s_add_u32 s58, s58, 4096
    buffer_load_dwordx2 a[10:11], v6, s[24:27], s42 offen offset:2176 sc1
    v_mfma_f32_16x16x32_bf16 v[212:215], v[112:115], v[40:43], v[212:215]
    s_add_u32 m0, m0, 4096
    ds_read_b64_tr_b16 v[112:113], v14 offset:7328
    v_mfma_f32_16x16x32_bf16 v[216:219], v[116:119], v[28:31], v[216:219]
    ds_read_b64_tr_b16 v[114:115], v14 offset:10912
    v_mfma_f32_16x16x32_bf16 v[220:223], v[116:119], v[32:35], v[220:223]
    buffer_load_dwordx2 a[12:13], v6, s[24:27], s42 offen offset:2304 sc1
    v_mfma_f32_16x16x32_bf16 v[224:227], v[116:119], v[36:39], v[224:227]
    buffer_load_dwordx2 a[14:15], v6, s[24:27], s42 offen offset:2432 sc1
    v_mfma_f32_16x16x32_bf16 v[228:231], v[116:119], v[40:43], v[228:231]
    s_waitcnt vmcnt(22) lgkmcnt(4)
    ds_read_b64_tr_b16 v[116:117], v14 offset:7360
    v_mfma_f32_16x16x32_bf16 v[120:123], v[92:95], v[44:47], v[120:123]
    ds_read_b64_tr_b16 v[118:119], v14 offset:10944
    v_mfma_f32_16x16x32_bf16 v[124:127], v[92:95], v[48:51], v[124:127]
    buffer_load_dwordx4 v[28:31], v12, s[28:31], s48 offen offset:0 sc1
    v_mfma_f32_16x16x32_bf16 v[128:131], v[92:95], v[52:55], v[128:131]
    buffer_load_dwordx4 v[32:35], v12, s[28:31], s48 offen offset:1024 sc1
    v_mfma_f32_16x16x32_bf16 v[132:135], v[92:95], v[56:59], v[132:135]
    ds_read_b64_tr_b16 v[92:93], v14 offset:14336
    v_mfma_f32_16x16x32_bf16 v[136:139], v[96:99], v[44:47], v[136:139]
    ds_read_b64_tr_b16 v[94:95], v14 offset:17920
    v_mfma_f32_16x16x32_bf16 v[140:143], v[96:99], v[48:51], v[140:143]
    buffer_load_dwordx4 v[36:39], v12, s[28:31], s48 offen offset:2048 sc1
    v_mfma_f32_16x16x32_bf16 v[144:147], v[96:99], v[52:55], v[144:147]
    buffer_load_dwordx4 v[40:43], v12, s[28:31], s48 offen offset:3072 sc1
    v_mfma_f32_16x16x32_bf16 v[148:151], v[96:99], v[56:59], v[148:151]
    ds_read_b64_tr_b16 v[96:97], v14 offset:14368
    v_mfma_f32_16x16x32_bf16 v[152:155], v[100:103], v[44:47], v[152:155]
    s_add_u32 s48, s48, 0x20000
    ds_read_b64_tr_b16 v[98:99], v14 offset:17952
    v_mfma_f32_16x16x32_bf16 v[156:159], v[100:103], v[48:51], v[156:159]
    buffer_load_dwordx2 a[16:17], v6, s[24:27], s43 offen offset:0 sc1
    v_mfma_f32_16x16x32_bf16 v[160:163], v[100:103], v[52:55], v[160:163]
    buffer_load_dwordx2 a[18:19], v6, s[24:27], s43 offen offset:128 sc1
    v_mfma_f32_16x16x32_bf16 v[164:167], v[100:103], v[56:59], v[164:167]
    s_waitcnt lgkmcnt(4)
    ds_read_b64_tr_b16 v[100:101], v14 offset:14400
    v_mfma_f32_16x16x32_bf16 v[168:171], v[104:107], v[44:47], v[168:171]
    s_and_b32 s48, s48, 0x3fffff
    ds_read_b64_tr_b16 v[102:103], v14 offset:17984
    v_mfma_f32_16x16x32_bf16 v[172:175], v[104:107], v[48:51], v[172:175]
    buffer_load_dwordx4 v16, s[16:19], s58 offen sc1 lds
    v_mfma_f32_16x16x32_bf16 v[176:179], v[104:107], v[52:55], v[176:179]
    s_add_u32 s58, s58, 4096
    buffer_load_dwordx2 a[20:21], v6, s[24:27], s43 offen offset:256 sc1
    v_mfma_f32_16x16x32_bf16 v[180:183], v[104:107], v[56:59], v[180:183]
    s_add_u32 m0, m0, 4096
    ds_read_b64_tr_b16 v[104:105], v14 offset:14432
    v_mfma_f32_16x16x32_bf16 v[184:187], v[108:111], v[44:47], v[184:187]
    ds_read_b64_tr_b16 v[106:107], v14 offset:18016
    v_mfma_f32_16x16x32_bf16 v[188:191], v[108:111], v[48:51], v[188:191]
    buffer_load_dwordx2 a[22:23], v6, s[24:27], s43 offen offset:384 sc1
    v_mfma_f32_16x16x32_bf16 v[192:195], v[108:111], v[52:55], v[192:195]
    buffer_load_dwordx2 a[24:25], v6, s[24:27], s43 offen offset:2048 sc1
    v_mfma_f32_16x16x32_bf16 v[196:199], v[108:111], v[56:59], v[196:199]
    ds_read_b64_tr_b16 v[108:109], v14 offset:14464
    v_mfma_f32_16x16x32_bf16 v[200:203], v[112:115], v[44:47], v[200:203]
    ds_read_b64_tr_b16 v[110:111], v14 offset:18048
    v_mfma_f32_16x16x32_bf16 v[204:207], v[112:115], v[48:51], v[204:207]
    buffer_load_dwordx4 v16, s[16:19], s58 offen sc1 lds
    v_mfma_f32_16x16x32_bf16 v[208:211], v[112:115], v[52:55], v[208:211]
    s_add_u32 s58, s58, 4096
    buffer_load_dwordx2 a[26:27], v6, s[24:27], s43 offen offset:2176 sc1
    v_mfma_f32_16x16x32_bf16 v[212:215], v[112:115], v[56:59], v[212:215]
    s_add_u32 m0, m0, 4096
    ds_read_b64_tr_b16 v[112:113], v14 offset:14496
    v_mfma_f32_16x16x32_bf16 v[216:219], v[116:119], v[44:47], v[216:219]
    ds_read_b64_tr_b16 v[114:115], v14 offset:18080
    v_mfma_f32_16x16x32_bf16 v[220:223], v[116:119], v[48:51], v[220:223]
    buffer_load_dwordx2 a[28:29], v6, s[24:27], s43 offen offset:2304 sc1
    v_mfma_f32_16x16x32_bf16 v[224:227], v[116:119], v[52:55], v[224:227]
    buffer_load_dwordx2 a[30:31], v6, s[24:27], s43 offen offset:2432 sc1
    v_mfma_f32_16x16x32_bf16 v[228:231], v[116:119], v[56:59], v[228:231]
    s_waitcnt vmcnt(31) lgkmcnt(4)
    ds_read_b64_tr_b16 v[116:117], v14 offset:14528
    v_mfma_f32_16x16x32_bf16 v[120:123], v[92:95], v[60:63], v[120:123]
    ds_read_b64_tr_b16 v[118:119], v14 offset:18112
    v_mfma_f32_16x16x32_bf16 v[124:127], v[92:95], v[64:67], v[124:127]
    buffer_load_dwordx4 v[44:47], v12, s[28:31], s48 offen offset:0 sc1
    v_mfma_f32_16x16x32_bf16 v[128:131], v[92:95], v[68:71], v[128:131]
    buffer_load_dwordx4 v[48:51], v12, s[28:31], s48 offen offset:1024 sc1
    v_mfma_f32_16x16x32_bf16 v[132:135], v[92:95], v[72:75], v[132:135]
    ds_read_b64_tr_b16 v[92:93], v14 offset:21504
    v_mfma_f32_16x16x32_bf16 v[136:139], v[96:99], v[60:63], v[136:139]
    ds_read_b64_tr_b16 v[94:95], v14 offset:25088
    v_mfma_f32_16x16x32_bf16 v[140:143], v[96:99], v[64:67], v[140:143]
    buffer_load_dwordx4 v[52:55], v12, s[28:31], s48 offen offset:2048 sc1
    v_mfma_f32_16x16x32_bf16 v[144:147], v[96:99], v[68:71], v[144:147]
    buffer_load_dwordx4 v[56:59], v12, s[28:31], s48 offen offset:3072 sc1
    v_mfma_f32_16x16x32_bf16 v[148:151], v[96:99], v[72:75], v[148:151]
    ds_read_b64_tr_b16 v[96:97], v14 offset:21536
    v_mfma_f32_16x16x32_bf16 v[152:155], v[100:103], v[60:63], v[152:155]
    s_add_u32 s48, s48, 0x20000
    ds_read_b64_tr_b16 v[98:99], v14 offset:25120
    v_mfma_f32_16x16x32_bf16 v[156:159], v[100:103], v[64:67], v[156:159]
    v_mfma_f32_16x16x32_bf16 v[160:163], v[100:103], v[68:71], v[160:163]
    v_mfma_f32_16x16x32_bf16 v[164:167], v[100:103], v[72:75], v[164:167]
    s_waitcnt lgkmcnt(4)
    ds_read_b64_tr_b16 v[100:101], v14 offset:21568
    v_mfma_f32_16x16x32_bf16 v[168:171], v[104:107], v[60:63], v[168:171]
    s_and_b32 s48, s48, 0x3fffff
    ds_read_b64_tr_b16 v[102:103], v14 offset:25152
    v_mfma_f32_16x16x32_bf16 v[172:175], v[104:107], v[64:67], v[172:175]
    buffer_load_dwordx4 v16, s[16:19], s58 offen sc1 lds
    v_mfma_f32_16x16x32_bf16 v[176:179], v[104:107], v[68:71], v[176:179]
    s_add_u32 s58, s58, 4096
    v_mfma_f32_16x16x32_bf16 v[180:183], v[104:107], v[72:75], v[180:183]
    s_add_u32 m0, m0, 4096
    ds_read_b64_tr_b16 v[104:105], v14 offset:21600
    v_mfma_f32_16x16x32_bf16 v[184:187], v[108:111], v[60:63], v[184:187]
    ds_read_b64_tr_b16 v[106:107], v14 offset:25184
    v_mfma_f32_16x16x32_bf16 v[188:191], v[108:111], v[64:67], v[188:191]
    v_mfma_f32_16x16x32_bf16 v[192:195], v[108:111], v[68:71], v[192:195]
    v_mfma_f32_16x16x32_bf16 v[196:199], v[108:111], v[72:75], v[196:199]
    ds_read_b64_tr_b16 v[108:109], v14 offset:21632
    v_mfma_f32_16x16x32_bf16 v[200:203], v[112:115], v[60:63], v[200:203]
    ds_read_b64_tr_b16 v[110:111], v14 offset:25216
    v_mfma_f32_16x16x32_bf16 v[204:207], v[112:115], v[64:67], v[204:207]
    v_mfma_f32_16x16x32_bf16 v[208:211], v[112:115], v[68:71], v[208:211]
    v_mfma_f32_16x16x32_bf16 v[212:215], v[112:115], v[72:75], v[212:215]
    ds_read_b64_tr_b16 v[112:113], v14 offset:21664
    v_mfma_f32_16x16x32_bf16 v[216:219], v[116:119], v[60:63], v[216:219]
    s_cmp_eq_u32 s58, 229376
    ds_read_b64_tr_b16 v[114:115], v14 offset:25248
    v_mfma_f32_16x16x32_bf16 v[220:223], v[116:119], v[64:67], v[220:223]
    s_cselect_b32 s58, 0, s58
    v_mfma_f32_16x16x32_bf16 v[224:227], v[116:119], v[68:71], v[224:227]
    v_mfma_f32_16x16x32_bf16 v[228:231], v[116:119], v[72:75], v[228:231]
    s_waitcnt vmcnt(29) lgkmcnt(4)
    ds_read_b64_tr_b16 v[116:117], v14 offset:21696
    v_cmp_eq_u32 vcc, 0, v252
    s_nop 0
    s_cmp_eq_u64 vcc, 0
    s_cbranch_scc1 K5_UOK
    s_mov_b32 s60, 0x200000
POLL_U:
    buffer_load_dword v252, v19, s[24:27], s55 offen sc1
    s_sub_u32 s60, s60, 1
    s_waitcnt vmcnt(0)
    v_cmp_eq_u32 vcc, 0, v252
    s_cmp_eq_u32 s60, 0
    s_cbranch_scc1 POLLX_U
    s_cmp_eq_u64 vcc, 0
    s_cbranch_scc1 POLLX_U
    s_sleep 4
    s_branch POLL_U
POLLX_U:
K5_UOK:
    s_mul_i32 s56, s41, 458752
    s_add_u32 s4, s10, s56
    s_addc_u32 s5, s11, 0
    s_add_u32 s12, s4, 0x2c00000
    s_addc_u32 s13, s5, 0
    s_and_b32 s13, s13, 0xffff
    s_mov_b32 s14, 0x70000
    s_mov_b32 s15, 0x20000
    s_lshl_b32 s58, s36, 11
    s_mov_b32 m0, s58
    s_mov_b32 s59, 0
    v_add_u32 v3, s58, v2
    v_mfma_f32_16x16x32_bf16 v[120:123], v[92:95], v[76:79], v[120:123]
    ds_read_b64_tr_b16 v[118:119], v14 offset:25280
    v_mfma_f32_16x16x32_bf16 v[124:127], v[92:95], v[80:83], v[124:127]
    s_mov_b32 s57, s50
    buffer_load_dwordx4 v[60:63], v12, s[28:31], s48 offen offset:0 sc1
    v_mfma_f32_16x16x32_bf16 v[128:131], v[92:95], v[84:87], v[128:131]
    v_add_u32 v14, s51, v13
    buffer_load_dwordx4 v[64:67], v12, s[28:31], s48 offen offset:1024 sc1
    s_waitcnt lgkmcnt(0)
    s_barrier
    v_mfma_f32_16x16x32_bf16 v[132:135], v[92:95], v[88:91], v[132:135]
    ds_read_b64_tr_b16 v[92:93], v14 offset:0
    v_mfma_f32_16x16x32_bf16 v[136:139], v[96:99], v[76:79], v[136:139]
    s_mov_b32 s50, s51
    ds_read_b64_tr_b16 v[94:95], v14 offset:3584
    v_mfma_f32_16x16x32_bf16 v[140:143], v[96:99], v[80:83], v[140:143]
    s_mov_b32 s51, s52
    buffer_load_dwordx4 v[68:71], v12, s[28:31], s48 offen offset:2048 sc1
    v_mfma_f32_16x16x32_bf16 v[144:147], v[96:99], v[84:87], v[144:147]
    s_mov_b32 s52, s57
    buffer_load_dwordx4 v[72:75], v12, s[28:31], s48 offen offset:3072 sc1
    v_mfma_f32_16x16x32_bf16 v[148:151], v[96:99], v[88:91], v[148:151]
    ds_read_b64_tr_b16 v[96:97], v14 offset:32
    v_mfma_f32_16x16x32_bf16 v[152:155], v[100:103], v[76:79], v[152:155]
    s_add_u32 s48, s48, 0x20000
    ds_read_b64_tr_b16 v[98:99], v14 offset:3616
    v_mfma_f32_16x16x32_bf16 v[156:159], v[100:103], v[80:83], v[156:159]
    buffer_load_dword a32, v7, s[24:27], s54 offen sc1
    s_add_u32 s54, s54, 28672
    v_mfma_f32_16x16x32_bf16 v[160:163], v[100:103], v[84:87], v[160:163]
    buffer_load_dword a33, v7, s[24:27], s54 offen sc1
    s_add_u32 s54, s54, 28672
    v_mfma_f32_16x16x32_bf16 v[164:167], v[100:103], v[88:91], v[164:167]
    s_waitcnt lgkmcnt(4)
    ds_read_b64_tr_b16 v[100:101], v14 offset:64
    v_mfma_f32_16x16x32_bf16 v[168:171], v[104:107], v[76:79], v[168:171]
    s_and_b32 s48, s48, 0x3fffff
    ds_read_b64_tr_b16 v[102:103], v14 offset:3648
    v_mfma_f32_16x16x32_bf16 v[172:175], v[104:107], v[80:83], v[172:175]
    buffer_load_dword a34, v7, s[24:27], s54 offen sc1
    s_add_u32 s54, s54, 28672
    v_mfma_f32_16x16x32_bf16 v[176:179], v[104:107], v[84:87], v[176:179]
    buffer_load_dword a35, v7, s[24:27], s54 offen sc1
    s_add_u32 s54, s54, 28672
    v_mfma_f32_16x16x32_bf16 v[180:183], v[104:107], v[88:91], v[180:183]
    ds_read_b64_tr_b16 v[104:105], v14 offset:96
    v_mfma_f32_16x16x32_bf16 v[184:187], v[108:111], v[76:79], v[184:187]
    ds_read_b64_tr_b16 v[106:107], v14 offset:3680
    v_mfma_f32_16x16x32_bf16 v[188:191], v[108:111], v[80:83], v[188:191]
    buffer_load_dword a36, v7, s[24:27], s54 offen sc1
    s_add_u32 s54, s54, 28672
    v_mfma_f32_16x16x32_bf16 v[192:195], v[108:111], v[84:87], v[192:195]
    buffer_load_dword a37, v7, s[24:27], s54 offen sc1
    s_add_u32 s54, s54, 28672
    v_mfma_f32_16x16x32_bf16 v[196:199], v[108:111], v[88:91], v[196:199]
    ds_read_b64_tr_b16 v[108:109], v14 offset:128
    v_mfma_f32_16x16x32_bf16 v[200:203], v[112:115], v[76:79], v[200:203]
    ds_read_b64_tr_b16 v[110:111], v14 offset:3712
    v_mfma_f32_16x16x32_bf16 v[204:207], v[112:115], v[80:83], v[204:207]
    buffer_load_dword a38, v7, s[24:27], s54 offen sc1
    s_add_u32 s54, s54, 28672
    v_mfma_f32_16x16x32_bf16 v[208:211], v[112:115], v[84:87], v[208:211]
    buffer_load_dword a39, v7, s[24:27], s54 offen sc1
    s_add_u32 s54, s54, 28672
    v_mfma_f32_16x16x32_bf16 v[212:215], v[112:115], v[88:91], v[212:215]
    ds_read_b64_tr_b16 v[112:113], v14 offset:160
    v_mfma_f32_16x16x32_bf16 v[216:219], v[116:119], v[76:79], v[216:219]
    ds_read_b64_tr_b16 v[114:115], v14 offset:3744
    v_mfma_f32_16x16x32_bf16 v[220:223], v[116:119], v[80:83], v[220:223]
    v_mfma_f32_16x16x32_bf16 v[224:227], v[116:119], v[84:87], v[224:227]
    v_mfma_f32_16x16x32_bf16 v[228:231], v[116:119], v[88:91], v[228:231]
    s_waitcnt vmcnt(17) lgkmcnt(4)
    ds_read_b64_tr_b16 v[116:117], v14 offset:192
    v_mfma_f32_16x16x32_bf16 v[120:123], v[92:95], v[28:31], v[120:123]
    ds_read_b64_tr_b16 v[118:119], v14 offset:3776
    v_accvgpr_read_b32 v244, a0
    v_mfma_f32_16x16x32_bf16 v[124:127], v[92:95], v[32:35], v[124:127]
    buffer_load_dwordx4 v[76:79], v12, s[28:31], s48 offen offset:0 sc1
    v_accvgpr_read_b32 v245, a2
    v_mfma_f32_16x16x32_bf16 v[128:131], v[92:95], v[36:39], v[128:131]
    buffer_load_dwordx4 v[80:83], v12, s[28:31], s48 offen offset:1024 sc1
    v_accvgpr_read_b32 v246, a4
    v_mfma_f32_16x16x32_bf16 v[132:135], v[92:95], v[40:43], v[132:135]
    ds_read_b64_tr_b16 v[92:93], v14 offset:7168
    v_accvgpr_read_b32 v247, a6
    v_mfma_f32_16x16x32_bf16 v[136:139], v[96:99], v[28:31], v[136:139]
    ds_read_b64_tr_b16 v[94:95], v14 offset:10752
    v_add_f32 v244, v244, v245
    v_mfma_f32_16x16x32_bf16 v[140:143], v[96:99], v[32:35], v[140:143]
    buffer_load_dwordx4 v[84:87], v12, s[28:31], s48 offen offset:2048 sc1
    v_add_f32 v246, v246, v247
    v_mfma_f32_16x16x32_bf16 v[144:147], v[96:99], v[36:39], v[144:147]
    buffer_load_dwordx4 v[88:91], v12, s[28:31], s48 offen offset:3072 sc1
    v_add_f32 v232, v244, v246
    v_mfma_f32_16x16x32_bf16 v[148:151], v[96:99], v[40:43], v[148:151]
    ds_read_b64_tr_b16 v[96:97], v14 offset:7200
    v_accvgpr_read_b32 v244, a8
    v_mfma_f32_16x16x32_bf16 v[152:155], v[100:103], v[28:31], v[152:155]
    s_add_u32 s48, s48, 0x20000
    ds_read_b64_tr_b16 v[98:99], v14 offset:10784
    v_accvgpr_read_b32 v245, a10
    v_mfma_f32_16x16x32_bf16 v[156:159], v[100:103], v[32:35], v[156:159]
    buffer_load_dwordx4 v3, s[12:15], s59 offen sc1 lds
    v_accvgpr_read_b32 v246, a12
    v_mfma_f32_16x16x32_bf16 v[160:163], v[100:103], v[36:39], v[160:163]
    buffer_load_dwordx4 v3, s[12:15], s59 offen offset:1024 sc1 lds
    v_accvgpr_read_b32 v247, a14
    v_mfma_f32_16x16x32_bf16 v[164:167], v[100:103], v[40:43], v[164:167]
    s_add_u32 s58, s58, 8192
    s_add_u32 s59, s59, 24576
    s_waitcnt lgkmcnt(4)
    ds_read_b64_tr_b16 v[100:101], v14 offset:7232
    v_add_f32 v244, v244, v245
    v_mfma_f32_16x16x32_bf16 v[168:171], v[104:107], v[28:31], v[168:171]
    s_and_b32 s48, s48, 0x3fffff
    s_and_b32 m0, s58, 0x1ffff
    ds_read_b64_tr_b16 v[102:103], v14 offset:10816
    v_add_f32 v246, v246, v247
    v_mfma_f32_16x16x32_bf16 v[172:175], v[104:107], v[32:35], v[172:175]
    v_add_f32 v233, v244, v246
    v_accvgpr_read_b32 v244, a16
    v_mfma_f32_16x16x32_bf16 v[176:179], v[104:107], v[36:39], v[176:179]
    v_accvgpr_read_b32 v245, a18
    v_accvgpr_read_b32 v246, a20
    v_mfma_f32_16x16x32_bf16 v[180:183], v[104:107], v[40:43], v[180:183]
    ds_read_b64_tr_b16 v[104:105], v14 offset:7264
    v_accvgpr_read_b32 v247, a22
    v_mfma_f32_16x16x32_bf16 v[184:187], v[108:111], v[28:31], v[184:187]
    ds_read_b64_tr_b16 v[106:107], v14 offset:10848
    v_add_f32 v244, v244, v245
    v_mfma_f32_16x16x32_bf16 v[188:191], v[108:111], v[32:35], v[188:191]
    buffer_load_dwordx4 v3, s[12:15], s59 offen sc1 lds
    v_add_f32 v246, v246, v247
    v_mfma_f32_16x16x32_bf16 v[192:195], v[108:111], v[36:39], v[192:195]
    buffer_load_dwordx4 v3, s[12:15], s59 offen offset:1024 sc1 lds
    v_add_f32 v234, v244, v246
    v_mfma_f32_16x16x32_bf16 v[196:199], v[108:111], v[40:43], v[196:199]
    s_add_u32 s58, s58, 8192
    s_add_u32 s59, s59, 24576
    ds_read_b64_tr_b16 v[108:109], v14 offset:7296
    v_accvgpr_read_b32 v244, a24
    v_mfma_f32_16x16x32_bf16 v[200:203], v[112:115], v[28:31], v[200:203]
    s_and_b32 m0, s58, 0x1ffff
    ds_read_b64_tr_b16 v[110:111], v14 offset:10880
    v_accvgpr_read_b32 v245, a26
    v_mfma_f32_16x16x32_bf16 v[204:207], v[112:115], v[32:35], v[204:207]
    v_accvgpr_read_b32 v246, a28
    v_accvgpr_read_b32 v247, a30
    v_mfma_f32_16x16x32_bf16 v[208:211], v[112:115], v[36:39], v[208:211]
    v_add_f32 v244, v244, v245
    v_add_f32 v246, v246, v247
    v_mfma_f32_16x16x32_bf16 v[212:215], v[112:115], v[40:43], v[212:215]
    ds_read_b64_tr_b16 v[112:113], v14 offset:7328
    v_add_f32 v235, v244, v246
    v_mfma_f32_16x16x32_bf16 v[216:219], v[116:119], v[28:31], v[216:219]
    ds_read_b64_tr_b16 v[114:115], v14 offset:10912
    v_mov_b32 v240, v232
    v_mfma_f32_16x16x32_bf16 v[220:223], v[116:119], v[32:35], v[220:223]
    v_mov_b32 v241, v233
    v_mov_b32 v242, v234
    v_mfma_f32_16x16x32_bf16 v[224:227], v[116:119], v[36:39], v[224:227]
    v_mov_b32 v243, v235
    s_nop 1
    v_mfma_f32_16x16x32_bf16 v[228:231], v[116:119], v[40:43], v[228:231]
    s_waitcnt vmcnt(21) lgkmcnt(4)
    ds_read_b64_tr_b16 v[116:117], v14 offset:7360
    v_permlane16_swap_b32 v232, v240
    v_mfma_f32_16x16x32_bf16 v[120:123], v[92:95], v[44:47], v[120:123]
    ds_read_b64_tr_b16 v[118:119], v14 offset:10944
    v_permlane16_swap_b32 v233, v241
    v_mfma_f32_16x16x32_bf16 v[124:127], v[92:95], v[48:51], v[124:127]
    buffer_load_dwordx4 v[28:31], v12, s[28:31], s48 offen offset:0 sc1
    v_permlane16_swap_b32 v234, v242
    v_mfma_f32_16x16x32_bf16 v[128:131], v[92:95], v[52:55], v[128:131]
    buffer_load_dwordx4 v[32:35], v12, s[28:31], s48 offen offset:1024 sc1
    v_permlane16_swap_b32 v235, v243
    v_mfma_f32_16x16x32_bf16 v[132:135], v[92:95], v[56:59], v[132:135]
    ds_read_b64_tr_b16 v[92:93], v14 offset:14336
    v_add_f32 v232, v232, v240
    v_mfma_f32_16x16x32_bf16 v[136:139], v[96:99], v[44:47], v[136:139]
    ds_read_b64_tr_b16 v[94:95], v14 offset:17920
    v_add_f32 v233, v233, v241
    v_mfma_f32_16x16x32_bf16 v[140:143], v[96:99], v[48:51], v[140:143]
    buffer_load_dwordx4 v[36:39], v12, s[28:31], s48 offen offset:2048 sc1
    v_add_f32 v234, v234, v242
    v_mfma_f32_16x16x32_bf16 v[144:147], v[96:99], v[52:55], v[144:147]
    buffer_load_dwordx4 v[40:43], v12, s[28:31], s48 offen offset:3072 sc1
    v_add_f32 v235, v235, v243
    v_mfma_f32_16x16x32_bf16 v[148:151], v[96:99], v[56:59], v[148:151]
    ds_read_b64_tr_b16 v[96:97], v14 offset:14368
    v_mov_b32 v240, v232
    v_mfma_f32_16x16x32_bf16 v[152:155], v[100:103], v[44:47], v[152:155]
    s_add_u32 s48, s48, 0x20000
    ds_read_b64_tr_b16 v[98:99], v14 offset:17952
    v_mov_b32 v241, v233
    v_mfma_f32_16x16x32_bf16 v[156:159], v[100:103], v[48:51], v[156:159]
    buffer_load_dwordx4 v3, s[12:15], s59 offen sc1 lds
    v_mov_b32 v242, v234
    v_mfma_f32_16x16x32_bf16 v[160:163], v[100:103], v[52:55], v[160:163]
    buffer_load_dwordx4 v3, s[12:15], s59 offen offset:1024 sc1 lds
    v_mov_b32 v243, v235
    v_mfma_f32_16x16x32_bf16 v[164:167], v[100:103], v[56:59], v[164:167]
    s_add_u32 s58, s58, 8192
    s_add_u32 s59, s59, 24576
    s_waitcnt lgkmcnt(4)
    ds_read_b64_tr_b16 v[100:101], v14 offset:14400
    s_nop 1
    v_mfma_f32_16x16x32_bf16 v[168:171], v[104:107], v[44:47], v[168:171]
    s_and_b32 s48, s48, 0x3fffff
    s_and_b32 m0, s58, 0x1ffff
    ds_read_b64_tr_b16 v[102:103], v14 offset:17984
    v_permlane32_swap_b32 v232, v240
    v_mfma_f32_16x16x32_bf16 v[172:175], v[104:107], v[48:51], v[172:175]
    v_permlane32_swap_b32 v233, v241
    v_permlane32_swap_b32 v234, v242
    v_mfma_f32_16x16x32_bf16 v[176:179], v[104:107], v[52:55], v[176:179]
    v_permlane32_swap_b32 v235, v243
    v_add_f32 v232, v232, v240
    v_mfma_f32_16x16x32_bf16 v[180:183], v[104:107], v[56:59], v[180:183]
    ds_read_b64_tr_b16 v[104:105], v14 offset:14432
    v_add_f32 v233, v233, v241
    v_mfma_f32_16x16x32_bf16 v[184:187], v[108:111], v[44:47], v[184:187]
    ds_read_b64_tr_b16 v[106:107], v14 offset:18016
    v_add_f32 v234, v234, v242
    v_mfma_f32_16x16x32_bf16 v[188:191], v[108:111], v[48:51], v[188:191]
    buffer_load_dwordx4 v3, s[12:15], s59 offen sc1 lds
    v_add_f32 v235, v235, v243
    v_mfma_f32_16x16x32_bf16 v[192:195], v[108:111], v[52:55], v[192:195]
    buffer_load_dwordx4 v3, s[12:15], s59 offen offset:1024 sc1 lds
    v_mul_f32 v232, 0x3a800000, v232
    v_mfma_f32_16x16x32_bf16 v[196:199], v[108:111], v[56:59], v[196:199]
    s_add_u32 s58, s58, 8192
    s_add_u32 s59, s59, 24576
    ds_read_b64_tr_b16 v[108:109], v14 offset:14464
    v_accvgpr_read_b32 v244, a0
    v_mfma_f32_16x16x32_bf16 v[200:203], v[112:115], v[44:47], v[200:203]
    s_and_b32 m0, s58, 0x1ffff
    ds_read_b64_tr_b16 v[110:111], v14 offset:18048
    v_accvgpr_read_b32 v245, a1
    v_mfma_f32_16x16x32_bf16 v[204:207], v[112:115], v[48:51], v[204:207]
    v_accvgpr_read_b32 v246, a2
    v_accvgpr_read_b32 v247, a3
    v_mfma_f32_16x16x32_bf16 v[208:211], v[112:115], v[52:55], v[208:211]
    v_accvgpr_read_b32 v248, a4
    v_accvgpr_read_b32 v249, a5
    v_mfma_f32_16x16x32_bf16 v[212:215], v[112:115], v[56:59], v[212:215]
    ds_read_b64_tr_b16 v[112:113], v14 offset:14496
    v_accvgpr_read_b32 v250, a6
    v_mfma_f32_16x16x32_bf16 v[216:219], v[116:119], v[44:47], v[216:219]
    ds_read_b64_tr_b16 v[114:115], v14 offset:18080
    v_accvgpr_read_b32 v251, a7
    v_mfma_f32_16x16x32_bf16 v[220:223], v[116:119], v[48:51], v[220:223]
    v_add_f32 v245, v245, v247
    v_add_f32 v249, v249, v251
    v_mfma_f32_16x16x32_bf16 v[224:227], v[116:119], v[52:55], v[224:227]
    v_add_f32 v236, v245, v249
    v_fma_f32 v240, v244, s62, -v232
    v_mfma_f32_16x16x32_bf16 v[228:231], v[116:119], v[56:59], v[228:231]
    s_waitcnt vmcnt(16) lgkmcnt(4)
    ds_read_b64_tr_b16 v[116:117], v14 offset:14528
    v_mul_f32 v240, v240, v240
    v_mfma_f32_16x16x32_bf16 v[120:123], v[92:95], v[60:63], v[120:123]
    ds_read_b64_tr_b16 v[118:119], v14 offset:18112
    v_fma_f32 v236, v240, s63, v236
    v_mfma_f32_16x16x32_bf16 v[124:127], v[92:95], v[64:67], v[124:127]
    buffer_load_dwordx4 v[44:47], v12, s[28:31], s48 offen offset:0 sc1
    v_fma_f32 v240, v246, s62, -v232
    v_mfma_f32_16x16x32_bf16 v[128:131], v[92:95], v[68:71], v[128:131]
    buffer_load_dwordx4 v[48:51], v12, s[28:31], s48 offen offset:1024 sc1
    v_mul_f32 v240, v240, v240
    v_mfma_f32_16x16x32_bf16 v[132:135], v[92:95], v[72:75], v[132:135]
    ds_read_b64_tr_b16 v[92:93], v14 offset:21504
    v_fma_f32 v236, v240, s63, v236
    v_mfma_f32_16x16x32_bf16 v[136:139], v[96:99], v[60:63], v[136:139]
    ds_read_b64_tr_b16 v[94:95], v14 offset:25088
    v_fma_f32 v240, v248, s62, -v232
    v_mfma_f32_16x16x32_bf16 v[140:143], v[96:99], v[64:67], v[140:143]
    buffer_load_dwordx4 v[52:55], v12, s[28:31], s48 offen offset:2048 sc1
    v_mul_f32 v240, v240, v240
    v_mfma_f32_16x16x32_bf16 v[144:147], v[96:99], v[68:71], v[144:147]
    buffer_load_dwordx4 v[56:59], v12, s[28:31], s48 offen offset:3072 sc1
    v_fma_f32 v236, v240, s63, v236
    v_mfma_f32_16x16x32_bf16 v[148:151], v[96:99], v[72:75], v[148:151]
    ds_read_b64_tr_b16 v[96:97], v14 offset:21536
    v_fma_f32 v240, v250, s62, -v232
    v_mfma_f32_16x16x32_bf16 v[152:155], v[100:103], v[60:63], v[152:155]
    s_add_u32 s48, s48, 0x20000
    ds_read_b64_tr_b16 v[98:99], v14 offset:25120
    v_mul_f32 v240, v240, v240
    v_mfma_f32_16x16x32_bf16 v[156:159], v[100:103], v[64:67], v[156:159]
    buffer_load_dwordx4 v3, s[12:15], s59 offen sc1 lds
    v_fma_f32 v236, v240, s63, v236
    v_mfma_f32_16x16x32_bf16 v[160:163], v[100:103], v[68:71], v[160:163]
    buffer_load_dwordx4 v3, s[12:15], s59 offen offset:1024 sc1 lds
    v_mul_f32 v233, 0x3a800000, v233
    v_mfma_f32_16x16x32_bf16 v[164:167], v[100:103], v[72:75], v[164:167]
    s_add_u32 s58, s58, 8192
    s_add_u32 s59, s59, 24576
    s_waitcnt lgkmcnt(4)
    ds_read_b64_tr_b16 v[100:101], v14 offset:21568
    v_accvgpr_read_b32 v244, a8
    v_mfma_f32_16x16x32_bf16 v[168:171], v[104:107], v[60:63], v[168:171]
    s_and_b32 s48, s48, 0x3fffff
    s_and_b32 m0, s58, 0x1ffff
    ds_read_b64_tr_b16 v[102:103], v14 offset:25152
    v_accvgpr_read_b32 v245, a9
    v_mfma_f32_16x16x32_bf16 v[172:175], v[104:107], v[64:67], v[172:175]
    v_accvgpr_read_b32 v246, a10
    v_accvgpr_read_b32 v247, a11
    v_mfma_f32_16x16x32_bf16 v[176:179], v[104:107], v[68:71], v[176:179]
    v_accvgpr_read_b32 v248, a12
    v_accvgpr_read_b32 v249, a13
    v_mfma_f32_16x16x32_bf16 v[180:183], v[104:107], v[72:75], v[180:183]
    ds_read_b64_tr_b16 v[104:105], v14 offset:21600
    v_accvgpr_read_b32 v250, a14
    v_mfma_f32_16x16x32_bf16 v[184:187], v[108:111], v[60:63], v[184:187]
    ds_read_b64_tr_b16 v[106:107], v14 offset:25184
    v_accvgpr_read_b32 v251, a15
    v_mfma_f32_16x16x32_bf16 v[188:191], v[108:111], v[64:67], v[188:191]
    buffer_load_dwordx4 v3, s[12:15], s59 offen sc1 lds
    v_add_f32 v245, v245, v247
    v_mfma_f32_16x16x32_bf16 v[192:195], v[108:111], v[68:71], v[192:195]
    buffer_load_dwordx4 v3, s[12:15], s59 offen offset:1024 sc1 lds
    v_add_f32 v249, v249, v251
    v_mfma_f32_16x16x32_bf16 v[196:199], v[108:111], v[72:75], v[196:199]
    s_add_u32 s58, s58, 8192
    s_add_u32 s59, s59, 24576
    ds_read_b64_tr_b16 v[108:109], v14 offset:21632
    v_add_f32 v237, v245, v249
    v_mfma_f32_16x16x32_bf16 v[200:203], v[112:115], v[60:63], v[200:203]
    s_and_b32 m0, s58, 0x1ffff
    ds_read_b64_tr_b16 v[110:111], v14 offset:25216
    v_fma_f32 v240, v244, s62, -v233
    v_mfma_f32_16x16x32_bf16 v[204:207], v[112:115], v[64:67], v[204:207]
    v_mul_f32 v240, v240, v240
    v_fma_f32 v237, v240, s63, v237
    v_mfma_f32_16x16x32_bf16 v[208:211], v[112:115], v[68:71], v[208:211]
    v_fma_f32 v240, v246, s62, -v233
    v_mul_f32 v240, v240, v240
    v_mfma_f32_16x16x32_bf16 v[212:215], v[112:115], v[72:75], v[212:215]
    ds_read_b64_tr_b16 v[112:113], v14 offset:21664
    v_fma_f32 v237, v240, s63, v237
    v_mfma_f32_16x16x32_bf16 v[216:219], v[116:119], v[60:63], v[216:219]
    ds_read_b64_tr_b16 v[114:115], v14 offset:25248
    v_fma_f32 v240, v248, s62, -v233
    v_mfma_f32_16x16x32_bf16 v[220:223], v[116:119], v[64:67], v[220:223]
    v_mul_f32 v240, v240, v240
    v_fma_f32 v237, v240, s63, v237
    v_mfma_f32_16x16x32_bf16 v[224:227], v[116:119], v[68:71], v[224:227]
    v_fma_f32 v240, v250, s62, -v233
    v_mul_f32 v240, v240, v240
    v_mfma_f32_16x16x32_bf16 v[228:231], v[116:119], v[72:75], v[228:231]
    s_waitcnt vmcnt(20) lgkmcnt(4)
    ds_read_b64_tr_b16 v[116:117], v14 offset:21696
    v_fma_f32 v237, v240, s63, v237
    v_mfma_f32_16x16x32_bf16 v[120:123], v[92:95], v[76:79], v[120:123]
    ds_read_b64_tr_b16 v[118:119], v14 offset:25280
    v_mul_f32 v234, 0x3a800000, v234
    v_mfma_f32_16x16x32_bf16 v[124:127], v[92:95], v[80:83], v[124:127]
    s_mov_b32 s57, s50
    buffer_load_dwordx4 v[60:63], v12, s[28:31], s48 offen offset:0 sc1
    v_accvgpr_read_b32 v244, a16
    v_mfma_f32_16x16x32_bf16 v[128:131], v[92:95], v[84:87], v[128:131]
    v_add_u32 v14, s51, v13
    buffer_load_dwordx4 v[64:67], v12, s[28:31], s48 offen offset:1024 sc1
    s_waitcnt lgkmcnt(0)
    s_barrier
    v_mfma_f32_16x16x32_bf16 v[132:135], v[92:95], v[88:91], v[132:135]
    ds_read_b64_tr_b16 v[92:93], v14 offset:0
    v_accvgpr_read_b32 v245, a17
    v_mfma_f32_16x16x32_bf16 v[136:139], v[96:99], v[76:79], v[136:139]
    s_mov_b32 s50, s51
    ds_read_b64_tr_b16 v[94:95], v14 offset:3584
    v_accvgpr_read_b32 v246, a18
    v_mfma_f32_16x16x32_bf16 v[140:143], v[96:99], v[80:83], v[140:143]
    s_mov_b32 s51, s52
    buffer_load_dwordx4 v[68:71], v12, s[28:31], s48 offen offset:2048 sc1
    v_accvgpr_read_b32 v247, a19
    v_mfma_f32_16x16x32_bf16 v[144:147], v[96:99], v[84:87], v[144:147]
    s_mov_b32 s52, s57
    buffer_load_dwordx4 v[72:75], v12, s[28:31], s48 offen offset:3072 sc1
    v_accvgpr_read_b32 v248, a20
    v_mfma_f32_16x16x32_bf16 v[148:151], v[96:99], v[88:91], v[148:151]
    ds_read_b64_tr_b16 v[96:97], v14 offset:32
    v_accvgpr_read_b32 v249, a21
    v_mfma_f32_16x16x32_bf16 v[152:155], v[100:103], v[76:79], v[152:155]
    s_add_u32 s48, s48, 0x20000
    ds_read_b64_tr_b16 v[98:99], v14 offset:3616
    v_accvgpr_read_b32 v250, a22
    v_mfma_f32_16x16x32_bf16 v[156:159], v[100:103], v[80:83], v[156:159]
    buffer_load_dwordx4 v3, s[12:15], s59 offen sc1 lds
    v_accvgpr_read_b32 v251, a23
    v_mfma_f32_16x16x32_bf16 v[160:163], v[100:103], v[84:87], v[160:163]
    buffer_load_dwordx4 v3, s[12:15], s59 offen offset:1024 sc1 lds
    v_add_f32 v245, v245, v247
    v_mfma_f32_16x16x32_bf16 v[164:167], v[100:103], v[88:91], v[164:167]
    s_add_u32 s58, s58, 8192
    s_add_u32 s59, s59, 24576
    s_waitcnt lgkmcnt(4)
    ds_read_b64_tr_b16 v[100:101], v14 offset:64
    v_add_f32 v249, v249, v251
    v_mfma_f32_16x16x32_bf16 v[168:171], v[104:107], v[76:79], v[168:171]
    s_and_b32 s48, s48, 0x3fffff
    s_and_b32 m0, s58, 0x1ffff
    ds_read_b64_tr_b16 v[102:103], v14 offset:3648
    v_add_f32 v238, v245, v249
    v_mfma_f32_16x16x32_bf16 v[172:175], v[104:107], v[80:83], v[172:175]
    v_fma_f32 v240, v244, s62, -v234
    v_mul_f32 v240, v240, v240
    v_mfma_f32_16x16x32_bf16 v[176:179], v[104:107], v[84:87], v[176:179]
    v_fma_f32 v238, v240, s63, v238
    v_fma_f32 v240, v246, s62, -v234
    v_mfma_f32_16x16x32_bf16 v[180:183], v[104:107], v[88:91], v[180:183]
    ds_read_b64_tr_b16 v[104:105], v14 offset:96
    v_mul_f32 v240, v240, v240
    v_mfma_f32_16x16x32_bf16 v[184:187], v[108:111], v[76:79], v[184:187]
    ds_read_b64_tr_b16 v[106:107], v14 offset:3680
    v_fma_f32 v238, v240, s63, v238
    v_mfma_f32_16x16x32_bf16 v[188:191], v[108:111], v[80:83], v[188:191]
    buffer_load_dwordx4 v3, s[12:15], s59 offen sc1 lds
    v_fma_f32 v240, v248, s62, -v234
    v_mfma_f32_16x16x32_bf16 v[192:195], v[108:111], v[84:87], v[192:195]
    buffer_load_dwordx4 v3, s[12:15], s59 offen offset:1024 sc1 lds
    v_mul_f32 v240, v240, v240
    v_mfma_f32_16x16x32_bf16 v[196:199], v[108:111], v[88:91], v[196:199]
    s_add_u32 s58, s58, 8192
    s_add_u32 s59, s59, 24576
    ds_read_b64_tr_b16 v[108:109], v14 offset:128
    v_fma_f32 v238, v240, s63, v238
    v_mfma_f32_16x16x32_bf16 v[200:203], v[112:115], v[76:79], v[200:203]
    s_and_b32 m0, s58, 0x1ffff
    ds_read_b64_tr_b16 v[110:111], v14 offset:3712
    v_fma_f32 v240, v250, s62, -v234
    v_mfma_f32_16x16x32_bf16 v[204:207], v[112:115], v[80:83], v[204:207]
    v_mul_f32 v240, v240, v240
    v_fma_f32 v238, v240, s63, v238
    v_mfma_f32_16x16x32_bf16 v[208:211], v[112:115], v[84:87], v[208:211]
    v_mul_f32 v235, 0x3a800000, v235
    v_accvgpr_read_b32 v244, a24
    v_mfma_f32_16x16x32_bf16 v[212:215], v[112:115], v[88:91], v[212:215]
    ds_read_b64_tr_b16 v[112:113], v14 offset:160
    v_accvgpr_read_b32 v245, a25
    v_mfma_f32_16x16x32_bf16 v[216:219], v[116:119], v[76:79], v[216:219]
    ds_read_b64_tr_b16 v[114:115], v14 offset:3744
    v_accvgpr_read_b32 v246, a26
    v_mfma_f32_16x16x32_bf16 v[220:223], v[116:119], v[80:83], v[220:223]
    v_accvgpr_read_b32 v247, a27
    v_accvgpr_read_b32 v248, a28
    v_mfma_f32_16x16x32_bf16 v[224:227], v[116:119], v[84:87], v[224:227]
    v_accvgpr_read_b32 v249, a29
    v_accvgpr_read_b32 v250, a30
    v_mfma_f32_16x16x32_bf16 v[228:231], v[116:119], v[88:91], v[228:231]
    s_waitcnt vmcnt(20) lgkmcnt(4)
    ds_read_b64_tr_b16 v[116:117], v14 offset:192
    v_accvgpr_read_b32 v251, a31
    v_mfma_f32_16x16x32_bf16 v[120:123], v[92:95], v[28:31], v[120:123]
    ds_read_b64_tr_b16 v[118:119], v14 offset:3776
    v_add_f32 v245, v245, v247
    v_mfma_f32_16x16x32_bf16 v[124:127], v[92:95], v[32:35], v[124:127]
    buffer_load_dwordx4 v[76:79], v12, s[28:31], s48 offen offset:0 sc1
    v_add_f32 v249, v249, v251
    v_mfma_f32_16x16x32_bf16 v[128:131], v[92:95], v[36:39], v[128:131]
    buffer_load_dwordx4 v[80:83], v12, s[28:31], s48 offen offset:1024 sc1
    v_add_f32 v239, v245, v249
    v_mfma_f32_16x16x32_bf16 v[132:135], v[92:95], v[40:43], v[132:135]
    ds_read_b64_tr_b16 v[92:93], v14 offset:7168
    v_fma_f32 v240, v244, s62, -v235
    v_mfma_f32_16x16x32_bf16 v[136:139], v[96:99], v[28:31], v[136:139]
    ds_read_b64_tr_b16 v[94:95], v14 offset:10752
    v_mul_f32 v240, v240, v240
    v_mfma_f32_16x16x32_bf16 v[140:143], v[96:99], v[32:35], v[140:143]
    buffer_load_dwordx4 v[84:87], v12, s[28:31], s48 offen offset:2048 sc1
    v_fma_f32 v239, v240, s63, v239
    v_mfma_f32_16x16x32_bf16 v[144:147], v[96:99], v[36:39], v[144:147]
    buffer_load_dwordx4 v[88:91], v12, s[28:31], s48 offen offset:3072 sc1
    v_fma_f32 v240, v246, s62, -v235
    v_mfma_f32_16x16x32_bf16 v[148:151], v[96:99], v[40:43], v[148:151]
    ds_read_b64_tr_b16 v[96:97], v14 offset:7200
    v_mul_f32 v240, v240, v240
    v_mfma_f32_16x16x32_bf16 v[152:155], v[100:103], v[28:31], v[152:155]
    s_add_u32 s48, s48, 0x20000
    ds_read_b64_tr_b16 v[98:99], v14 offset:10784
    v_fma_f32 v239, v240, s63, v239
    v_mfma_f32_16x16x32_bf16 v[156:159], v[100:103], v[32:35], v[156:159]
    buffer_load_dwordx4 v3, s[12:15], s59 offen sc1 lds
    v_fma_f32 v240, v248, s62, -v235
    v_mfma_f32_16x16x32_bf16 v[160:163], v[100:103], v[36:39], v[160:163]
    buffer_load_dwordx4 v3, s[12:15], s59 offen offset:1024 sc1 lds
    v_mul_f32 v240, v240, v240
    v_mfma_f32_16x16x32_bf16 v[164:167], v[100:103], v[40:43], v[164:167]
    s_add_u32 s58, s58, 8192
    s_add_u32 s59, s59, 24576
    s_waitcnt lgkmcnt(4)
    ds_read_b64_tr_b16 v[100:101], v14 offset:7232
    v_fma_f32 v239, v240, s63, v239
    v_mfma_f32_16x16x32_bf16 v[168:171], v[104:107], v[28:31], v[168:171]
    s_and_b32 s48, s48, 0x3fffff
    s_and_b32 m0, s58, 0x1ffff
    ds_read_b64_tr_b16 v[102:103], v14 offset:10816
    v_fma_f32 v240, v250, s62, -v235
    v_mfma_f32_16x16x32_bf16 v[172:175], v[104:107], v[32:35], v[172:175]
    v_mul_f32 v240, v240, v240
    v_fma_f32 v239, v240, s63, v239
    v_mfma_f32_16x16x32_bf16 v[176:179], v[104:107], v[36:39], v[176:179]
    v_mov_b32 v240, v236
    v_mov_b32 v241, v237
    v_mfma_f32_16x16x32_bf16 v[180:183], v[104:107], v[40:43], v[180:183]
    ds_read_b64_tr_b16 v[104:105], v14 offset:7264
    v_mov_b32 v242, v238
    v_mfma_f32_16x16x32_bf16 v[184:187], v[108:111], v[28:31], v[184:187]
    ds_read_b64_tr_b16 v[106:107], v14 offset:10848
    v_mov_b32 v243, v239
    v_mfma_f32_16x16x32_bf16 v[188:191], v[108:111], v[32:35], v[188:191]
    s_nop 1
    v_permlane16_swap_b32 v236, v240
    v_mfma_f32_16x16x32_bf16 v[192:195], v[108:111], v[36:39], v[192:195]
    v_permlane16_swap_b32 v237, v241
    v_permlane16_swap_b32 v238, v242
    v_mfma_f32_16x16x32_bf16 v[196:199], v[108:111], v[40:43], v[196:199]
    ds_read_b64_tr_b16 v[108:109], v14 offset:7296
    v_permlane16_swap_b32 v239, v243
    v_mfma_f32_16x16x32_bf16 v[200:203], v[112:115], v[28:31], v[200:203]
    ds_read_b64_tr_b16 v[110:111], v14 offset:10880
    v_add_f32 v236, v236, v240
    v_mfma_f32_16x16x32_bf16 v[204:207], v[112:115], v[32:35], v[204:207]
    v_add_f32 v237, v237, v241
    v_add_f32 v238, v238, v242
    v_mfma_f32_16x16x32_bf16 v[208:211], v[112:115], v[36:39], v[208:211]
    v_add_f32 v239, v239, v243
    v_mov_b32 v240, v236
    v_mfma_f32_16x16x32_bf16 v[212:215], v[112:115], v[40:43], v[212:215]
    ds_read_b64_tr_b16 v[112:113], v14 offset:7328
    v_mov_b32 v241, v237
    v_mfma_f32_16x16x32_bf16 v[216:219], v[116:119], v[28:31], v[216:219]
    ds_read_b64_tr_b16 v[114:115], v14 offset:10912
    v_mov_b32 v242, v238
    v_mfma_f32_16x16x32_bf16 v[220:223], v[116:119], v[32:35], v[220:223]
    v_mov_b32 v243, v239
    s_nop 1
    v_mfma_f32_16x16x32_bf16 v[224:227], v[116:119], v[36:39], v[224:227]
    v_permlane32_swap_b32 v236, v240
    v_permlane32_swap_b32 v237, v241
    v_mfma_f32_16x16x32_bf16 v[228:231], v[116:119], v[40:43], v[228:231]
    s_waitcnt vmcnt(18) lgkmcnt(4)
    ds_read_b64_tr_b16 v[116:117], v14 offset:7360
    v_permlane32_swap_b32 v238, v242
    v_mfma_f32_16x16x32_bf16 v[120:123], v[92:95], v[44:47], v[120:123]
    ds_read_b64_tr_b16 v[118:119], v14 offset:10944
    v_permlane32_swap_b32 v239, v243
    v_mfma_f32_16x16x32_bf16 v[124:127], v[92:95], v[48:51], v[124:127]
    v_add_f32 v236, v236, v240
    v_add_f32 v237, v237, v241
    v_mfma_f32_16x16x32_bf16 v[128:131], v[92:95], v[52:55], v[128:131]
    v_add_f32 v238, v238, v242
    v_add_f32 v239, v239, v243
    v_mfma_f32_16x16x32_bf16 v[132:135], v[92:95], v[56:59], v[132:135]
    ds_read_b64_tr_b16 v[92:93], v14 offset:14336
    v_mul_f32 v236, 0x3a800000, v236
    v_mfma_f32_16x16x32_bf16 v[136:139], v[96:99], v[44:47], v[136:139]
    ds_read_b64_tr_b16 v[94:95], v14 offset:17920
    v_cvt_pk_bf16_f32 v232, v232, v232
    v_mfma_f32_16x16x32_bf16 v[140:143], v[96:99], v[48:51], v[140:143]
    v_and_b32 v232, 0xffff0000, v232
    v_cvt_pk_bf16_f32 v236, v236, v236
    v_mfma_f32_16x16x32_bf16 v[144:147], v[96:99], v[52:55], v[144:147]
    v_and_b32 v236, 0xffff0000, v236
    v_add_f32 v236, 0x3727c5ac, v236
    v_mfma_f32_16x16x32_bf16 v[148:151], v[96:99], v[56:59], v[148:151]
    ds_read_b64_tr_b16 v[96:97], v14 offset:14368
    v_cvt_pk_bf16_f32 v236, v236, v236
    v_mfma_f32_16x16x32_bf16 v[152:155], v[100:103], v[44:47], v[152:155]
    ds_read_b64_tr_b16 v[98:99], v14 offset:17952
    v_and_b32 v236, 0xffff0000, v236
    v_mfma_f32_16x16x32_bf16 v[156:159], v[100:103], v[48:51], v[156:159]
    buffer_load_dwordx4 v3, s[12:15], s59 offen sc1 lds
    v_mul_f32 v237, 0x3a800000, v237
    v_mfma_f32_16x16x32_bf16 v[160:163], v[100:103], v[52:55], v[160:163]
    buffer_load_dwordx4 v3, s[12:15], s59 offen offset:1024 sc1 lds
    v_cvt_pk_bf16_f32 v233, v233, v233
    v_mfma_f32_16x16x32_bf16 v[164:167], v[100:103], v[56:59], v[164:167]
    s_add_u32 s58, s58, 8192
    s_add_u32 s59, s59, 24576
    s_waitcnt lgkmcnt(4)
    ds_read_b64_tr_b16 v[100:101], v14 offset:14400
    v_and_b32 v233, 0xffff0000, v233
    v_mfma_f32_16x16x32_bf16 v[168:171], v[104:107], v[44:47], v[168:171]
    s_and_b32 m0, s58, 0x1ffff
    ds_read_b64_tr_b16 v[102:103], v14 offset:17984
    v_cvt_pk_bf16_f32 v237, v237, v237
    v_mfma_f32_16x16x32_bf16 v[172:175], v[104:107], v[48:51], v[172:175]
    v_and_b32 v237, 0xffff0000, v237
    v_add_f32 v237, 0x3727c5ac, v237
    v_mfma_f32_16x16x32_bf16 v[176:179], v[104:107], v[52:55], v[176:179]
    v_cvt_pk_bf16_f32 v237, v237, v237
    v_and_b32 v237, 0xffff0000, v237
    v_mfma_f32_16x16x32_bf16 v[180:183], v[104:107], v[56:59], v[180:183]
    ds_read_b64_tr_b16 v[104:105], v14 offset:14432
    v_mul_f32 v238, 0x3a800000, v238
    v_mfma_f32_16x16x32_bf16 v[184:187], v[108:111], v[44:47], v[184:187]
    ds_read_b64_tr_b16 v[106:107], v14 offset:18016
    v_cvt_pk_bf16_f32 v234, v234, v234
    v_mfma_f32_16x16x32_bf16 v[188:191], v[108:111], v[48:51], v[188:191]
    v_and_b32 v234, 0xffff0000, v234
    v_cvt_pk_bf16_f32 v238, v238, v238
    v_mfma_f32_16x16x32_bf16 v[192:195], v[108:111], v[52:55], v[192:195]
    v_and_b32 v238, 0xffff0000, v238
    v_add_f32 v238, 0x3727c5ac, v238
    v_mfma_f32_16x16x32_bf16 v[196:199], v[108:111], v[56:59], v[196:199]
    ds_read_b64_tr_b16 v[108:109], v14 offset:14464
    v_cvt_pk_bf16_f32 v238, v238, v238
    v_mfma_f32_16x16x32_bf16 v[200:203], v[112:115], v[44:47], v[200:203]
    ds_read_b64_tr_b16 v[110:111], v14 offset:18048
    v_and_b32 v238, 0xffff0000, v238
    v_mfma_f32_16x16x32_bf16 v[204:207], v[112:115], v[48:51], v[204:207]
    v_mul_f32 v239, 0x3a800000, v239
    v_cvt_pk_bf16_f32 v235, v235, v235
    v_mfma_f32_16x16x32_bf16 v[208:211], v[112:115], v[52:55], v[208:211]
    v_and_b32 v235, 0xffff0000, v235
    v_cvt_pk_bf16_f32 v239, v239, v239
    v_mfma_f32_16x16x32_bf16 v[212:215], v[112:115], v[56:59], v[212:215]
    ds_read_b64_tr_b16 v[112:113], v14 offset:14496
    v_and_b32 v239, 0xffff0000, v239
    v_mfma_f32_16x16x32_bf16 v[216:219], v[116:119], v[44:47], v[216:219]
    ds_read_b64_tr_b16 v[114:115], v14 offset:18080
    v_add_f32 v239, 0x3727c5ac, v239
    v_mfma_f32_16x16x32_bf16 v[220:223], v[116:119], v[48:51], v[220:223]
    v_cvt_pk_bf16_f32 v239, v239, v239
    v_and_b32 v239, 0xffff0000, v239
    v_mfma_f32_16x16x32_bf16 v[224:227], v[116:119], v[52:55], v[224:227]
    v_sqrt_f32 v236, v236
    v_mfma_f32_16x16x32_bf16 v[228:231], v[116:119], v[56:59], v[228:231]
    s_waitcnt vmcnt(12) lgkmcnt(4)
    ds_read_b64_tr_b16 v[116:117], v14 offset:14528
    v_sqrt_f32 v237, v237
    v_mfma_f32_16x16x32_bf16 v[120:123], v[92:95], v[60:63], v[120:123]
    ds_read_b64_tr_b16 v[118:119], v14 offset:18112
    v_sqrt_f32 v238, v238
    v_mfma_f32_16x16x32_bf16 v[124:127], v[92:95], v[64:67], v[124:127]
    v_sqrt_f32 v239, v239
    v_mfma_f32_16x16x32_bf16 v[128:131], v[92:95], v[68:71], v[128:131]
    s_nop 0
    v_cvt_pk_bf16_f32 v236, v236, v236
    v_mfma_f32_16x16x32_bf16 v[132:135], v[92:95], v[72:75], v[132:135]
    ds_read_b64_tr_b16 v[92:93], v14 offset:21504
    v_and_b32 v236, 0xffff0000, v236
    v_mfma_f32_16x16x32_bf16 v[136:139], v[96:99], v[60:63], v[136:139]
    ds_read_b64_tr_b16 v[94:95], v14 offset:25088
    v_cvt_pk_bf16_f32 v237, v237, v237
    v_mfma_f32_16x16x32_bf16 v[140:143], v[96:99], v[64:67], v[140:143]
    v_and_b32 v237, 0xffff0000, v237
    v_cvt_pk_bf16_f32 v238, v238, v238
    v_mfma_f32_16x16x32_bf16 v[144:147], v[96:99], v[68:71], v[144:147]
    v_and_b32 v238, 0xffff0000, v238
    v_cvt_pk_bf16_f32 v239, v239, v239
    v_mfma_f32_16x16x32_bf16 v[148:151], v[96:99], v[72:75], v[148:151]
    ds_read_b64_tr_b16 v[96:97], v14 offset:21536
    v_and_b32 v239, 0xffff0000, v239
    v_mfma_f32_16x16x32_bf16 v[152:155], v[100:103], v[60:63], v[152:155]
    ds_read_b64_tr_b16 v[98:99], v14 offset:25120
    v_rcp_f32 v236, v236
    v_mfma_f32_16x16x32_bf16 v[156:159], v[100:103], v[64:67], v[156:159]
    buffer_load_dwordx4 v3, s[12:15], s59 offen sc1 lds
    v_rcp_f32 v237, v237
    v_mfma_f32_16x16x32_bf16 v[160:163], v[100:103], v[68:71], v[160:163]
    buffer_load_dwordx4 v3, s[12:15], s59 offen offset:1024 sc1 lds
    v_rcp_f32 v238, v238
    v_mfma_f32_16x16x32_bf16 v[164:167], v[100:103], v[72:75], v[164:167]
    s_add_u32 s58, s58, 8192
    s_add_u32 s59, s59, 24576
    s_waitcnt lgkmcnt(4)
    ds_read_b64_tr_b16 v[100:101], v14 offset:21568
    v_rcp_f32 v239, v239
    v_mfma_f32_16x16x32_bf16 v[168:171], v[104:107], v[60:63], v[168:171]
    s_and_b32 m0, s58, 0x1ffff
    ds_read_b64_tr_b16 v[102:103], v14 offset:25152
    s_nop 0
    v_mfma_f32_16x16x32_bf16 v[172:175], v[104:107], v[64:67], v[172:175]
    v_mul_f32 v24, -v232, v236
    v_mul_f32 v20, 0xbfb8aa3b, v236
    v_mfma_f32_16x16x32_bf16 v[176:179], v[104:107], v[68:71], v[176:179]
    v_mul_f32 v25, -v233, v237
    v_mul_f32 v21, 0xbfb8aa3b, v237
    v_mfma_f32_16x16x32_bf16 v[180:183], v[104:107], v[72:75], v[180:183]
    ds_read_b64_tr_b16 v[104:105], v14 offset:21600
    v_mul_f32 v26, -v234, v238
    v_mfma_f32_16x16x32_bf16 v[184:187], v[108:111], v[60:63], v[184:187]
    ds_read_b64_tr_b16 v[106:107], v14 offset:25184
    v_mul_f32 v22, 0xbfb8aa3b, v238
    v_mfma_f32_16x16x32_bf16 v[188:191], v[108:111], v[64:67], v[188:191]
    v_mul_f32 v27, -v235, v239
    v_mul_f32 v23, 0xbfb8aa3b, v239
    v_mfma_f32_16x16x32_bf16 v[192:195], v[108:111], v[68:71], v[192:195]
    v_accvgpr_read_b32 v244, a32
    v_accvgpr_read_b32 v245, a33
    v_mfma_f32_16x16x32_bf16 v[196:199], v[108:111], v[72:75], v[196:199]
    ds_read_b64_tr_b16 v[108:109], v14 offset:21632
    v_accvgpr_read_b32 v246, a34
    v_mfma_f32_16x16x32_bf16 v[200:203], v[112:115], v[60:63], v[200:203]
    ds_read_b64_tr_b16 v[110:111], v14 offset:25216
    v_accvgpr_read_b32 v247, a35
    v_mfma_f32_16x16x32_bf16 v[204:207], v[112:115], v[64:67], v[204:207]
    v_accvgpr_read_b32 v248, a36
    v_accvgpr_read_b32 v249, a37
    v_mfma_f32_16x16x32_bf16 v[208:211], v[112:115], v[68:71], v[208:211]
    v_accvgpr_read_b32 v250, a38
    v_accvgpr_read_b32 v251, a39
    v_mfma_f32_16x16x32_bf16 v[212:215], v[112:115], v[72:75], v[212:215]
    ds_read_b64_tr_b16 v[112:113], v14 offset:21664
    v_add_f32 v244, v244, v245
    v_mfma_f32_16x16x32_bf16 v[216:219], v[116:119], v[60:63], v[216:219]
    ds_read_b64_tr_b16 v[114:115], v14 offset:25248
    v_add_f32 v244, v244, v246
    v_mfma_f32_16x16x32_bf16 v[220:223], v[116:119], v[64:67], v[220:223]
    v_add_f32 v244, v244, v247
    v_add_f32 v244, v244, v248
    v_mfma_f32_16x16x32_bf16 v[224:227], v[116:119], v[68:71], v[224:227]
    v_add_f32 v244, v244, v249
    v_add_f32 v244, v244, v250
    v_mfma_f32_16x16x32_bf16 v[228:231], v[116:119], v[72:75], v[228:231]
    s_waitcnt vmcnt(6) lgkmcnt(4)
    ds_read_b64_tr_b16 v[116:117], v14 offset:21696
    v_add_f32 v244, v244, v251
    v_mfma_f32_16x16x32_bf16 v[120:123], v[92:95], v[76:79], v[120:123]
    ds_read_b64_tr_b16 v[118:119], v14 offset:25280
    v_mul_f32 v252, 0xbfb8aa3b, v244
    v_mfma_f32_16x16x32_bf16 v[124:127], v[92:95], v[80:83], v[124:127]
    ds_write_b32 v8, v252
    v_mfma_f32_16x16x32_bf16 v[128:131], v[92:95], v[84:87], v[128:131]
    v_mfma_f32_16x16x32_bf16 v[132:135], v[92:95], v[88:91], v[132:135]
    v_mfma_f32_16x16x32_bf16 v[136:139], v[96:99], v[76:79], v[136:139]
    v_mfma_f32_16x16x32_bf16 v[140:143], v[96:99], v[80:83], v[140:143]
    v_mfma_f32_16x16x32_bf16 v[144:147], v[96:99], v[84:87], v[144:147]
    v_mfma_f32_16x16x32_bf16 v[148:151], v[96:99], v[88:91], v[148:151]
    v_mfma_f32_16x16x32_bf16 v[152:155], v[100:103], v[76:79], v[152:155]
    v_mfma_f32_16x16x32_bf16 v[156:159], v[100:103], v[80:83], v[156:159]
    v_mfma_f32_16x16x32_bf16 v[160:163], v[100:103], v[84:87], v[160:163]
    v_mfma_f32_16x16x32_bf16 v[164:167], v[100:103], v[88:91], v[164:167]
    s_waitcnt lgkmcnt(0)
    v_mfma_f32_16x16x32_bf16 v[168:171], v[104:107], v[76:79], v[168:171]
    v_mfma_f32_16x16x32_bf16 v[172:175], v[104:107], v[80:83], v[172:175]
    v_mfma_f32_16x16x32_bf16 v[176:179], v[104:107], v[84:87], v[176:179]
    v_mfma_f32_16x16x32_bf16 v[180:183], v[104:107], v[88:91], v[180:183]
    v_mfma_f32_16x16x32_bf16 v[184:187], v[108:111], v[76:79], v[184:187]
    v_mfma_f32_16x16x32_bf16 v[188:191], v[108:111], v[80:83], v[188:191]
    v_mfma_f32_16x16x32_bf16 v[192:195], v[108:111], v[84:87], v[192:195]
    v_mfma_f32_16x16x32_bf16 v[196:199], v[108:111], v[88:91], v[196:199]
    v_mfma_f32_16x16x32_bf16 v[200:203], v[112:115], v[76:79], v[200:203]
    v_mfma_f32_16x16x32_bf16 v[204:207], v[112:115], v[80:83], v[204:207]
    v_mfma_f32_16x16x32_bf16 v[208:211], v[112:115], v[84:87], v[208:211]
    v_mfma_f32_16x16x32_bf16 v[212:215], v[112:115], v[88:91], v[212:215]
    v_mfma_f32_16x16x32_bf16 v[216:219], v[116:119], v[76:79], v[216:219]
    v_mfma_f32_16x16x32_bf16 v[220:223], v[116:119], v[80:83], v[220:223]
    v_mfma_f32_16x16x32_bf16 v[224:227], v[116:119], v[84:87], v[224:227]
    v_mfma_f32_16x16x32_bf16 v[228:231], v[116:119], v[88:91], v[228:231]
    s_waitcnt lgkmcnt(0)
    s_barrier
    s_load_dwordx2 s[6:7], s[0:1], 80
    ds_read_b128 v[28:31], v9 offset:0
    ds_read_b128 v[56:59], v9 offset:448
    ds_read_b128 v[32:35], v9 offset:64
    ds_read_b128 v[60:63], v9 offset:512
    ds_read_b128 v[36:39], v9 offset:128
    ds_read_b128 v[64:67], v9 offset:576
    ds_read_b128 v[40:43], v9 offset:192
    ds_read_b128 v[68:71], v9 offset:640
    ds_read_b128 v[44:47], v9 offset:256
    ds_read_b128 v[72:75], v9 offset:704
    ds_read_b128 v[48:51], v9 offset:320
    ds_read_b128 v[76:79], v9 offset:768
    ds_read_b128 v[52:55], v9 offset:384
    ds_read_b128 v[80:83], v9 offset:832
    s_lshr_b32 s43, s39, 4
    s_mul_i32 s43, s43, 56
    s_and_b32 s49, s39, 15
    s_mul_i32 s42, s49, 3
    s_add_u32 s42, s42, s43
    s_lshl_b32 s42, s42, 17
    s_add_u32 s42, s42, 0x100000
    s_lshr_b32 s49, s49, 1
    s_add_u32 s49, s49, s43
    s_lshl_b32 s49, s49, 17
    s_and_b32 s43, s39, 1
    s_lshl_b32 s43, s43, 10
    s_add_u32 s49, s49, s43
    s_add_u32 s49, s49, 0x700000
    s_mov_b32 s50, 0xbfb8aa3b
    s_mov_b32 s51, s50
    s_waitcnt lgkmcnt(0)
    s_lshl_b32 s56, s46, 5
    s_add_u32 s56, s56, s39
    s_lshl_b32 s56, s56, 7
    s_add_u32 s56, s56, 25427968
    s_and_b32 s52, s2, 1
    s_lshr_b32 s53, s47, 1
    s_lshl_b32 s53, s53, 1
    s_add_u32 s53, s53, s52
    s_lshl_b32 s53, s53, 11
    s_add_u32 s53, s53, 25427968
    v_and_b32 v10, 15, v1
    v_lshlrev_b32 v10, 7, v10
    v_pk_fma_f32 v[92:93], v[28:29], v[24:25], v[56:57] op_sel:[0,0,0] op_sel_hi:[1,0,1]
    v_pk_fma_f32 v[94:95], v[30:31], v[24:25], v[58:59] op_sel:[0,0,0] op_sel_hi:[1,0,1]
    v_pk_fma_f32 v[96:97], v[32:33], v[24:25], v[60:61] op_sel:[0,0,0] op_sel_hi:[1,0,1]
    v_pk_fma_f32 v[98:99], v[34:35], v[24:25], v[62:63] op_sel:[0,0,0] op_sel_hi:[1,0,1]
    v_pk_fma_f32 v[120:121], v[120:121], v[20:21], v[92:93] op_sel:[0,0,0] op_sel_hi:[1,0,1]
    v_pk_fma_f32 v[122:123], v[122:123], v[20:21], v[94:95] op_sel:[0,0,0] op_sel_hi:[1,0,1]
    v_pk_fma_f32 v[136:137], v[136:137], v[20:21], v[96:97] op_sel:[0,0,0] op_sel_hi:[1,0,1]
    v_pk_fma_f32 v[138:139], v[138:139], v[20:21], v[98:99] op_sel:[0,0,0] op_sel_hi:[1,0,1]
    v_exp_f32 v92, v120
    v_exp_f32 v93, v121
    v_exp_f32 v94, v122
    v_exp_f32 v95, v123
    v_exp_f32 v96, v136
    v_exp_f32 v97, v137
    v_exp_f32 v98, v138
    v_exp_f32 v99, v139
    v_pk_fma_f32 v[92:93], v[92:93], s[50:51], s[50:51]
    v_pk_fma_f32 v[94:95], v[94:95], s[50:51], s[50:51]
    v_pk_fma_f32 v[96:97], v[96:97], s[50:51], s[50:51]
    v_pk_fma_f32 v[98:99], v[98:99], s[50:51], s[50:51]
    v_rcp_f32 v92, v92
    v_rcp_f32 v93, v93
    v_rcp_f32 v94, v94
    v_rcp_f32 v95, v95
    v_rcp_f32 v96, v96
    v_rcp_f32 v97, v97
    v_rcp_f32 v98, v98
    v_rcp_f32 v99, v99
    v_pk_mul_f32 v[120:121], v[120:121], v[92:93]
    v_pk_mul_f32 v[122:123], v[122:123], v[94:95]
    v_pk_mul_f32 v[136:137], v[136:137], v[96:97]
    v_pk_mul_f32 v[138:139], v[138:139], v[98:99]
    v_cvt_pk_bf16_f32 v104, v120, v121
    v_cvt_pk_bf16_f32 v105, v122, v123
    v_cvt_pk_bf16_f32 v106, v136, v137
    v_cvt_pk_bf16_f32 v107, v138, v139
    buffer_store_dwordx4 v[104:107], v12, s[24:27], s42 offen offset:0 sc1
    buffer_load_dwordx4 v3, s[12:15], s59 offen sc1 lds
    buffer_load_dwordx4 v3, s[12:15], s59 offen offset:1024 sc1 lds
    s_add_u32 s58, s58, 8192
    s_and_b32 m0, s58, 0x1ffff
    s_add_u32 s59, s59, 24576
    v_pk_fma_f32 v[92:93], v[28:29], v[24:25], v[56:57] op_sel:[0,1,0] op_sel_hi:[1,1,1]
    v_pk_fma_f32 v[94:95], v[30:31], v[24:25], v[58:59] op_sel:[0,1,0] op_sel_hi:[1,1,1]
    v_pk_fma_f32 v[96:97], v[32:33], v[24:25], v[60:61] op_sel:[0,1,0] op_sel_hi:[1,1,1]
    v_pk_fma_f32 v[98:99], v[34:35], v[24:25], v[62:63] op_sel:[0,1,0] op_sel_hi:[1,1,1]
    v_pk_fma_f32 v[124:125], v[124:125], v[20:21], v[92:93] op_sel:[0,1,0] op_sel_hi:[1,1,1]
    v_pk_fma_f32 v[126:127], v[126:127], v[20:21], v[94:95] op_sel:[0,1,0] op_sel_hi:[1,1,1]
    v_pk_fma_f32 v[140:141], v[140:141], v[20:21], v[96:97] op_sel:[0,1,0] op_sel_hi:[1,1,1]
    v_pk_fma_f32 v[142:143], v[142:143], v[20:21], v[98:99] op_sel:[0,1,0] op_sel_hi:[1,1,1]
    v_exp_f32 v92, v124
    v_exp_f32 v93, v125
    v_exp_f32 v94, v126
    v_exp_f32 v95, v127
    v_exp_f32 v96, v140
    v_exp_f32 v97, v141
    v_exp_f32 v98, v142
    v_exp_f32 v99, v143
    v_pk_fma_f32 v[92:93], v[92:93], s[50:51], s[50:51]
    v_pk_fma_f32 v[94:95], v[94:95], s[50:51], s[50:51]
    v_pk_fma_f32 v[96:97], v[96:97], s[50:51], s[50:51]
    v_pk_fma_f32 v[98:99], v[98:99], s[50:51], s[50:51]
    v_rcp_f32 v92, v92
    v_rcp_f32 v93, v93
    v_rcp_f32 v94, v94
    v_rcp_f32 v95, v95
    v_rcp_f32 v96, v96
    v_rcp_f32 v97, v97
    v_rcp_f32 v98, v98
    v_rcp_f32 v99, v99
    v_pk_mul_f32 v[124:125], v[124:125], v[92:93]
    v_pk_mul_f32 v[126:127], v[126:127], v[94:95]
    v_pk_mul_f32 v[140:141], v[140:141], v[96:97]
    v_pk_mul_f32 v[142:143], v[142:143], v[98:99]
    v_cvt_pk_bf16_f32 v108, v124, v125
    v_cvt_pk_bf16_f32 v109, v126, v127
    v_cvt_pk_bf16_f32 v110, v140, v141
    v_cvt_pk_bf16_f32 v111, v142, v143
    buffer_store_dwordx4 v[108:111], v12, s[24:27], s42 offen offset:1024 sc1
    v_pk_fma_f32 v[92:93], v[28:29], v[26:27], v[56:57] op_sel:[0,0,0] op_sel_hi:[1,0,1]
    v_pk_fma_f32 v[94:95], v[30:31], v[26:27], v[58:59] op_sel:[0,0,0] op_sel_hi:[1,0,1]
    v_pk_fma_f32 v[96:97], v[32:33], v[26:27], v[60:61] op_sel:[0,0,0] op_sel_hi:[1,0,1]
    v_pk_fma_f32 v[98:99], v[34:35], v[26:27], v[62:63] op_sel:[0,0,0] op_sel_hi:[1,0,1]
    v_pk_fma_f32 v[128:129], v[128:129], v[22:23], v[92:93] op_sel:[0,0,0] op_sel_hi:[1,0,1]
    v_pk_fma_f32 v[130:131], v[130:131], v[22:23], v[94:95] op_sel:[0,0,0] op_sel_hi:[1,0,1]
    v_pk_fma_f32 v[144:145], v[144:145], v[22:23], v[96:97] op_sel:[0,0,0] op_sel_hi:[1,0,1]
    v_pk_fma_f32 v[146:147], v[146:147], v[22:23], v[98:99] op_sel:[0,0,0] op_sel_hi:[1,0,1]
    v_exp_f32 v92, v128
    v_exp_f32 v93, v129
    v_exp_f32 v94, v130
    v_exp_f32 v95, v131
    v_exp_f32 v96, v144
    v_exp_f32 v97, v145
    v_exp_f32 v98, v146
    v_exp_f32 v99, v147
    v_pk_fma_f32 v[92:93], v[92:93], s[50:51], s[50:51]
    v_pk_fma_f32 v[94:95], v[94:95], s[50:51], s[50:51]
    v_pk_fma_f32 v[96:97], v[96:97], s[50:51], s[50:51]
    v_pk_fma_f32 v[98:99], v[98:99], s[50:51], s[50:51]
    v_rcp_f32 v92, v92
    v_rcp_f32 v93, v93
    v_rcp_f32 v94, v94
    v_rcp_f32 v95, v95
    v_rcp_f32 v96, v96
    v_rcp_f32 v97, v97
    v_rcp_f32 v98, v98
    v_rcp_f32 v99, v99
    v_pk_mul_f32 v[128:129], v[128:129], v[92:93]
    v_pk_mul_f32 v[130:131], v[130:131], v[94:95]
    v_pk_mul_f32 v[144:145], v[144:145], v[96:97]
    v_pk_mul_f32 v[146:147], v[146:147], v[98:99]
    v_cvt_pk_bf16_f32 v104, v128, v129
    v_cvt_pk_bf16_f32 v105, v130, v131
    v_cvt_pk_bf16_f32 v106, v144, v145
    v_cvt_pk_bf16_f32 v107, v146, v147
    buffer_store_dwordx4 v[104:107], v12, s[24:27], s42 offen offset:2048 sc1
    v_pk_fma_f32 v[92:93], v[28:29], v[26:27], v[56:57] op_sel:[0,1,0] op_sel_hi:[1,1,1]
    v_pk_fma_f32 v[94:95], v[30:31], v[26:27], v[58:59] op_sel:[0,1,0] op_sel_hi:[1,1,1]
    v_pk_fma_f32 v[96:97], v[32:33], v[26:27], v[60:61] op_sel:[0,1,0] op_sel_hi:[1,1,1]
    v_pk_fma_f32 v[98:99], v[34:35], v[26:27], v[62:63] op_sel:[0,1,0] op_sel_hi:[1,1,1]
    v_pk_fma_f32 v[132:133], v[132:133], v[22:23], v[92:93] op_sel:[0,1,0] op_sel_hi:[1,1,1]
    v_pk_fma_f32 v[134:135], v[134:135], v[22:23], v[94:95] op_sel:[0,1,0] op_sel_hi:[1,1,1]
    v_pk_fma_f32 v[148:149], v[148:149], v[22:23], v[96:97] op_sel:[0,1,0] op_sel_hi:[1,1,1]
    v_pk_fma_f32 v[150:151], v[150:151], v[22:23], v[98:99] op_sel:[0,1,0] op_sel_hi:[1,1,1]
    v_exp_f32 v92, v132
    v_exp_f32 v93, v133
    v_exp_f32 v94, v134
    v_exp_f32 v95, v135
    v_exp_f32 v96, v148
    v_exp_f32 v97, v149
    v_exp_f32 v98, v150
    v_exp_f32 v99, v151
    v_pk_fma_f32 v[92:93], v[92:93], s[50:51], s[50:51]
    v_pk_fma_f32 v[94:95], v[94:95], s[50:51], s[50:51]
    v_pk_fma_f32 v[96:97], v[96:97], s[50:51], s[50:51]
    v_pk_fma_f32 v[98:99], v[98:99], s[50:51], s[50:51]
    v_rcp_f32 v92, v92
    v_rcp_f32 v93, v93
    v_rcp_f32 v94, v94
    v_rcp_f32 v95, v95
    v_rcp_f32 v96, v96
    v_rcp_f32 v97, v97
    v_rcp_f32 v98, v98
    v_rcp_f32 v99, v99
    v_pk_mul_f32 v[132:133], v[132:133], v[92:93]
    v_pk_mul_f32 v[134:135], v[134:135], v[94:95]
    v_pk_mul_f32 v[148:149], v[148:149], v[96:97]
    v_pk_mul_f32 v[150:151], v[150:151], v[98:99]
    v_cvt_pk_bf16_f32 v108, v132, v133
    v_cvt_pk_bf16_f32 v109, v134, v135
    v_cvt_pk_bf16_f32 v110, v148, v149
    v_cvt_pk_bf16_f32 v111, v150, v151
    buffer_store_dwordx4 v[108:111], v12, s[24:27], s42 offen offset:3072 sc1
    buffer_load_dwordx4 v3, s[12:15], s59 offen sc1 lds
    buffer_load_dwordx4 v3, s[12:15], s59 offen offset:1024 sc1 lds
    s_add_u32 s58, s58, 8192
    s_and_b32 m0, s58, 0x1ffff
    s_add_u32 s59, s59, 24576
    s_add_u32 s42, s42, 0x20000
    v_pk_fma_f32 v[92:93], v[36:37], v[24:25], v[64:65] op_sel:[0,0,0] op_sel_hi:[1,0,1]
    v_pk_fma_f32 v[94:95], v[38:39], v[24:25], v[66:67] op_sel:[0,0,0] op_sel_hi:[1,0,1]
    v_pk_fma_f32 v[96:97], v[40:41], v[24:25], v[68:69] op_sel:[0,0,0] op_sel_hi:[1,0,1]
    v_pk_fma_f32 v[98:99], v[42:43], v[24:25], v[70:71] op_sel:[0,0,0] op_sel_hi:[1,0,1]
    v_pk_fma_f32 v[152:153], v[152:153], v[20:21], v[92:93] op_sel:[0,0,0] op_sel_hi:[1,0,1]
    v_pk_fma_f32 v[154:155], v[154:155], v[20:21], v[94:95] op_sel:[0,0,0] op_sel_hi:[1,0,1]
    v_pk_fma_f32 v[168:169], v[168:169], v[20:21], v[96:97] op_sel:[0,0,0] op_sel_hi:[1,0,1]
    v_pk_fma_f32 v[170:171], v[170:171], v[20:21], v[98:99] op_sel:[0,0,0] op_sel_hi:[1,0,1]
    v_exp_f32 v92, v152
    v_exp_f32 v93, v153
    v_exp_f32 v94, v154
    v_exp_f32 v95, v155
    v_exp_f32 v96, v168
    v_exp_f32 v97, v169
    v_exp_f32 v98, v170
    v_exp_f32 v99, v171
    v_pk_fma_f32 v[92:93], v[92:93], s[50:51], s[50:51]
    v_pk_fma_f32 v[94:95], v[94:95], s[50:51], s[50:51]
    v_pk_fma_f32 v[96:97], v[96:97], s[50:51], s[50:51]
    v_pk_fma_f32 v[98:99], v[98:99], s[50:51], s[50:51]
    v_rcp_f32 v92, v92
    v_rcp_f32 v93, v93
    v_rcp_f32 v94, v94
    v_rcp_f32 v95, v95
    v_rcp_f32 v96, v96
    v_rcp_f32 v97, v97
    v_rcp_f32 v98, v98
    v_rcp_f32 v99, v99
    v_pk_mul_f32 v[152:153], v[152:153], v[92:93]
    v_pk_mul_f32 v[154:155], v[154:155], v[94:95]
    v_pk_mul_f32 v[168:169], v[168:169], v[96:97]
    v_pk_mul_f32 v[170:171], v[170:171], v[98:99]
    v_cvt_pk_bf16_f32 v104, v152, v153
    v_cvt_pk_bf16_f32 v105, v154, v155
    v_cvt_pk_bf16_f32 v106, v168, v169
    v_cvt_pk_bf16_f32 v107, v170, v171
    buffer_store_dwordx4 v[104:107], v12, s[24:27], s42 offen offset:0 sc1
    v_pk_fma_f32 v[92:93], v[36:37], v[24:25], v[64:65] op_sel:[0,1,0] op_sel_hi:[1,1,1]
    v_pk_fma_f32 v[94:95], v[38:39], v[24:25], v[66:67] op_sel:[0,1,0] op_sel_hi:[1,1,1]
    v_pk_fma_f32 v[96:97], v[40:41], v[24:25], v[68:69] op_sel:[0,1,0] op_sel_hi:[1,1,1]
    v_pk_fma_f32 v[98:99], v[42:43], v[24:25], v[70:71] op_sel:[0,1,0] op_sel_hi:[1,1,1]
    v_pk_fma_f32 v[156:157], v[156:157], v[20:21], v[92:93] op_sel:[0,1,0] op_sel_hi:[1,1,1]
    v_pk_fma_f32 v[158:159], v[158:159], v[20:21], v[94:95] op_sel:[0,1,0] op_sel_hi:[1,1,1]
    v_pk_fma_f32 v[172:173], v[172:173], v[20:21], v[96:97] op_sel:[0,1,0] op_sel_hi:[1,1,1]
    v_pk_fma_f32 v[174:175], v[174:175], v[20:21], v[98:99] op_sel:[0,1,0] op_sel_hi:[1,1,1]
    v_exp_f32 v92, v156
    v_exp_f32 v93, v157
    v_exp_f32 v94, v158
    v_exp_f32 v95, v159
    v_exp_f32 v96, v172
    v_exp_f32 v97, v173
    v_exp_f32 v98, v174
    v_exp_f32 v99, v175
    v_pk_fma_f32 v[92:93], v[92:93], s[50:51], s[50:51]
    v_pk_fma_f32 v[94:95], v[94:95], s[50:51], s[50:51]
    v_pk_fma_f32 v[96:97], v[96:97], s[50:51], s[50:51]
    v_pk_fma_f32 v[98:99], v[98:99], s[50:51], s[50:51]
    v_rcp_f32 v92, v92
    v_rcp_f32 v93, v93
    v_rcp_f32 v94, v94
    v_rcp_f32 v95, v95
    v_rcp_f32 v96, v96
    v_rcp_f32 v97, v97
    v_rcp_f32 v98, v98
    v_rcp_f32 v99, v99
    v_pk_mul_f32 v[156:157], v[156:157], v[92:93]
    v_pk_mul_f32 v[158:159], v[158:159], v[94:95]
    v_pk_mul_f32 v[172:173], v[172:173], v[96:97]
    v_pk_mul_f32 v[174:175], v[174:175], v[98:99]
    v_cvt_pk_bf16_f32 v108, v156, v157
    v_cvt_pk_bf16_f32 v109, v158, v159
    v_cvt_pk_bf16_f32 v110, v172, v173
    v_cvt_pk_bf16_f32 v111, v174, v175
    buffer_store_dwordx4 v[108:111], v12, s[24:27], s42 offen offset:1024 sc1
    v_pk_fma_f32 v[92:93], v[36:37], v[26:27], v[64:65] op_sel:[0,0,0] op_sel_hi:[1,0,1]
    v_pk_fma_f32 v[94:95], v[38:39], v[26:27], v[66:67] op_sel:[0,0,0] op_sel_hi:[1,0,1]
    v_pk_fma_f32 v[96:97], v[40:41], v[26:27], v[68:69] op_sel:[0,0,0] op_sel_hi:[1,0,1]
    v_pk_fma_f32 v[98:99], v[42:43], v[26:27], v[70:71] op_sel:[0,0,0] op_sel_hi:[1,0,1]
    v_pk_fma_f32 v[160:161], v[160:161], v[22:23], v[92:93] op_sel:[0,0,0] op_sel_hi:[1,0,1]
    v_pk_fma_f32 v[162:163], v[162:163], v[22:23], v[94:95] op_sel:[0,0,0] op_sel_hi:[1,0,1]
    v_pk_fma_f32 v[176:177], v[176:177], v[22:23], v[96:97] op_sel:[0,0,0] op_sel_hi:[1,0,1]
    v_pk_fma_f32 v[178:179], v[178:179], v[22:23], v[98:99] op_sel:[0,0,0] op_sel_hi:[1,0,1]
    v_exp_f32 v92, v160
    v_exp_f32 v93, v161
    v_exp_f32 v94, v162
    v_exp_f32 v95, v163
    v_exp_f32 v96, v176
    v_exp_f32 v97, v177
    v_exp_f32 v98, v178
    v_exp_f32 v99, v179
    v_pk_fma_f32 v[92:93], v[92:93], s[50:51], s[50:51]
    v_pk_fma_f32 v[94:95], v[94:95], s[50:51], s[50:51]
    v_pk_fma_f32 v[96:97], v[96:97], s[50:51], s[50:51]
    v_pk_fma_f32 v[98:99], v[98:99], s[50:51], s[50:51]
    v_rcp_f32 v92, v92
    v_rcp_f32 v93, v93
    v_rcp_f32 v94, v94
    v_rcp_f32 v95, v95
    v_rcp_f32 v96, v96
    v_rcp_f32 v97, v97
    v_rcp_f32 v98, v98
    v_rcp_f32 v99, v99
    v_pk_mul_f32 v[160:161], v[160:161], v[92:93]
    v_pk_mul_f32 v[162:163], v[162:163], v[94:95]
    v_pk_mul_f32 v[176:177], v[176:177], v[96:97]
    v_pk_mul_f32 v[178:179], v[178:179], v[98:99]
    v_cvt_pk_bf16_f32 v104, v160, v161
    v_cvt_pk_bf16_f32 v105, v162, v163
    v_cvt_pk_bf16_f32 v106, v176, v177
    v_cvt_pk_bf16_f32 v107, v178, v179
    buffer_store_dwordx4 v[104:107], v12, s[24:27], s42 offen offset:2048 sc1
    buffer_load_dwordx4 v3, s[12:15], s59 offen sc1 lds
    buffer_load_dwordx4 v3, s[12:15], s59 offen offset:1024 sc1 lds
    s_add_u32 s58, s58, 8192
    s_and_b32 m0, s58, 0x1ffff
    s_add_u32 s59, s59, 24576
    v_pk_fma_f32 v[92:93], v[36:37], v[26:27], v[64:65] op_sel:[0,1,0] op_sel_hi:[1,1,1]
    v_pk_fma_f32 v[94:95], v[38:39], v[26:27], v[66:67] op_sel:[0,1,0] op_sel_hi:[1,1,1]
    v_pk_fma_f32 v[96:97], v[40:41], v[26:27], v[68:69] op_sel:[0,1,0] op_sel_hi:[1,1,1]
    v_pk_fma_f32 v[98:99], v[42:43], v[26:27], v[70:71] op_sel:[0,1,0] op_sel_hi:[1,1,1]
    v_pk_fma_f32 v[164:165], v[164:165], v[22:23], v[92:93] op_sel:[0,1,0] op_sel_hi:[1,1,1]
    v_pk_fma_f32 v[166:167], v[166:167], v[22:23], v[94:95] op_sel:[0,1,0] op_sel_hi:[1,1,1]
    v_pk_fma_f32 v[180:181], v[180:181], v[22:23], v[96:97] op_sel:[0,1,0] op_sel_hi:[1,1,1]
    v_pk_fma_f32 v[182:183], v[182:183], v[22:23], v[98:99] op_sel:[0,1,0] op_sel_hi:[1,1,1]
    v_exp_f32 v92, v164
    v_exp_f32 v93, v165
    v_exp_f32 v94, v166
    v_exp_f32 v95, v167
    v_exp_f32 v96, v180
    v_exp_f32 v97, v181
    v_exp_f32 v98, v182
    v_exp_f32 v99, v183
    v_pk_fma_f32 v[92:93], v[92:93], s[50:51], s[50:51]
    v_pk_fma_f32 v[94:95], v[94:95], s[50:51], s[50:51]
    v_pk_fma_f32 v[96:97], v[96:97], s[50:51], s[50:51]
    v_pk_fma_f32 v[98:99], v[98:99], s[50:51], s[50:51]
    v_rcp_f32 v92, v92
    v_rcp_f32 v93, v93
    v_rcp_f32 v94, v94
    v_rcp_f32 v95, v95
    v_rcp_f32 v96, v96
    v_rcp_f32 v97, v97
    v_rcp_f32 v98, v98
    v_rcp_f32 v99, v99
    v_pk_mul_f32 v[164:165], v[164:165], v[92:93]
    v_pk_mul_f32 v[166:167], v[166:167], v[94:95]
    v_pk_mul_f32 v[180:181], v[180:181], v[96:97]
    v_pk_mul_f32 v[182:183], v[182:183], v[98:99]
    v_cvt_pk_bf16_f32 v108, v164, v165
    v_cvt_pk_bf16_f32 v109, v166, v167
    v_cvt_pk_bf16_f32 v110, v180, v181
    v_cvt_pk_bf16_f32 v111, v182, v183
    buffer_store_dwordx4 v[108:111], v12, s[24:27], s42 offen offset:3072 sc1
    s_add_u32 s42, s42, 0x20000
    s_waitcnt vmcnt(8)
    v_mov_b32 v4, 0
    v_mov_b32 v5, 1
    s_mov_b64 exec, 1
    buffer_store_dword v5, v4, s[24:27], s56 offen sc1
    s_mov_b64 exec, -1
    v_pk_fma_f32 v[92:93], v[44:45], v[24:25], v[72:73] op_sel:[0,0,0] op_sel_hi:[1,0,1]
    v_pk_fma_f32 v[94:95], v[46:47], v[24:25], v[74:75] op_sel:[0,0,0] op_sel_hi:[1,0,1]
    v_pk_fma_f32 v[96:97], v[48:49], v[24:25], v[76:77] op_sel:[0,0,0] op_sel_hi:[1,0,1]
    v_pk_fma_f32 v[98:99], v[50:51], v[24:25], v[78:79] op_sel:[0,0,0] op_sel_hi:[1,0,1]
    v_pk_fma_f32 v[184:185], v[184:185], v[20:21], v[92:93] op_sel:[0,0,0] op_sel_hi:[1,0,1]
    v_pk_fma_f32 v[186:187], v[186:187], v[20:21], v[94:95] op_sel:[0,0,0] op_sel_hi:[1,0,1]
    v_pk_fma_f32 v[200:201], v[200:201], v[20:21], v[96:97] op_sel:[0,0,0] op_sel_hi:[1,0,1]
    v_pk_fma_f32 v[202:203], v[202:203], v[20:21], v[98:99] op_sel:[0,0,0] op_sel_hi:[1,0,1]
    v_exp_f32 v92, v184
    v_exp_f32 v93, v185
    v_exp_f32 v94, v186
    v_exp_f32 v95, v187
    v_exp_f32 v96, v200
    v_exp_f32 v97, v201
    v_exp_f32 v98, v202
    v_exp_f32 v99, v203
    v_pk_fma_f32 v[92:93], v[92:93], s[50:51], s[50:51]
    v_pk_fma_f32 v[94:95], v[94:95], s[50:51], s[50:51]
    v_pk_fma_f32 v[96:97], v[96:97], s[50:51], s[50:51]
    v_pk_fma_f32 v[98:99], v[98:99], s[50:51], s[50:51]
    v_rcp_f32 v92, v92
    v_rcp_f32 v93, v93
    v_rcp_f32 v94, v94
    v_rcp_f32 v95, v95
    v_rcp_f32 v96, v96
    v_rcp_f32 v97, v97
    v_rcp_f32 v98, v98
    v_rcp_f32 v99, v99
    v_pk_mul_f32 v[184:185], v[184:185], v[92:93]
    v_pk_mul_f32 v[186:187], v[186:187], v[94:95]
    v_pk_mul_f32 v[200:201], v[200:201], v[96:97]
    v_pk_mul_f32 v[202:203], v[202:203], v[98:99]
    v_cvt_pk_bf16_f32 v104, v184, v185
    v_cvt_pk_bf16_f32 v105, v186, v187
    v_cvt_pk_bf16_f32 v106, v200, v201
    v_cvt_pk_bf16_f32 v107, v202, v203
    buffer_store_dwordx4 v[104:107], v12, s[24:27], s42 offen offset:0 sc1
    v_pk_fma_f32 v[92:93], v[44:45], v[24:25], v[72:73] op_sel:[0,1,0] op_sel_hi:[1,1,1]
    v_pk_fma_f32 v[94:95], v[46:47], v[24:25], v[74:75] op_sel:[0,1,0] op_sel_hi:[1,1,1]
    v_pk_fma_f32 v[96:97], v[48:49], v[24:25], v[76:77] op_sel:[0,1,0] op_sel_hi:[1,1,1]
    v_pk_fma_f32 v[98:99], v[50:51], v[24:25], v[78:79] op_sel:[0,1,0] op_sel_hi:[1,1,1]
    v_pk_fma_f32 v[188:189], v[188:189], v[20:21], v[92:93] op_sel:[0,1,0] op_sel_hi:[1,1,1]
    v_pk_fma_f32 v[190:191], v[190:191], v[20:21], v[94:95] op_sel:[0,1,0] op_sel_hi:[1,1,1]
    v_pk_fma_f32 v[204:205], v[204:205], v[20:21], v[96:97] op_sel:[0,1,0] op_sel_hi:[1,1,1]
    v_pk_fma_f32 v[206:207], v[206:207], v[20:21], v[98:99] op_sel:[0,1,0] op_sel_hi:[1,1,1]
    v_exp_f32 v92, v188
    v_exp_f32 v93, v189
    v_exp_f32 v94, v190
    v_exp_f32 v95, v191
    v_exp_f32 v96, v204
    v_exp_f32 v97, v205
    v_exp_f32 v98, v206
    v_exp_f32 v99, v207
    v_pk_fma_f32 v[92:93], v[92:93], s[50:51], s[50:51]
    v_pk_fma_f32 v[94:95], v[94:95], s[50:51], s[50:51]
    v_pk_fma_f32 v[96:97], v[96:97], s[50:51], s[50:51]
    v_pk_fma_f32 v[98:99], v[98:99], s[50:51], s[50:51]
    v_rcp_f32 v92, v92
    v_rcp_f32 v93, v93
    v_rcp_f32 v94, v94
    v_rcp_f32 v95, v95
    v_rcp_f32 v96, v96
    v_rcp_f32 v97, v97
    v_rcp_f32 v98, v98
    v_rcp_f32 v99, v99
    v_pk_mul_f32 v[188:189], v[188:189], v[92:93]
    v_pk_mul_f32 v[190:191], v[190:191], v[94:95]
    v_pk_mul_f32 v[204:205], v[204:205], v[96:97]
    v_pk_mul_f32 v[206:207], v[206:207], v[98:99]
    v_cvt_pk_bf16_f32 v108, v188, v189
    v_cvt_pk_bf16_f32 v109, v190, v191
    v_cvt_pk_bf16_f32 v110, v204, v205
    v_cvt_pk_bf16_f32 v111, v206, v207
    buffer_store_dwordx4 v[108:111], v12, s[24:27], s42 offen offset:1024 sc1
    v_pk_fma_f32 v[92:93], v[44:45], v[26:27], v[72:73] op_sel:[0,0,0] op_sel_hi:[1,0,1]
    v_pk_fma_f32 v[94:95], v[46:47], v[26:27], v[74:75] op_sel:[0,0,0] op_sel_hi:[1,0,1]
    v_pk_fma_f32 v[96:97], v[48:49], v[26:27], v[76:77] op_sel:[0,0,0] op_sel_hi:[1,0,1]
    v_pk_fma_f32 v[98:99], v[50:51], v[26:27], v[78:79] op_sel:[0,0,0] op_sel_hi:[1,0,1]
    v_pk_fma_f32 v[192:193], v[192:193], v[22:23], v[92:93] op_sel:[0,0,0] op_sel_hi:[1,0,1]
    v_pk_fma_f32 v[194:195], v[194:195], v[22:23], v[94:95] op_sel:[0,0,0] op_sel_hi:[1,0,1]
    v_pk_fma_f32 v[208:209], v[208:209], v[22:23], v[96:97] op_sel:[0,0,0] op_sel_hi:[1,0,1]
    v_pk_fma_f32 v[210:211], v[210:211], v[22:23], v[98:99] op_sel:[0,0,0] op_sel_hi:[1,0,1]
    v_exp_f32 v92, v192
    v_exp_f32 v93, v193
    v_exp_f32 v94, v194
    v_exp_f32 v95, v195
    v_exp_f32 v96, v208
    v_exp_f32 v97, v209
    v_exp_f32 v98, v210
    v_exp_f32 v99, v211
    v_pk_fma_f32 v[92:93], v[92:93], s[50:51], s[50:51]
    v_pk_fma_f32 v[94:95], v[94:95], s[50:51], s[50:51]
    v_pk_fma_f32 v[96:97], v[96:97], s[50:51], s[50:51]
    v_pk_fma_f32 v[98:99], v[98:99], s[50:51], s[50:51]
    v_rcp_f32 v92, v92
    v_rcp_f32 v93, v93
    v_rcp_f32 v94, v94
    v_rcp_f32 v95, v95
    v_rcp_f32 v96, v96
    v_rcp_f32 v97, v97
    v_rcp_f32 v98, v98
    v_rcp_f32 v99, v99
    v_pk_mul_f32 v[192:193], v[192:193], v[92:93]
    v_pk_mul_f32 v[194:195], v[194:195], v[94:95]
    v_pk_mul_f32 v[208:209], v[208:209], v[96:97]
    v_pk_mul_f32 v[210:211], v[210:211], v[98:99]
    v_cvt_pk_bf16_f32 v104, v192, v193
    v_cvt_pk_bf16_f32 v105, v194, v195
    v_cvt_pk_bf16_f32 v106, v208, v209
    v_cvt_pk_bf16_f32 v107, v210, v211
    buffer_store_dwordx4 v[104:107], v12, s[24:27], s42 offen offset:2048 sc1
    v_pk_fma_f32 v[92:93], v[44:45], v[26:27], v[72:73] op_sel:[0,1,0] op_sel_hi:[1,1,1]
    v_pk_fma_f32 v[94:95], v[46:47], v[26:27], v[74:75] op_sel:[0,1,0] op_sel_hi:[1,1,1]
    v_pk_fma_f32 v[96:97], v[48:49], v[26:27], v[76:77] op_sel:[0,1,0] op_sel_hi:[1,1,1]
    v_pk_fma_f32 v[98:99], v[50:51], v[26:27], v[78:79] op_sel:[0,1,0] op_sel_hi:[1,1,1]
    v_pk_fma_f32 v[196:197], v[196:197], v[22:23], v[92:93] op_sel:[0,1,0] op_sel_hi:[1,1,1]
    v_pk_fma_f32 v[198:199], v[198:199], v[22:23], v[94:95] op_sel:[0,1,0] op_sel_hi:[1,1,1]
    v_pk_fma_f32 v[212:213], v[212:213], v[22:23], v[96:97] op_sel:[0,1,0] op_sel_hi:[1,1,1]
    v_pk_fma_f32 v[214:215], v[214:215], v[22:23], v[98:99] op_sel:[0,1,0] op_sel_hi:[1,1,1]
    v_exp_f32 v92, v196
    v_exp_f32 v93, v197
    v_exp_f32 v94, v198
    v_exp_f32 v95, v199
    v_exp_f32 v96, v212
    v_exp_f32 v97, v213
    v_exp_f32 v98, v214
    v_exp_f32 v99, v215
    v_pk_fma_f32 v[92:93], v[92:93], s[50:51], s[50:51]
    v_pk_fma_f32 v[94:95], v[94:95], s[50:51], s[50:51]
    v_pk_fma_f32 v[96:97], v[96:97], s[50:51], s[50:51]
    v_pk_fma_f32 v[98:99], v[98:99], s[50:51], s[50:51]
    v_rcp_f32 v92, v92
    v_rcp_f32 v93, v93
    v_rcp_f32 v94, v94
    v_rcp_f32 v95, v95
    v_rcp_f32 v96, v96
    v_rcp_f32 v97, v97
    v_rcp_f32 v98, v98
    v_rcp_f32 v99, v99
    v_pk_mul_f32 v[196:197], v[196:197], v[92:93]
    v_pk_mul_f32 v[198:199], v[198:199], v[94:95]
    v_pk_mul_f32 v[212:213], v[212:213], v[96:97]
    v_pk_mul_f32 v[214:215], v[214:215], v[98:99]
    v_cvt_pk_bf16_f32 v108, v196, v197
    v_cvt_pk_bf16_f32 v109, v198, v199
    v_cvt_pk_bf16_f32 v110, v212, v213
    v_cvt_pk_bf16_f32 v111, v214, v215
    buffer_store_dwordx4 v[108:111], v12, s[24:27], s42 offen offset:3072 sc1
    v_pk_fma_f32 v[92:93], v[52:53], v[24:25], v[80:81] op_sel:[0,0,0] op_sel_hi:[1,0,1]
    v_pk_fma_f32 v[94:95], v[54:55], v[24:25], v[82:83] op_sel:[0,0,0] op_sel_hi:[1,0,1]
    v_pk_fma_f32 v[96:97], v[52:53], v[24:25], v[80:81] op_sel:[0,1,0] op_sel_hi:[1,1,1]
    v_pk_fma_f32 v[98:99], v[54:55], v[24:25], v[82:83] op_sel:[0,1,0] op_sel_hi:[1,1,1]
    v_pk_fma_f32 v[216:217], v[216:217], v[20:21], v[92:93] op_sel:[0,0,0] op_sel_hi:[1,0,1]
    v_pk_fma_f32 v[218:219], v[218:219], v[20:21], v[94:95] op_sel:[0,0,0] op_sel_hi:[1,0,1]
    v_pk_fma_f32 v[220:221], v[220:221], v[20:21], v[96:97] op_sel:[0,1,0] op_sel_hi:[1,1,1]
    v_pk_fma_f32 v[222:223], v[222:223], v[20:21], v[98:99] op_sel:[0,1,0] op_sel_hi:[1,1,1]
    v_exp_f32 v92, v216
    v_exp_f32 v93, v217
    v_exp_f32 v94, v218
    v_exp_f32 v95, v219
    v_exp_f32 v96, v220
    v_exp_f32 v97, v221
    v_exp_f32 v98, v222
    v_exp_f32 v99, v223
    v_pk_fma_f32 v[92:93], v[92:93], s[50:51], s[50:51]
    v_pk_fma_f32 v[94:95], v[94:95], s[50:51], s[50:51]
    v_pk_fma_f32 v[96:97], v[96:97], s[50:51], s[50:51]
    v_pk_fma_f32 v[98:99], v[98:99], s[50:51], s[50:51]
    v_rcp_f32 v92, v92
    v_rcp_f32 v93, v93
    v_rcp_f32 v94, v94
    v_rcp_f32 v95, v95
    v_rcp_f32 v96, v96
    v_rcp_f32 v97, v97
    v_rcp_f32 v98, v98
    v_rcp_f32 v99, v99
    v_pk_mul_f32 v[216:217], v[216:217], v[92:93]
    v_pk_mul_f32 v[218:219], v[218:219], v[94:95]
    v_pk_mul_f32 v[220:221], v[220:221], v[96:97]
    v_pk_mul_f32 v[222:223], v[222:223], v[98:99]
    v_cvt_pk_bf16_f32 v104, v216, v217
    v_cvt_pk_bf16_f32 v105, v218, v219
    v_cvt_pk_bf16_f32 v106, v220, v221
    v_cvt_pk_bf16_f32 v107, v222, v223
    buffer_store_dwordx4 v[104:107], v12, s[24:27], s49 offen offset:0 sc1
    v_pk_fma_f32 v[92:93], v[52:53], v[26:27], v[80:81] op_sel:[0,0,0] op_sel_hi:[1,0,1]
    v_pk_fma_f32 v[94:95], v[54:55], v[26:27], v[82:83] op_sel:[0,0,0] op_sel_hi:[1,0,1]
    v_pk_fma_f32 v[96:97], v[52:53], v[26:27], v[80:81] op_sel:[0,1,0] op_sel_hi:[1,1,1]
    v_pk_fma_f32 v[98:99], v[54:55], v[26:27], v[82:83] op_sel:[0,1,0] op_sel_hi:[1,1,1]
    v_pk_fma_f32 v[224:225], v[224:225], v[22:23], v[92:93] op_sel:[0,0,0] op_sel_hi:[1,0,1]
    v_pk_fma_f32 v[226:227], v[226:227], v[22:23], v[94:95] op_sel:[0,0,0] op_sel_hi:[1,0,1]
    v_pk_fma_f32 v[228:229], v[228:229], v[22:23], v[96:97] op_sel:[0,1,0] op_sel_hi:[1,1,1]
    v_pk_fma_f32 v[230:231], v[230:231], v[22:23], v[98:99] op_sel:[0,1,0] op_sel_hi:[1,1,1]
    v_exp_f32 v92, v224
    v_exp_f32 v93, v225
    v_exp_f32 v94, v226
    v_exp_f32 v95, v227
    v_exp_f32 v96, v228
    v_exp_f32 v97, v229
    v_exp_f32 v98, v230
    v_exp_f32 v99, v231
    v_pk_fma_f32 v[92:93], v[92:93], s[50:51], s[50:51]
    v_pk_fma_f32 v[94:95], v[94:95], s[50:51], s[50:51]
    v_pk_fma_f32 v[96:97], v[96:97], s[50:51], s[50:51]
    v_pk_fma_f32 v[98:99], v[98:99], s[50:51], s[50:51]
    v_rcp_f32 v92, v92
    v_rcp_f32 v93, v93
    v_rcp_f32 v94, v94
    v_rcp_f32 v95, v95
    v_rcp_f32 v96, v96
    v_rcp_f32 v97, v97
    v_rcp_f32 v98, v98
    v_rcp_f32 v99, v99
    v_pk_mul_f32 v[224:225], v[224:225], v[92:93]
    v_pk_mul_f32 v[226:227], v[226:227], v[94:95]
    v_pk_mul_f32 v[228:229], v[228:229], v[96:97]
    v_pk_mul_f32 v[230:231], v[230:231], v[98:99]
    v_cvt_pk_bf16_f32 v108, v224, v225
    v_cvt_pk_bf16_f32 v109, v226, v227
    v_cvt_pk_bf16_f32 v110, v228, v229
    v_cvt_pk_bf16_f32 v111, v230, v231
    buffer_load_dword v11, v10, s[24:27], s53 offen sc1
    buffer_store_dwordx4 v[108:111], v12, s[24:27], s49 offen offset:2048 sc1
    s_mul_i32 s43, s52, 7340032
    s_add_u32 s4, s10, s43
    s_addc_u32 s5, s11, 0
    s_add_u32 s28, s4, 0x100000
    s_addc_u32 s29, s5, 0
    s_and_b32 s29, s29, 0xffff
    s_mov_b32 s30, 0x700000
    s_mov_b32 s31, 0x20000
    s_mov_b32 s48, 0
    s_lshl_b32 s43, s47, 11
    v_add_u32 v12, s43, v2
    v_bfe_u32 v4, v1, 2, 2
    v_lshl_add_u32 v5, v15, 2, v4
    v_and_b32 v4, 3, v1
    v_lshlrev_b32 v4, 3, v4
    v_lshl_add_u32 v4, v5, 8, v4
    v_and_b32 v5, 7, v5
    v_lshl_add_u32 v4, v5, 5, v4
    s_lshl_b32 s43, s52, 7
    v_xor_b32 v16, s43, v4
    v_xor_b32 v17, 32, v16
    v_xor_b32 v18, 64, v16
    v_xor_b32 v19, 96, v16
    v_xor_b32 v20, 128, v16
    v_xor_b32 v21, 160, v16
    v_xor_b32 v22, 192, v16
    v_xor_b32 v23, 224, v16
    s_waitcnt vmcnt(1)
    v_cmp_eq_u32 vcc, 0, v11
    s_barrier
    s_cmp_eq_u64 vcc, 0
    s_cbranch_scc1 K6_AOK
    s_mov_b32 s60, 0x200000
POLL_HA:
    buffer_load_dword v11, v10, s[24:27], s53 offen sc1
    s_sub_u32 s60, s60, 1
    s_waitcnt vmcnt(0)
    v_cmp_eq_u32 vcc, 0, v11
    s_cmp_eq_u32 s60, 0
    s_cbranch_scc1 POLLX_HA
    s_cmp_eq_u64 vcc, 0
    s_cbranch_scc1 POLLX_HA
    s_sleep 4
    s_branch POLL_HA
POLLX_HA:
K6_AOK:
    buffer_load_dwordx4 v[120:123], v12, s[28:31], s48 offen offset:0 sc1
    buffer_load_dwordx4 v[124:127], v12, s[28:31], s48 offen offset:1024 sc1
    s_add_u32 s48, s48, 393216
    buffer_load_dwordx4 v[128:131], v12, s[28:31], s48 offen offset:0 sc1
    buffer_load_dwordx4 v[132:135], v12, s[28:31], s48 offen offset:1024 sc1
    s_add_u32 s48, s48, 393216
    buffer_load_dwordx4 v[136:139], v12, s[28:31], s48 offen offset:0 sc1
    buffer_load_dwordx4 v[140:143], v12, s[28:31], s48 offen offset:1024 sc1
    s_add_u32 s48, s48, 393216
    buffer_load_dwordx4 v[144:147], v12, s[28:31], s48 offen offset:0 sc1
    buffer_load_dwordx4 v[148:151], v12, s[28:31], s48 offen offset:1024 sc1
    s_add_u32 s48, s48, 393216
    buffer_load_dwordx4 v[152:155], v12, s[28:31], s48 offen offset:0 sc1
    buffer_load_dwordx4 v[156:159], v12, s[28:31], s48 offen offset:1024 sc1
    s_add_u32 s48, s48, 393216
    ds_read_b64_tr_b16 v[24:25], v16 offset:0
    ds_read_b64_tr_b16 v[26:27], v16 offset:4096
    ds_read_b64_tr_b16 v[28:29], v17 offset:0
    ds_read_b64_tr_b16 v[30:31], v17 offset:4096
    ds_read_b64_tr_b16 v[32:33], v18 offset:0
    ds_read_b64_tr_b16 v[34:35], v18 offset:4096
    ds_read_b64_tr_b16 v[36:37], v19 offset:0
    ds_read_b64_tr_b16 v[38:39], v19 offset:4096
    ds_read_b64_tr_b16 v[40:41], v20 offset:0
    ds_read_b64_tr_b16 v[42:43], v20 offset:4096
    ds_read_b64_tr_b16 v[44:45], v21 offset:0
    ds_read_b64_tr_b16 v[46:47], v21 offset:4096
    ds_read_b64_tr_b16 v[48:49], v22 offset:0
    ds_read_b64_tr_b16 v[50:51], v22 offset:4096
    ds_read_b64_tr_b16 v[52:53], v23 offset:0
    ds_read_b64_tr_b16 v[54:55], v23 offset:4096
    s_mov_b32 s20, s6
    s_and_b32 s21, s7, 0xffff
    s_mov_b32 s22, 0x400000
    s_mov_b32 s23, 0x20000
    s_lshl_b32 s43, s41, 8
    v_lshlrev_b32 v13, 2, v1
    v_add_u32 v13, s43, v13
    s_mov_b32 s54, 20480
    s_mov_b32 s51, 24576
    s_mov_b32 s63, 393216
    s_add_u32 s56, s56, 262144
    s_add_u32 s53, s53, 262144
    v_mov_b64 v[56:57], 0
    v_mov_b64 v[58:59], 0
    v_mov_b64 v[60:61], 0
    v_mov_b64 v[62:63], 0
    v_mov_b64 v[64:65], 0
    v_mov_b64 v[66:67], 0
    v_mov_b64 v[68:69], 0
    v_mov_b64 v[70:71], 0
    v_mov_b64 v[72:73], 0
    v_mov_b64 v[74:75], 0
    v_mov_b64 v[76:77], 0
    v_mov_b64 v[78:79], 0
    v_mov_b64 v[80:81], 0
    v_mov_b64 v[82:83], 0
    v_mov_b64 v[84:85], 0
    v_mov_b64 v[86:87], 0
    v_mov_b64 v[88:89], 0
    v_mov_b64 v[90:91], 0
    v_mov_b64 v[92:93], 0
    v_mov_b64 v[94:95], 0
    v_mov_b64 v[96:97], 0
    v_mov_b64 v[98:99], 0
    v_mov_b64 v[100:101], 0
    v_mov_b64 v[102:103], 0
    v_mov_b64 v[104:105], 0
    v_mov_b64 v[106:107], 0
    v_mov_b64 v[108:109], 0
    v_mov_b64 v[110:111], 0
    v_mov_b64 v[112:113], 0
    v_mov_b64 v[114:115], 0
    v_mov_b64 v[116:117], 0
    v_mov_b64 v[118:119], 0
    s_waitcnt vmcnt(8) lgkmcnt(0)
    v_mov_b32 v4, 0
    v_mov_b32 v5, 1
    s_mov_b64 exec, 1
    buffer_store_dword v5, v4, s[24:27], s56 offen sc1
    s_mov_b64 exec, -1
    v_mfma_f32_16x16x32_bf16 v[56:59], v[24:27], v[120:123], v[56:59]
    buffer_load_dwordx4 v[160:163], v12, s[28:31], s48 offen offset:0 sc1
    v_mfma_f32_16x16x32_bf16 v[60:63], v[24:27], v[124:127], v[60:63]
    ds_read_b64_tr_b16 v[24:25], v16 offset:8192
    v_mfma_f32_16x16x32_bf16 v[64:67], v[28:31], v[120:123], v[64:67]
    ds_read_b64_tr_b16 v[26:27], v16 offset:12288
    buffer_load_dwordx4 v[164:167], v12, s[28:31], s48 offen offset:1024 sc1
    v_mfma_f32_16x16x32_bf16 v[68:71], v[28:31], v[124:127], v[68:71]
    s_cmp_ge_u32 s48, 5898240
    ds_read_b64_tr_b16 v[28:29], v17 offset:8192
    v_mfma_f32_16x16x32_bf16 v[72:75], v[32:35], v[120:123], v[72:75]
    s_cselect_b32 s62, 4289200128, s63
    ds_read_b64_tr_b16 v[30:31], v17 offset:12288
    v_mfma_f32_16x16x32_bf16 v[76:79], v[32:35], v[124:127], v[76:79]
    s_cmp_ge_u32 s48, 6160384
    ds_read_b64_tr_b16 v[32:33], v18 offset:8192
    v_mfma_f32_16x16x32_bf16 v[80:83], v[36:39], v[120:123], v[80:83]
    s_cselect_b32 s62, 131072, s62
    ds_read_b64_tr_b16 v[34:35], v18 offset:12288
    v_mfma_f32_16x16x32_bf16 v[84:87], v[36:39], v[124:127], v[84:87]
    s_waitcnt lgkmcnt(6)
    ds_read_b64_tr_b16 v[36:37], v19 offset:8192
    v_mfma_f32_16x16x32_bf16 v[88:91], v[40:43], v[120:123], v[88:91]
    s_add_u32 s48, s48, s62
    ds_read_b64_tr_b16 v[38:39], v19 offset:12288
    v_mfma_f32_16x16x32_bf16 v[92:95], v[40:43], v[124:127], v[92:95]
    ds_read_b64_tr_b16 v[40:41], v20 offset:8192
    v_mfma_f32_16x16x32_bf16 v[96:99], v[44:47], v[120:123], v[96:99]
    ds_read_b64_tr_b16 v[42:43], v20 offset:12288
    v_mfma_f32_16x16x32_bf16 v[100:103], v[44:47], v[124:127], v[100:103]
    ds_read_b64_tr_b16 v[44:45], v21 offset:8192
    v_mfma_f32_16x16x32_bf16 v[104:107], v[48:51], v[120:123], v[104:107]
    ds_read_b64_tr_b16 v[46:47], v21 offset:12288
    v_mfma_f32_16x16x32_bf16 v[108:111], v[48:51], v[124:127], v[108:111]
    ds_read_b64_tr_b16 v[48:49], v22 offset:8192
    v_mfma_f32_16x16x32_bf16 v[112:115], v[52:55], v[120:123], v[112:115]
    ds_read_b64_tr_b16 v[50:51], v22 offset:12288
    v_mfma_f32_16x16x32_bf16 v[116:119], v[52:55], v[124:127], v[116:119]
    s_waitcnt vmcnt(9) lgkmcnt(6)
    ds_read_b64_tr_b16 v[52:53], v23 offset:8192
    v_mfma_f32_16x16x32_bf16 v[56:59], v[24:27], v[128:131], v[56:59]
    ds_read_b64_tr_b16 v[54:55], v23 offset:12288
    buffer_load_dwordx4 v[168:171], v12, s[28:31], s48 offen offset:0 sc1
    s_barrier
    v_mfma_f32_16x16x32_bf16 v[60:63], v[24:27], v[132:135], v[60:63]
    ds_read_b64_tr_b16 v[24:25], v16 offset:16384
    v_mfma_f32_16x16x32_bf16 v[64:67], v[28:31], v[128:131], v[64:67]
    ds_read_b64_tr_b16 v[26:27], v16 offset:20480
    buffer_load_dwordx4 v[172:175], v12, s[28:31], s48 offen offset:1024 sc1
    v_mfma_f32_16x16x32_bf16 v[68:71], v[28:31], v[132:135], v[68:71]
    s_cmp_ge_u32 s48, 5898240
    ds_read_b64_tr_b16 v[28:29], v17 offset:16384
    v_mfma_f32_16x16x32_bf16 v[72:75], v[32:35], v[128:131], v[72:75]
    s_cselect_b32 s62, 4289200128, s63
    ds_read_b64_tr_b16 v[30:31], v17 offset:20480
    v_mfma_f32_16x16x32_bf16 v[76:79], v[32:35], v[132:135], v[76:79]
    s_cmp_ge_u32 s48, 6160384
    ds_read_b64_tr_b16 v[32:33], v18 offset:16384
    v_mfma_f32_16x16x32_bf16 v[80:83], v[36:39], v[128:131], v[80:83]
    s_cselect_b32 s62, 131072, s62
    ds_read_b64_tr_b16 v[34:35], v18 offset:20480
    buffer_load_dwordx4 v3, s[12:15], s59 offen sc1 lds
    v_mfma_f32_16x16x32_bf16 v[84:87], v[36:39], v[132:135], v[84:87]
    s_waitcnt lgkmcnt(6)
    ds_read_b64_tr_b16 v[36:37], v19 offset:16384
    v_mfma_f32_16x16x32_bf16 v[88:91], v[40:43], v[128:131], v[88:91]
    s_add_u32 s48, s48, s62
    ds_read_b64_tr_b16 v[38:39], v19 offset:20480
    buffer_load_dwordx4 v3, s[12:15], s59 offen offset:1024 sc1 lds
    v_mfma_f32_16x16x32_bf16 v[92:95], v[40:43], v[132:135], v[92:95]
    s_cmp_ge_u32 s59, 368640
    ds_read_b64_tr_b16 v[40:41], v20 offset:16384
    v_mfma_f32_16x16x32_bf16 v[96:99], v[44:47], v[128:131], v[96:99]
    s_cselect_b32 s50, 4294606848, s51
    ds_read_b64_tr_b16 v[42:43], v20 offset:20480
    v_mfma_f32_16x16x32_bf16 v[100:103], v[44:47], v[132:135], v[100:103]
    s_cmp_ge_u32 s59, 385024
    ds_read_b64_tr_b16 v[44:45], v21 offset:16384
    v_mfma_f32_16x16x32_bf16 v[104:107], v[48:51], v[128:131], v[104:107]
    s_cselect_b32 s50, 8192, s50
    ds_read_b64_tr_b16 v[46:47], v21 offset:20480
    v_mfma_f32_16x16x32_bf16 v[108:111], v[48:51], v[132:135], v[108:111]
    s_add_u32 s59, s59, s50
    ds_read_b64_tr_b16 v[48:49], v22 offset:16384
    v_mfma_f32_16x16x32_bf16 v[112:115], v[52:55], v[128:131], v[112:115]
    s_add_u32 s58, s58, 8192
    s_and_b32 m0, s58, 0x1ffff
    ds_read_b64_tr_b16 v[50:51], v22 offset:20480
    v_mfma_f32_16x16x32_bf16 v[116:119], v[52:55], v[132:135], v[116:119]
    s_waitcnt vmcnt(11) lgkmcnt(6)
    ds_read_b64_tr_b16 v[52:53], v23 offset:16384
    v_mfma_f32_16x16x32_bf16 v[56:59], v[24:27], v[136:139], v[56:59]
    ds_read_b64_tr_b16 v[54:55], v23 offset:20480
    buffer_load_dwordx4 v[176:179], v12, s[28:31], s48 offen offset:0 sc1
    v_mfma_f32_16x16x32_bf16 v[60:63], v[24:27], v[140:143], v[60:63]
    ds_read_b64_tr_b16 v[24:25], v16 offset:24576
    v_mfma_f32_16x16x32_bf16 v[64:67], v[28:31], v[136:139], v[64:67]
    ds_read_b64_tr_b16 v[26:27], v16 offset:28672
    buffer_load_dwordx4 v[180:183], v12, s[28:31], s48 offen offset:1024 sc1
    v_mfma_f32_16x16x32_bf16 v[68:71], v[28:31], v[140:143], v[68:71]
    s_cmp_ge_u32 s48, 5898240
    ds_read_b64_tr_b16 v[28:29], v17 offset:24576
    v_mfma_f32_16x16x32_bf16 v[72:75], v[32:35], v[136:139], v[72:75]
    s_cselect_b32 s62, 4289200128, s63
    ds_read_b64_tr_b16 v[30:31], v17 offset:28672
    v_mfma_f32_16x16x32_bf16 v[76:79], v[32:35], v[140:143], v[76:79]
    s_cmp_ge_u32 s48, 6160384
    ds_read_b64_tr_b16 v[32:33], v18 offset:24576
    v_mfma_f32_16x16x32_bf16 v[80:83], v[36:39], v[136:139], v[80:83]
    s_cselect_b32 s62, 131072, s62
    ds_read_b64_tr_b16 v[34:35], v18 offset:28672
    buffer_load_dwordx4 v3, s[12:15], s59 offen sc1 lds
    v_mfma_f32_16x16x32_bf16 v[84:87], v[36:39], v[140:143], v[84:87]
    s_waitcnt lgkmcnt(6)
    ds_read_b64_tr_b16 v[36:37], v19 offset:24576
    v_mfma_f32_16x16x32_bf16 v[88:91], v[40:43], v[136:139], v[88:91]
    s_add_u32 s48, s48, s62
    ds_read_b64_tr_b16 v[38:39], v19 offset:28672
    buffer_load_dwordx4 v3, s[12:15], s59 offen offset:1024 sc1 lds
    v_mfma_f32_16x16x32_bf16 v[92:95], v[40:43], v[140:143], v[92:95]
    s_cmp_ge_u32 s59, 368640
    ds_read_b64_tr_b16 v[40:41], v20 offset:24576
    v_mfma_f32_16x16x32_bf16 v[96:99], v[44:47], v[136:139], v[96:99]
    s_cselect_b32 s50, 4294606848, s51
    ds_read_b64_tr_b16 v[42:43], v20 offset:28672
    v_mfma_f32_16x16x32_bf16 v[100:103], v[44:47], v[140:143], v[100:103]
    s_cmp_ge_u32 s59, 385024
    ds_read_b64_tr_b16 v[44:45], v21 offset:24576
    v_mfma_f32_16x16x32_bf16 v[104:107], v[48:51], v[136:139], v[104:107]
    s_cselect_b32 s50, 8192, s50
    ds_read_b64_tr_b16 v[46:47], v21 offset:28672
    v_mfma_f32_16x16x32_bf16 v[108:111], v[48:51], v[140:143], v[108:111]
    s_add_u32 s59, s59, s50
    ds_read_b64_tr_b16 v[48:49], v22 offset:24576
    v_mfma_f32_16x16x32_bf16 v[112:115], v[52:55], v[136:139], v[112:115]
    s_add_u32 s58, s58, 8192
    s_and_b32 m0, s58, 0x1ffff
    ds_read_b64_tr_b16 v[50:51], v22 offset:28672
    v_mfma_f32_16x16x32_bf16 v[116:119], v[52:55], v[140:143], v[116:119]
    s_waitcnt vmcnt(13) lgkmcnt(6)
    ds_read_b64_tr_b16 v[52:53], v23 offset:24576
    v_mfma_f32_16x16x32_bf16 v[56:59], v[24:27], v[144:147], v[56:59]
    ds_read_b64_tr_b16 v[54:55], v23 offset:28672
    buffer_load_dwordx4 v[120:123], v12, s[28:31], s48 offen offset:0 sc1
    s_barrier
    v_mfma_f32_16x16x32_bf16 v[60:63], v[24:27], v[148:151], v[60:63]
    ds_read_b64_tr_b16 v[24:25], v16 offset:32768
    v_mfma_f32_16x16x32_bf16 v[64:67], v[28:31], v[144:147], v[64:67]
    ds_read_b64_tr_b16 v[26:27], v16 offset:36864
    buffer_load_dwordx4 v[124:127], v12, s[28:31], s48 offen offset:1024 sc1
    v_mfma_f32_16x16x32_bf16 v[68:71], v[28:31], v[148:151], v[68:71]
    s_cmp_ge_u32 s48, 5898240
    ds_read_b64_tr_b16 v[28:29], v17 offset:32768
    v_mfma_f32_16x16x32_bf16 v[72:75], v[32:35], v[144:147], v[72:75]
    s_cselect_b32 s62, 4289200128, s63
    ds_read_b64_tr_b16 v[30:31], v17 offset:36864
    v_mfma_f32_16x16x32_bf16 v[76:79], v[32:35], v[148:151], v[76:79]
    s_cmp_ge_u32 s48, 6160384
    ds_read_b64_tr_b16 v[32:33], v18 offset:32768
    v_mfma_f32_16x16x32_bf16 v[80:83], v[36:39], v[144:147], v[80:83]
    s_cselect_b32 s62, 131072, s62
    ds_read_b64_tr_b16 v[34:35], v18 offset:36864
    buffer_load_dwordx4 v3, s[12:15], s59 offen sc1 lds
    v_mfma_f32_16x16x32_bf16 v[84:87], v[36:39], v[148:151], v[84:87]
    s_waitcnt lgkmcnt(6)
    ds_read_b64_tr_b16 v[36:37], v19 offset:32768
    v_mfma_f32_16x16x32_bf16 v[88:91], v[40:43], v[144:147], v[88:91]
    s_add_u32 s48, s48, s62
    ds_read_b64_tr_b16 v[38:39], v19 offset:36864
    buffer_load_dwordx4 v3, s[12:15], s59 offen offset:1024 sc1 lds
    v_mfma_f32_16x16x32_bf16 v[92:95], v[40:43], v[148:151], v[92:95]
    s_cmp_ge_u32 s59, 368640
    ds_read_b64_tr_b16 v[40:41], v20 offset:32768
    v_mfma_f32_16x16x32_bf16 v[96:99], v[44:47], v[144:147], v[96:99]
    s_cselect_b32 s50, 4294606848, s51
    ds_read_b64_tr_b16 v[42:43], v20 offset:36864
    v_mfma_f32_16x16x32_bf16 v[100:103], v[44:47], v[148:151], v[100:103]
    s_cmp_ge_u32 s59, 385024
    ds_read_b64_tr_b16 v[44:45], v21 offset:32768
    v_mfma_f32_16x16x32_bf16 v[104:107], v[48:51], v[144:147], v[104:107]
    s_cselect_b32 s50, 8192, s50
    ds_read_b64_tr_b16 v[46:47], v21 offset:36864
    buffer_load_dword v11, v10, s[24:27], s53 offen sc1
    v_mfma_f32_16x16x32_bf16 v[108:111], v[48:51], v[148:151], v[108:111]
    s_add_u32 s59, s59, s50
    ds_read_b64_tr_b16 v[48:49], v22 offset:32768
    v_mfma_f32_16x16x32_bf16 v[112:115], v[52:55], v[144:147], v[112:115]
    s_add_u32 s58, s58, 8192
    s_and_b32 m0, s58, 0x1ffff
    ds_read_b64_tr_b16 v[50:51], v22 offset:36864
    v_mfma_f32_16x16x32_bf16 v[116:119], v[52:55], v[148:151], v[116:119]
    s_waitcnt vmcnt(16) lgkmcnt(6)
    ds_read_b64_tr_b16 v[52:53], v23 offset:32768
    v_mfma_f32_16x16x32_bf16 v[56:59], v[24:27], v[152:155], v[56:59]
    ds_read_b64_tr_b16 v[54:55], v23 offset:36864
    buffer_load_dwordx4 v[128:131], v12, s[28:31], s48 offen offset:0 sc1
    v_mfma_f32_16x16x32_bf16 v[60:63], v[24:27], v[156:159], v[60:63]
    ds_read_b64_tr_b16 v[24:25], v16 offset:40960
    v_mfma_f32_16x16x32_bf16 v[64:67], v[28:31], v[152:155], v[64:67]
    ds_read_b64_tr_b16 v[26:27], v16 offset:45056
    buffer_load_dwordx4 v[132:135], v12, s[28:31], s48 offen offset:1024 sc1
    v_mfma_f32_16x16x32_bf16 v[68:71], v[28:31], v[156:159], v[68:71]
    s_cmp_ge_u32 s48, 5898240
    ds_read_b64_tr_b16 v[28:29], v17 offset:40960
    v_mfma_f32_16x16x32_bf16 v[72:75], v[32:35], v[152:155], v[72:75]
    s_cselect_b32 s62, 4289200128, s63
    ds_read_b64_tr_b16 v[30:31], v17 offset:45056
    v_mfma_f32_16x16x32_bf16 v[76:79], v[32:35], v[156:159], v[76:79]
    s_cmp_ge_u32 s48, 6160384
    ds_read_b64_tr_b16 v[32:33], v18 offset:40960
    v_mfma_f32_16x16x32_bf16 v[80:83], v[36:39], v[152:155], v[80:83]
    s_cselect_b32 s62, 131072, s62
    ds_read_b64_tr_b16 v[34:35], v18 offset:45056
    buffer_load_dwordx4 v3, s[12:15], s59 offen sc1 lds
    v_mfma_f32_16x16x32_bf16 v[84:87], v[36:39], v[156:159], v[84:87]
    s_waitcnt lgkmcnt(6)
    ds_read_b64_tr_b16 v[36:37], v19 offset:40960
    v_mfma_f32_16x16x32_bf16 v[88:91], v[40:43], v[152:155], v[88:91]
    s_add_u32 s48, s48, s62
    ds_read_b64_tr_b16 v[38:39], v19 offset:45056
    buffer_load_dwordx4 v3, s[12:15], s59 offen offset:1024 sc1 lds
    v_mfma_f32_16x16x32_bf16 v[92:95], v[40:43], v[156:159], v[92:95]
    s_cmp_ge_u32 s59, 368640
    ds_read_b64_tr_b16 v[40:41], v20 offset:40960
    v_mfma_f32_16x16x32_bf16 v[96:99], v[44:47], v[152:155], v[96:99]
    s_cselect_b32 s50, 4294606848, s51
    ds_read_b64_tr_b16 v[42:43], v20 offset:45056
    v_mfma_f32_16x16x32_bf16 v[100:103], v[44:47], v[156:159], v[100:103]
    s_cmp_ge_u32 s59, 385024
    ds_read_b64_tr_b16 v[44:45], v21 offset:40960
    v_mfma_f32_16x16x32_bf16 v[104:107], v[48:51], v[152:155], v[104:107]
    s_cselect_b32 s50, 8192, s50
    ds_read_b64_tr_b16 v[46:47], v21 offset:45056
    v_mfma_f32_16x16x32_bf16 v[108:111], v[48:51], v[156:159], v[108:111]
    s_add_u32 s59, s59, s50
    ds_read_b64_tr_b16 v[48:49], v22 offset:40960
    v_mfma_f32_16x16x32_bf16 v[112:115], v[52:55], v[152:155], v[112:115]
    s_add_u32 s58, s58, 8192
    s_and_b32 m0, s58, 0x1ffff
    ds_read_b64_tr_b16 v[50:51], v22 offset:45056
    v_mfma_f32_16x16x32_bf16 v[116:119], v[52:55], v[156:159], v[116:119]
    s_waitcnt vmcnt(17) lgkmcnt(6)
    ds_read_b64_tr_b16 v[52:53], v23 offset:40960
    v_mfma_f32_16x16x32_bf16 v[56:59], v[24:27], v[160:163], v[56:59]
    ds_read_b64_tr_b16 v[54:55], v23 offset:45056
    buffer_load_dwordx4 v[136:139], v12, s[28:31], s48 offen offset:0 sc1
    s_barrier
    v_mfma_f32_16x16x32_bf16 v[60:63], v[24:27], v[164:167], v[60:63]
    ds_read_b64_tr_b16 v[24:25], v16 offset:49152
    v_mfma_f32_16x16x32_bf16 v[64:67], v[28:31], v[160:163], v[64:67]
    ds_read_b64_tr_b16 v[26:27], v16 offset:53248
    buffer_load_dwordx4 v[140:143], v12, s[28:31], s48 offen offset:1024 sc1
    v_mfma_f32_16x16x32_bf16 v[68:71], v[28:31], v[164:167], v[68:71]
    s_cmp_ge_u32 s48, 5898240
    ds_read_b64_tr_b16 v[28:29], v17 offset:49152
    v_mfma_f32_16x16x32_bf16 v[72:75], v[32:35], v[160:163], v[72:75]
    s_cselect_b32 s62, 4289200128, s63
    ds_read_b64_tr_b16 v[30:31], v17 offset:53248
    v_mfma_f32_16x16x32_bf16 v[76:79], v[32:35], v[164:167], v[76:79]
    s_cmp_ge_u32 s48, 6160384
    ds_read_b64_tr_b16 v[32:33], v18 offset:49152
    v_mfma_f32_16x16x32_bf16 v[80:83], v[36:39], v[160:163], v[80:83]
    s_cselect_b32 s62, 131072, s62
    ds_read_b64_tr_b16 v[34:35], v18 offset:53248
    buffer_load_dwordx4 v3, s[12:15], s59 offen sc1 lds
    v_mfma_f32_16x16x32_bf16 v[84:87], v[36:39], v[164:167], v[84:87]
    s_waitcnt lgkmcnt(6)
    ds_read_b64_tr_b16 v[36:37], v19 offset:49152
    v_mfma_f32_16x16x32_bf16 v[88:91], v[40:43], v[160:163], v[88:91]
    s_add_u32 s48, s48, s62
    ds_read_b64_tr_b16 v[38:39], v19 offset:53248
    buffer_load_dwordx4 v3, s[12:15], s59 offen offset:1024 sc1 lds
    v_mfma_f32_16x16x32_bf16 v[92:95], v[40:43], v[164:167], v[92:95]
    s_cmp_ge_u32 s59, 368640
    ds_read_b64_tr_b16 v[40:41], v20 offset:49152
    v_mfma_f32_16x16x32_bf16 v[96:99], v[44:47], v[160:163], v[96:99]
    s_cselect_b32 s50, 4294606848, s51
    ds_read_b64_tr_b16 v[42:43], v20 offset:53248
    v_mfma_f32_16x16x32_bf16 v[100:103], v[44:47], v[164:167], v[100:103]
    s_cmp_ge_u32 s59, 385024
    ds_read_b64_tr_b16 v[44:45], v21 offset:49152
    v_mfma_f32_16x16x32_bf16 v[104:107], v[48:51], v[160:163], v[104:107]
    s_cselect_b32 s50, 8192, s50
    ds_read_b64_tr_b16 v[46:47], v21 offset:53248
    v_mfma_f32_16x16x32_bf16 v[108:111], v[48:51], v[164:167], v[108:111]
    s_add_u32 s59, s59, s50
    ds_read_b64_tr_b16 v[48:49], v22 offset:49152
    v_mfma_f32_16x16x32_bf16 v[112:115], v[52:55], v[160:163], v[112:115]
    s_add_u32 s58, s58, 8192
    s_and_b32 m0, s58, 0x1ffff
    ds_read_b64_tr_b16 v[50:51], v22 offset:53248
    v_mfma_f32_16x16x32_bf16 v[116:119], v[52:55], v[164:167], v[116:119]
    s_waitcnt vmcnt(19) lgkmcnt(6)
    ds_read_b64_tr_b16 v[52:53], v23 offset:49152
    v_mfma_f32_16x16x32_bf16 v[56:59], v[24:27], v[168:171], v[56:59]
    ds_read_b64_tr_b16 v[54:55], v23 offset:53248
    buffer_load_dwordx4 v[144:147], v12, s[28:31], s48 offen offset:0 sc1
    v_mfma_f32_16x16x32_bf16 v[60:63], v[24:27], v[172:175], v[60:63]
    ds_read_b64_tr_b16 v[24:25], v16 offset:57344
    v_mfma_f32_16x16x32_bf16 v[64:67], v[28:31], v[168:171], v[64:67]
    ds_read_b64_tr_b16 v[26:27], v16 offset:61440
    buffer_load_dwordx4 v[148:151], v12, s[28:31], s48 offen offset:1024 sc1
    v_mfma_f32_16x16x32_bf16 v[68:71], v[28:31], v[172:175], v[68:71]
    s_cmp_ge_u32 s48, 5898240
    ds_read_b64_tr_b16 v[28:29], v17 offset:57344
    v_mfma_f32_16x16x32_bf16 v[72:75], v[32:35], v[168:171], v[72:75]
    s_cselect_b32 s62, 4289200128, s63
    ds_read_b64_tr_b16 v[30:31], v17 offset:61440
    v_mfma_f32_16x16x32_bf16 v[76:79], v[32:35], v[172:175], v[76:79]
    s_cmp_ge_u32 s48, 6160384
    ds_read_b64_tr_b16 v[32:33], v18 offset:57344
    v_mfma_f32_16x16x32_bf16 v[80:83], v[36:39], v[168:171], v[80:83]
    s_cselect_b32 s62, 131072, s62
    ds_read_b64_tr_b16 v[34:35], v18 offset:61440
    buffer_load_dwordx4 v3, s[12:15], s59 offen sc1 lds
    v_mfma_f32_16x16x32_bf16 v[84:87], v[36:39], v[172:175], v[84:87]
    s_waitcnt lgkmcnt(6)
    ds_read_b64_tr_b16 v[36:37], v19 offset:57344
    v_mfma_f32_16x16x32_bf16 v[88:91], v[40:43], v[168:171], v[88:91]
    s_add_u32 s48, s48, s62
    ds_read_b64_tr_b16 v[38:39], v19 offset:61440
    buffer_load_dwordx4 v3, s[12:15], s59 offen offset:1024 sc1 lds
    v_mfma_f32_16x16x32_bf16 v[92:95], v[40:43], v[172:175], v[92:95]
    s_cmp_ge_u32 s59, 368640
    ds_read_b64_tr_b16 v[40:41], v20 offset:57344
    v_mfma_f32_16x16x32_bf16 v[96:99], v[44:47], v[168:171], v[96:99]
    s_cselect_b32 s50, 4294606848, s51
    ds_read_b64_tr_b16 v[42:43], v20 offset:61440
    v_mfma_f32_16x16x32_bf16 v[100:103], v[44:47], v[172:175], v[100:103]
    s_cmp_ge_u32 s59, 385024
    ds_read_b64_tr_b16 v[44:45], v21 offset:57344
    v_mfma_f32_16x16x32_bf16 v[104:107], v[48:51], v[168:171], v[104:107]
    s_cselect_b32 s50, 8192, s50
    ds_read_b64_tr_b16 v[46:47], v21 offset:61440
    v_mfma_f32_16x16x32_bf16 v[108:111], v[48:51], v[172:175], v[108:111]
    s_add_u32 s59, s59, s50
    ds_read_b64_tr_b16 v[48:49], v22 offset:57344
    v_mfma_f32_16x16x32_bf16 v[112:115], v[52:55], v[168:171], v[112:115]
    s_add_u32 s58, s58, 8192
    s_and_b32 m0, s58, 0x1ffff
    ds_read_b64_tr_b16 v[50:51], v22 offset:61440
    v_mfma_f32_16x16x32_bf16 v[116:119], v[52:55], v[172:175], v[116:119]
    s_waitcnt vmcnt(19) lgkmcnt(6)
    ds_read_b64_tr_b16 v[52:53], v23 offset:57344
    v_mfma_f32_16x16x32_bf16 v[56:59], v[24:27], v[176:179], v[56:59]
    ds_read_b64_tr_b16 v[54:55], v23 offset:61440
    buffer_load_dwordx4 v[152:155], v12, s[28:31], s48 offen offset:0 sc1
    s_barrier
    v_xor_b32 v16, 0x10000, v16
    v_mfma_f32_16x16x32_bf16 v[60:63], v[24:27], v[180:183], v[60:63]
    ds_read_b64_tr_b16 v[24:25], v16 offset:0
    v_mfma_f32_16x16x32_bf16 v[64:67], v[28:31], v[176:179], v[64:67]
    ds_read_b64_tr_b16 v[26:27], v16 offset:4096
    buffer_load_dwordx4 v[156:159], v12, s[28:31], s48 offen offset:1024 sc1
    v_xor_b32 v17, 0x10000, v17
    v_mfma_f32_16x16x32_bf16 v[68:71], v[28:31], v[180:183], v[68:71]
    s_cmp_ge_u32 s48, 5898240
    ds_read_b64_tr_b16 v[28:29], v17 offset:0
    v_mfma_f32_16x16x32_bf16 v[72:75], v[32:35], v[176:179], v[72:75]
    s_cselect_b32 s62, 4289200128, s63
    ds_read_b64_tr_b16 v[30:31], v17 offset:4096
    v_xor_b32 v18, 0x10000, v18
    v_mfma_f32_16x16x32_bf16 v[76:79], v[32:35], v[180:183], v[76:79]
    s_cmp_ge_u32 s48, 6160384
    ds_read_b64_tr_b16 v[32:33], v18 offset:0
    v_mfma_f32_16x16x32_bf16 v[80:83], v[36:39], v[176:179], v[80:83]
    s_cselect_b32 s62, 131072, s62
    ds_read_b64_tr_b16 v[34:35], v18 offset:4096
    buffer_load_dwordx4 v3, s[12:15], s59 offen sc1 lds
    v_xor_b32 v19, 0x10000, v19
    v_mfma_f32_16x16x32_bf16 v[84:87], v[36:39], v[180:183], v[84:87]
    s_waitcnt lgkmcnt(6)
    ds_read_b64_tr_b16 v[36:37], v19 offset:0
    v_mfma_f32_16x16x32_bf16 v[88:91], v[40:43], v[176:179], v[88:91]
    s_add_u32 s48, s48, s62
    ds_read_b64_tr_b16 v[38:39], v19 offset:4096
    buffer_load_dwordx4 v3, s[12:15], s59 offen offset:1024 sc1 lds
    v_xor_b32 v20, 0x10000, v20
    v_mfma_f32_16x16x32_bf16 v[92:95], v[40:43], v[180:183], v[92:95]
    s_cmp_ge_u32 s59, 368640
    ds_read_b64_tr_b16 v[40:41], v20 offset:0
    v_mfma_f32_16x16x32_bf16 v[96:99], v[44:47], v[176:179], v[96:99]
    s_cselect_b32 s50, 4294606848, s51
    ds_read_b64_tr_b16 v[42:43], v20 offset:4096
    v_xor_b32 v21, 0x10000, v21
    v_mfma_f32_16x16x32_bf16 v[100:103], v[44:47], v[180:183], v[100:103]
    s_cmp_ge_u32 s59, 385024
    ds_read_b64_tr_b16 v[44:45], v21 offset:0
    v_mfma_f32_16x16x32_bf16 v[104:107], v[48:51], v[176:179], v[104:107]
    s_cselect_b32 s50, 8192, s50
    ds_read_b64_tr_b16 v[46:47], v21 offset:4096
    v_xor_b32 v22, 0x10000, v22
    v_mfma_f32_16x16x32_bf16 v[108:111], v[48:51], v[180:183], v[108:111]
    s_add_u32 s59, s59, s50
    ds_read_b64_tr_b16 v[48:49], v22 offset:0
    v_mfma_f32_16x16x32_bf16 v[112:115], v[52:55], v[176:179], v[112:115]
    s_add_u32 s58, s58, 8192
    s_and_b32 m0, s58, 0x1ffff
    ds_read_b64_tr_b16 v[50:51], v22 offset:4096
    v_xor_b32 v23, 0x10000, v23
    v_mfma_f32_16x16x32_bf16 v[116:119], v[52:55], v[180:183], v[116:119]
    s_waitcnt vmcnt(16) lgkmcnt(6)
    ds_read_b64_tr_b16 v[52:53], v23 offset:0
    v_cmp_eq_u32 vcc, 0, v11
    s_mov_b32 s55, 5
    s_cmp_eq_u64 vcc, 0
    s_cbranch_scc1 K6_LOOP
    s_mov_b32 s60, 0x200000
POLL_HB:
    buffer_load_dword v11, v10, s[24:27], s53 offen sc1
    s_sub_u32 s60, s60, 1
    s_waitcnt vmcnt(0)
    v_cmp_eq_u32 vcc, 0, v11
    s_cmp_eq_u32 s60, 0
    s_cbranch_scc1 POLLX_HB
    s_cmp_eq_u64 vcc, 0
    s_cbranch_scc1 POLLX_HB
    s_sleep 4
    s_branch POLL_HB
POLLX_HB:
    .p2align 6
K6_LOOP:
    v_mfma_f32_16x16x32_bf16 v[56:59], v[24:27], v[120:123], v[56:59]
    ds_read_b64_tr_b16 v[54:55], v23 offset:4096
    buffer_load_dwordx4 v[160:163], v12, s[28:31], s48 offen offset:0 sc1
    v_mfma_f32_16x16x32_bf16 v[60:63], v[24:27], v[124:127], v[60:63]
    ds_read_b64_tr_b16 v[24:25], v16 offset:8192
    v_mfma_f32_16x16x32_bf16 v[64:67], v[28:31], v[120:123], v[64:67]
    ds_read_b64_tr_b16 v[26:27], v16 offset:12288
    buffer_load_dwordx4 v[164:167], v12, s[28:31], s48 offen offset:1024 sc1
    v_mfma_f32_16x16x32_bf16 v[68:71], v[28:31], v[124:127], v[68:71]
    s_cmp_ge_u32 s48, 5898240
    ds_read_b64_tr_b16 v[28:29], v17 offset:8192
    v_mfma_f32_16x16x32_bf16 v[72:75], v[32:35], v[120:123], v[72:75]
    s_cselect_b32 s62, 4289200128, s63
    ds_read_b64_tr_b16 v[30:31], v17 offset:12288
    v_mfma_f32_16x16x32_bf16 v[76:79], v[32:35], v[124:127], v[76:79]
    s_cmp_ge_u32 s48, 6160384
    ds_read_b64_tr_b16 v[32:33], v18 offset:8192
    v_mfma_f32_16x16x32_bf16 v[80:83], v[36:39], v[120:123], v[80:83]
    s_cselect_b32 s62, 131072, s62
    ds_read_b64_tr_b16 v[34:35], v18 offset:12288
    v_mfma_f32_16x16x32_bf16 v[84:87], v[36:39], v[124:127], v[84:87]
    s_waitcnt lgkmcnt(6)
    ds_read_b64_tr_b16 v[36:37], v19 offset:8192
    v_mfma_f32_16x16x32_bf16 v[88:91], v[40:43], v[120:123], v[88:91]
    s_add_u32 s48, s48, s62
    ds_read_b64_tr_b16 v[38:39], v19 offset:12288
    v_mfma_f32_16x16x32_bf16 v[92:95], v[40:43], v[124:127], v[92:95]
    ds_read_b64_tr_b16 v[40:41], v20 offset:8192
    v_mfma_f32_16x16x32_bf16 v[96:99], v[44:47], v[120:123], v[96:99]
    ds_read_b64_tr_b16 v[42:43], v20 offset:12288
    v_mfma_f32_16x16x32_bf16 v[100:103], v[44:47], v[124:127], v[100:103]
    ds_read_b64_tr_b16 v[44:45], v21 offset:8192
    v_mfma_f32_16x16x32_bf16 v[104:107], v[48:51], v[120:123], v[104:107]
    ds_read_b64_tr_b16 v[46:47], v21 offset:12288
    v_mfma_f32_16x16x32_bf16 v[108:111], v[48:51], v[124:127], v[108:111]
    ds_read_b64_tr_b16 v[48:49], v22 offset:8192
    v_mfma_f32_16x16x32_bf16 v[112:115], v[52:55], v[120:123], v[112:115]
    ds_read_b64_tr_b16 v[50:51], v22 offset:12288
    v_mfma_f32_16x16x32_bf16 v[116:119], v[52:55], v[124:127], v[116:119]
    s_waitcnt vmcnt(16) lgkmcnt(6)
    ds_read_b64_tr_b16 v[52:53], v23 offset:8192
    v_mfma_f32_16x16x32_bf16 v[56:59], v[24:27], v[128:131], v[56:59]
    ds_read_b64_tr_b16 v[54:55], v23 offset:12288
    buffer_load_dwordx4 v[168:171], v12, s[28:31], s48 offen offset:0 sc1
    s_barrier
    v_mfma_f32_16x16x32_bf16 v[60:63], v[24:27], v[132:135], v[60:63]
    ds_read_b64_tr_b16 v[24:25], v16 offset:16384
    v_mfma_f32_16x16x32_bf16 v[64:67], v[28:31], v[128:131], v[64:67]
    ds_read_b64_tr_b16 v[26:27], v16 offset:20480
    buffer_load_dwordx4 v[172:175], v12, s[28:31], s48 offen offset:1024 sc1
    v_mfma_f32_16x16x32_bf16 v[68:71], v[28:31], v[132:135], v[68:71]
    s_cmp_ge_u32 s48, 5898240
    ds_read_b64_tr_b16 v[28:29], v17 offset:16384
    v_mfma_f32_16x16x32_bf16 v[72:75], v[32:35], v[128:131], v[72:75]
    s_cselect_b32 s62, 4289200128, s63
    ds_read_b64_tr_b16 v[30:31], v17 offset:20480
    v_mfma_f32_16x16x32_bf16 v[76:79], v[32:35], v[132:135], v[76:79]
    s_cmp_ge_u32 s48, 6160384
    ds_read_b64_tr_b16 v[32:33], v18 offset:16384
    v_mfma_f32_16x16x32_bf16 v[80:83], v[36:39], v[128:131], v[80:83]
    s_cselect_b32 s62, 131072, s62
    ds_read_b64_tr_b16 v[34:35], v18 offset:20480
    buffer_load_dwordx4 v3, s[12:15], s59 offen sc1 lds
    v_mfma_f32_16x16x32_bf16 v[84:87], v[36:39], v[132:135], v[84:87]
    s_waitcnt lgkmcnt(6)
    ds_read_b64_tr_b16 v[36:37], v19 offset:16384
    v_mfma_f32_16x16x32_bf16 v[88:91], v[40:43], v[128:131], v[88:91]
    s_add_u32 s48, s48, s62
    ds_read_b64_tr_b16 v[38:39], v19 offset:20480
    buffer_load_dwordx4 v3, s[12:15], s59 offen offset:1024 sc1 lds
    v_mfma_f32_16x16x32_bf16 v[92:95], v[40:43], v[132:135], v[92:95]
    s_cmp_ge_u32 s59, 368640
    ds_read_b64_tr_b16 v[40:41], v20 offset:16384
    v_mfma_f32_16x16x32_bf16 v[96:99], v[44:47], v[128:131], v[96:99]
    s_cselect_b32 s50, 4294606848, s51
    ds_read_b64_tr_b16 v[42:43], v20 offset:20480
    v_mfma_f32_16x16x32_bf16 v[100:103], v[44:47], v[132:135], v[100:103]
    s_cmp_ge_u32 s59, 385024
    ds_read_b64_tr_b16 v[44:45], v21 offset:16384
    v_mfma_f32_16x16x32_bf16 v[104:107], v[48:51], v[128:131], v[104:107]
    s_cselect_b32 s50, 8192, s50
    ds_read_b64_tr_b16 v[46:47], v21 offset:20480
    v_mfma_f32_16x16x32_bf16 v[108:111], v[48:51], v[132:135], v[108:111]
    s_add_u32 s59, s59, s50
    ds_read_b64_tr_b16 v[48:49], v22 offset:16384
    v_mfma_f32_16x16x32_bf16 v[112:115], v[52:55], v[128:131], v[112:115]
    s_add_u32 s58, s58, 8192
    s_and_b32 m0, s58, 0x1ffff
    ds_read_b64_tr_b16 v[50:51], v22 offset:20480
    v_mfma_f32_16x16x32_bf16 v[116:119], v[52:55], v[132:135], v[116:119]
    s_waitcnt vmcnt(16) lgkmcnt(6)
    ds_read_b64_tr_b16 v[52:53], v23 offset:16384
    v_mfma_f32_16x16x32_bf16 v[56:59], v[24:27], v[136:139], v[56:59]
    ds_read_b64_tr_b16 v[54:55], v23 offset:20480
    buffer_load_dwordx4 v[176:179], v12, s[28:31], s48 offen offset:0 sc1
    v_mfma_f32_16x16x32_bf16 v[60:63], v[24:27], v[140:143], v[60:63]
    ds_read_b64_tr_b16 v[24:25], v16 offset:24576
    v_mfma_f32_16x16x32_bf16 v[64:67], v[28:31], v[136:139], v[64:67]
    ds_read_b64_tr_b16 v[26:27], v16 offset:28672
    buffer_load_dwordx4 v[180:183], v12, s[28:31], s48 offen offset:1024 sc1
    v_mfma_f32_16x16x32_bf16 v[68:71], v[28:31], v[140:143], v[68:71]
    s_cmp_ge_u32 s48, 5898240
    ds_read_b64_tr_b16 v[28:29], v17 offset:24576
    v_mfma_f32_16x16x32_bf16 v[72:75], v[32:35], v[136:139], v[72:75]
    s_cselect_b32 s62, 4289200128, s63
    ds_read_b64_tr_b16 v[30:31], v17 offset:28672
    v_mfma_f32_16x16x32_bf16 v[76:79], v[32:35], v[140:143], v[76:79]
    s_cmp_ge_u32 s48, 6160384
    ds_read_b64_tr_b16 v[32:33], v18 offset:24576
    v_mfma_f32_16x16x32_bf16 v[80:83], v[36:39], v[136:139], v[80:83]
    s_cselect_b32 s62, 131072, s62
    ds_read_b64_tr_b16 v[34:35], v18 offset:28672
    buffer_load_dwordx4 v3, s[12:15], s59 offen sc1 lds
    v_mfma_f32_16x16x32_bf16 v[84:87], v[36:39], v[140:143], v[84:87]
    s_waitcnt lgkmcnt(6)
    ds_read_b64_tr_b16 v[36:37], v19 offset:24576
    v_mfma_f32_16x16x32_bf16 v[88:91], v[40:43], v[136:139], v[88:91]
    s_add_u32 s48, s48, s62
    ds_read_b64_tr_b16 v[38:39], v19 offset:28672
    buffer_load_dwordx4 v3, s[12:15], s59 offen offset:1024 sc1 lds
    v_mfma_f32_16x16x32_bf16 v[92:95], v[40:43], v[140:143], v[92:95]
    s_cmp_ge_u32 s59, 368640
    ds_read_b64_tr_b16 v[40:41], v20 offset:24576
    v_mfma_f32_16x16x32_bf16 v[96:99], v[44:47], v[136:139], v[96:99]
    s_cselect_b32 s50, 4294606848, s51
    ds_read_b64_tr_b16 v[42:43], v20 offset:28672
    v_mfma_f32_16x16x32_bf16 v[100:103], v[44:47], v[140:143], v[100:103]
    s_cmp_ge_u32 s59, 385024
    ds_read_b64_tr_b16 v[44:45], v21 offset:24576
    v_mfma_f32_16x16x32_bf16 v[104:107], v[48:51], v[136:139], v[104:107]
    s_cselect_b32 s50, 8192, s50
    ds_read_b64_tr_b16 v[46:47], v21 offset:28672
    v_mfma_f32_16x16x32_bf16 v[108:111], v[48:51], v[140:143], v[108:111]
    s_add_u32 s59, s59, s50
    ds_read_b64_tr_b16 v[48:49], v22 offset:24576
    v_mfma_f32_16x16x32_bf16 v[112:115], v[52:55], v[136:139], v[112:115]
    s_add_u32 s58, s58, 8192
    s_and_b32 m0, s58, 0x1ffff
    ds_read_b64_tr_b16 v[50:51], v22 offset:28672
    v_mfma_f32_16x16x32_bf16 v[116:119], v[52:55], v[140:143], v[116:119]
    s_waitcnt vmcnt(16) lgkmcnt(6)
    ds_read_b64_tr_b16 v[52:53], v23 offset:24576
    v_mfma_f32_16x16x32_bf16 v[56:59], v[24:27], v[144:147], v[56:59]
    ds_read_b64_tr_b16 v[54:55], v23 offset:28672
    buffer_load_dwordx4 v[120:123], v12, s[28:31], s48 offen offset:0 sc1
    s_barrier
    v_mfma_f32_16x16x32_bf16 v[60:63], v[24:27], v[148:151], v[60:63]
    ds_read_b64_tr_b16 v[24:25], v16 offset:32768
    v_mfma_f32_16x16x32_bf16 v[64:67], v[28:31], v[144:147], v[64:67]
    ds_read_b64_tr_b16 v[26:27], v16 offset:36864
    buffer_load_dwordx4 v[124:127], v12, s[28:31], s48 offen offset:1024 sc1
    v_mfma_f32_16x16x32_bf16 v[68:71], v[28:31], v[148:151], v[68:71]
    s_cmp_ge_u32 s48, 5898240
    ds_read_b64_tr_b16 v[28:29], v17 offset:32768
    v_mfma_f32_16x16x32_bf16 v[72:75], v[32:35], v[144:147], v[72:75]
    s_cselect_b32 s62, 4289200128, s63
    ds_read_b64_tr_b16 v[30:31], v17 offset:36864
    v_mfma_f32_16x16x32_bf16 v[76:79], v[32:35], v[148:151], v[76:79]
    s_cmp_ge_u32 s48, 6160384
    ds_read_b64_tr_b16 v[32:33], v18 offset:32768
    v_mfma_f32_16x16x32_bf16 v[80:83], v[36:39], v[144:147], v[80:83]
    s_cselect_b32 s62, 131072, s62
    ds_read_b64_tr_b16 v[34:35], v18 offset:36864
    buffer_load_dwordx4 v3, s[12:15], s59 offen sc1 lds
    v_mfma_f32_16x16x32_bf16 v[84:87], v[36:39], v[148:151], v[84:87]
    s_waitcnt lgkmcnt(6)
    ds_read_b64_tr_b16 v[36:37], v19 offset:32768
    v_mfma_f32_16x16x32_bf16 v[88:91], v[40:43], v[144:147], v[88:91]
    s_add_u32 s48, s48, s62
    ds_read_b64_tr_b16 v[38:39], v19 offset:36864
    buffer_load_dwordx4 v3, s[12:15], s59 offen offset:1024 sc1 lds
    v_mfma_f32_16x16x32_bf16 v[92:95], v[40:43], v[148:151], v[92:95]
    s_cmp_ge_u32 s59, 368640
    ds_read_b64_tr_b16 v[40:41], v20 offset:32768
    v_mfma_f32_16x16x32_bf16 v[96:99], v[44:47], v[144:147], v[96:99]
    s_cselect_b32 s50, 4294606848, s51
    ds_read_b64_tr_b16 v[42:43], v20 offset:36864
    v_mfma_f32_16x16x32_bf16 v[100:103], v[44:47], v[148:151], v[100:103]
    s_cmp_ge_u32 s59, 385024
    ds_read_b64_tr_b16 v[44:45], v21 offset:32768
    v_mfma_f32_16x16x32_bf16 v[104:107], v[48:51], v[144:147], v[104:107]
    s_cselect_b32 s50, 8192, s50
    ds_read_b64_tr_b16 v[46:47], v21 offset:36864
    v_mfma_f32_16x16x32_bf16 v[108:111], v[48:51], v[148:151], v[108:111]
    s_add_u32 s59, s59, s50
    ds_read_b64_tr_b16 v[48:49], v22 offset:32768
    v_mfma_f32_16x16x32_bf16 v[112:115], v[52:55], v[144:147], v[112:115]
    s_add_u32 s58, s58, 8192
    s_and_b32 m0, s58, 0x1ffff
    ds_read_b64_tr_b16 v[50:51], v22 offset:36864
    v_mfma_f32_16x16x32_bf16 v[116:119], v[52:55], v[148:151], v[116:119]
    s_waitcnt vmcnt(16) lgkmcnt(6)
    ds_read_b64_tr_b16 v[52:53], v23 offset:32768
    v_mfma_f32_16x16x32_bf16 v[56:59], v[24:27], v[152:155], v[56:59]
    ds_read_b64_tr_b16 v[54:55], v23 offset:36864
    buffer_load_dwordx4 v[128:131], v12, s[28:31], s48 offen offset:0 sc1
    v_mfma_f32_16x16x32_bf16 v[60:63], v[24:27], v[156:159], v[60:63]
    ds_read_b64_tr_b16 v[24:25], v16 offset:40960
    v_mfma_f32_16x16x32_bf16 v[64:67], v[28:31], v[152:155], v[64:67]
    ds_read_b64_tr_b16 v[26:27], v16 offset:45056
    buffer_load_dwordx4 v[132:135], v12, s[28:31], s48 offen offset:1024 sc1
    v_mfma_f32_16x16x32_bf16 v[68:71], v[28:31], v[156:159], v[68:71]
    s_cmp_ge_u32 s48, 5898240
    ds_read_b64_tr_b16 v[28:29], v17 offset:40960
    v_mfma_f32_16x16x32_bf16 v[72:75], v[32:35], v[152:155], v[72:75]
    s_cselect_b32 s62, 4289200128, s63
    ds_read_b64_tr_b16 v[30:31], v17 offset:45056
    v_mfma_f32_16x16x32_bf16 v[76:79], v[32:35], v[156:159], v[76:79]
    s_cmp_ge_u32 s48, 6160384
    ds_read_b64_tr_b16 v[32:33], v18 offset:40960
    v_mfma_f32_16x16x32_bf16 v[80:83], v[36:39], v[152:155], v[80:83]
    s_cselect_b32 s62, 131072, s62
    ds_read_b64_tr_b16 v[34:35], v18 offset:45056
    buffer_load_dwordx4 v3, s[12:15], s59 offen sc1 lds
    v_mfma_f32_16x16x32_bf16 v[84:87], v[36:39], v[156:159], v[84:87]
    s_waitcnt lgkmcnt(6)
    ds_read_b64_tr_b16 v[36:37], v19 offset:40960
    v_mfma_f32_16x16x32_bf16 v[88:91], v[40:43], v[152:155], v[88:91]
    s_add_u32 s48, s48, s62
    ds_read_b64_tr_b16 v[38:39], v19 offset:45056
    buffer_load_dwordx4 v3, s[12:15], s59 offen offset:1024 sc1 lds
    v_mfma_f32_16x16x32_bf16 v[92:95], v[40:43], v[156:159], v[92:95]
    s_cmp_ge_u32 s59, 368640
    ds_read_b64_tr_b16 v[40:41], v20 offset:40960
    v_mfma_f32_16x16x32_bf16 v[96:99], v[44:47], v[152:155], v[96:99]
    s_cselect_b32 s50, 4294606848, s51
    ds_read_b64_tr_b16 v[42:43], v20 offset:45056
    v_mfma_f32_16x16x32_bf16 v[100:103], v[44:47], v[156:159], v[100:103]
    s_cmp_ge_u32 s59, 385024
    ds_read_b64_tr_b16 v[44:45], v21 offset:40960
    v_mfma_f32_16x16x32_bf16 v[104:107], v[48:51], v[152:155], v[104:107]
    s_cselect_b32 s50, 8192, s50
    ds_read_b64_tr_b16 v[46:47], v21 offset:45056
    v_mfma_f32_16x16x32_bf16 v[108:111], v[48:51], v[156:159], v[108:111]
    s_add_u32 s59, s59, s50
    ds_read_b64_tr_b16 v[48:49], v22 offset:40960
    v_mfma_f32_16x16x32_bf16 v[112:115], v[52:55], v[152:155], v[112:115]
    s_add_u32 s58, s58, 8192
    s_and_b32 m0, s58, 0x1ffff
    ds_read_b64_tr_b16 v[50:51], v22 offset:45056
    v_mfma_f32_16x16x32_bf16 v[116:119], v[52:55], v[156:159], v[116:119]
    s_waitcnt vmcnt(16) lgkmcnt(6)
    ds_read_b64_tr_b16 v[52:53], v23 offset:40960
    v_mfma_f32_16x16x32_bf16 v[56:59], v[24:27], v[160:163], v[56:59]
    ds_read_b64_tr_b16 v[54:55], v23 offset:45056
    buffer_load_dwordx4 v[136:139], v12, s[28:31], s48 offen offset:0 sc1
    s_barrier
    v_mfma_f32_16x16x32_bf16 v[60:63], v[24:27], v[164:167], v[60:63]
    ds_read_b64_tr_b16 v[24:25], v16 offset:49152
    v_mfma_f32_16x16x32_bf16 v[64:67], v[28:31], v[160:163], v[64:67]
    ds_read_b64_tr_b16 v[26:27], v16 offset:53248
    buffer_load_dwordx4 v[140:143], v12, s[28:31], s48 offen offset:1024 sc1
    v_mfma_f32_16x16x32_bf16 v[68:71], v[28:31], v[164:167], v[68:71]
    s_cmp_ge_u32 s48, 5898240
    ds_read_b64_tr_b16 v[28:29], v17 offset:49152
    v_mfma_f32_16x16x32_bf16 v[72:75], v[32:35], v[160:163], v[72:75]
    s_cselect_b32 s62, 4289200128, s63
    ds_read_b64_tr_b16 v[30:31], v17 offset:53248
    v_mfma_f32_16x16x32_bf16 v[76:79], v[32:35], v[164:167], v[76:79]
    s_cmp_ge_u32 s48, 6160384
    ds_read_b64_tr_b16 v[32:33], v18 offset:49152
    v_mfma_f32_16x16x32_bf16 v[80:83], v[36:39], v[160:163], v[80:83]
    s_cselect_b32 s62, 131072, s62
    ds_read_b64_tr_b16 v[34:35], v18 offset:53248
    buffer_load_dwordx4 v3, s[12:15], s59 offen sc1 lds
    v_mfma_f32_16x16x32_bf16 v[84:87], v[36:39], v[164:167], v[84:87]
    s_waitcnt lgkmcnt(6)
    ds_read_b64_tr_b16 v[36:37], v19 offset:49152
    v_mfma_f32_16x16x32_bf16 v[88:91], v[40:43], v[160:163], v[88:91]
    s_add_u32 s48, s48, s62
    ds_read_b64_tr_b16 v[38:39], v19 offset:53248
    buffer_load_dwordx4 v3, s[12:15], s59 offen offset:1024 sc1 lds
    v_mfma_f32_16x16x32_bf16 v[92:95], v[40:43], v[164:167], v[92:95]
    s_cmp_ge_u32 s59, 368640
    ds_read_b64_tr_b16 v[40:41], v20 offset:49152
    v_mfma_f32_16x16x32_bf16 v[96:99], v[44:47], v[160:163], v[96:99]
    s_cselect_b32 s50, 4294606848, s51
    ds_read_b64_tr_b16 v[42:43], v20 offset:53248
    v_mfma_f32_16x16x32_bf16 v[100:103], v[44:47], v[164:167], v[100:103]
    s_cmp_ge_u32 s59, 385024
    ds_read_b64_tr_b16 v[44:45], v21 offset:49152
    v_mfma_f32_16x16x32_bf16 v[104:107], v[48:51], v[160:163], v[104:107]
    s_cselect_b32 s50, 8192, s50
    ds_read_b64_tr_b16 v[46:47], v21 offset:53248
    v_mfma_f32_16x16x32_bf16 v[108:111], v[48:51], v[164:167], v[108:111]
    s_add_u32 s59, s59, s50
    ds_read_b64_tr_b16 v[48:49], v22 offset:49152
    v_mfma_f32_16x16x32_bf16 v[112:115], v[52:55], v[160:163], v[112:115]
    s_add_u32 s58, s58, 8192
    s_and_b32 m0, s58, 0x1ffff
    ds_read_b64_tr_b16 v[50:51], v22 offset:53248
    v_mfma_f32_16x16x32_bf16 v[116:119], v[52:55], v[164:167], v[116:119]
    s_waitcnt vmcnt(18) lgkmcnt(6)
    ds_read_b64_tr_b16 v[52:53], v23 offset:49152
    v_mfma_f32_16x16x32_bf16 v[56:59], v[24:27], v[168:171], v[56:59]
    ds_read_b64_tr_b16 v[54:55], v23 offset:53248
    buffer_load_dwordx4 v[144:147], v12, s[28:31], s48 offen offset:0 sc1
    v_mfma_f32_16x16x32_bf16 v[60:63], v[24:27], v[172:175], v[60:63]
    ds_read_b64_tr_b16 v[24:25], v16 offset:57344
    v_mfma_f32_16x16x32_bf16 v[64:67], v[28:31], v[168:171], v[64:67]
    ds_read_b64_tr_b16 v[26:27], v16 offset:61440
    buffer_load_dwordx4 v[148:151], v12, s[28:31], s48 offen offset:1024 sc1
    v_mfma_f32_16x16x32_bf16 v[68:71], v[28:31], v[172:175], v[68:71]
    s_cmp_ge_u32 s48, 5898240
    ds_read_b64_tr_b16 v[28:29], v17 offset:57344
    v_mfma_f32_16x16x32_bf16 v[72:75], v[32:35], v[168:171], v[72:75]
    s_cselect_b32 s62, 4289200128, s63
    ds_read_b64_tr_b16 v[30:31], v17 offset:61440
    v_mfma_f32_16x16x32_bf16 v[76:79], v[32:35], v[172:175], v[76:79]
    s_cmp_ge_u32 s48, 6160384
    ds_read_b64_tr_b16 v[32:33], v18 offset:57344
    v_mfma_f32_16x16x32_bf16 v[80:83], v[36:39], v[168:171], v[80:83]
    s_cselect_b32 s62, 131072, s62
    ds_read_b64_tr_b16 v[34:35], v18 offset:61440
    buffer_load_dwordx4 v3, s[12:15], s59 offen sc1 lds
    v_mfma_f32_16x16x32_bf16 v[84:87], v[36:39], v[172:175], v[84:87]
    s_waitcnt lgkmcnt(6)
    ds_read_b64_tr_b16 v[36:37], v19 offset:57344
    v_mfma_f32_16x16x32_bf16 v[88:91], v[40:43], v[168:171], v[88:91]
    s_add_u32 s48, s48, s62
    ds_read_b64_tr_b16 v[38:39], v19 offset:61440
    buffer_load_dwordx4 v3, s[12:15], s59 offen offset:1024 sc1 lds
    v_mfma_f32_16x16x32_bf16 v[92:95], v[40:43], v[172:175], v[92:95]
    s_cmp_ge_u32 s59, 368640
    ds_read_b64_tr_b16 v[40:41], v20 offset:57344
    v_mfma_f32_16x16x32_bf16 v[96:99], v[44:47], v[168:171], v[96:99]
    s_cselect_b32 s50, 4294606848, s51
    ds_read_b64_tr_b16 v[42:43], v20 offset:61440
    v_mfma_f32_16x16x32_bf16 v[100:103], v[44:47], v[172:175], v[100:103]
    s_cmp_ge_u32 s59, 385024
    ds_read_b64_tr_b16 v[44:45], v21 offset:57344
    v_mfma_f32_16x16x32_bf16 v[104:107], v[48:51], v[168:171], v[104:107]
    s_cselect_b32 s50, 8192, s50
    ds_read_b64_tr_b16 v[46:47], v21 offset:61440
    v_mfma_f32_16x16x32_bf16 v[108:111], v[48:51], v[172:175], v[108:111]
    s_add_u32 s59, s59, s50
    ds_read_b64_tr_b16 v[48:49], v22 offset:57344
    v_mfma_f32_16x16x32_bf16 v[112:115], v[52:55], v[168:171], v[112:115]
    s_add_u32 s58, s58, 8192
    s_and_b32 m0, s58, 0x1ffff
    ds_read_b64_tr_b16 v[50:51], v22 offset:61440
    v_mfma_f32_16x16x32_bf16 v[116:119], v[52:55], v[172:175], v[116:119]
    s_waitcnt vmcnt(18) lgkmcnt(6)
    ds_read_b64_tr_b16 v[52:53], v23 offset:57344
    v_mfma_f32_16x16x32_bf16 v[56:59], v[24:27], v[176:179], v[56:59]
    ds_read_b64_tr_b16 v[54:55], v23 offset:61440
    buffer_load_dwordx4 v[152:155], v12, s[28:31], s48 offen offset:0 sc1
    s_barrier
    v_xor_b32 v16, 0x10000, v16
    v_mfma_f32_16x16x32_bf16 v[60:63], v[24:27], v[180:183], v[60:63]
    ds_read_b64_tr_b16 v[24:25], v16 offset:0
    v_mfma_f32_16x16x32_bf16 v[64:67], v[28:31], v[176:179], v[64:67]
    ds_read_b64_tr_b16 v[26:27], v16 offset:4096
    buffer_load_dwordx4 v[156:159], v12, s[28:31], s48 offen offset:1024 sc1
    v_xor_b32 v17, 0x10000, v17
    v_mfma_f32_16x16x32_bf16 v[68:71], v[28:31], v[180:183], v[68:71]
    s_cmp_ge_u32 s48, 5898240
    ds_read_b64_tr_b16 v[28:29], v17 offset:0
    v_mfma_f32_16x16x32_bf16 v[72:75], v[32:35], v[176:179], v[72:75]
    s_cselect_b32 s62, 4289200128, s63
    ds_read_b64_tr_b16 v[30:31], v17 offset:4096
    v_xor_b32 v18, 0x10000, v18
    v_mfma_f32_16x16x32_bf16 v[76:79], v[32:35], v[180:183], v[76:79]
    s_cmp_ge_u32 s48, 6160384
    ds_read_b64_tr_b16 v[32:33], v18 offset:0
    v_mfma_f32_16x16x32_bf16 v[80:83], v[36:39], v[176:179], v[80:83]
    s_cselect_b32 s62, 131072, s62
    ds_read_b64_tr_b16 v[34:35], v18 offset:4096
    buffer_load_dwordx4 v3, s[12:15], s59 offen sc1 lds
    v_xor_b32 v19, 0x10000, v19
    v_mfma_f32_16x16x32_bf16 v[84:87], v[36:39], v[180:183], v[84:87]
    s_waitcnt lgkmcnt(6)
    ds_read_b64_tr_b16 v[36:37], v19 offset:0
    v_mfma_f32_16x16x32_bf16 v[88:91], v[40:43], v[176:179], v[88:91]
    s_add_u32 s48, s48, s62
    ds_read_b64_tr_b16 v[38:39], v19 offset:4096
    buffer_load_dwordx4 v3, s[12:15], s59 offen offset:1024 sc1 lds
    v_xor_b32 v20, 0x10000, v20
    v_mfma_f32_16x16x32_bf16 v[92:95], v[40:43], v[180:183], v[92:95]
    s_cmp_ge_u32 s59, 368640
    ds_read_b64_tr_b16 v[40:41], v20 offset:0
    v_mfma_f32_16x16x32_bf16 v[96:99], v[44:47], v[176:179], v[96:99]
    s_cselect_b32 s50, 4294606848, s51
    ds_read_b64_tr_b16 v[42:43], v20 offset:4096
    v_xor_b32 v21, 0x10000, v21
    v_mfma_f32_16x16x32_bf16 v[100:103], v[44:47], v[180:183], v[100:103]
    s_cmp_ge_u32 s59, 385024
    ds_read_b64_tr_b16 v[44:45], v21 offset:0
    v_mfma_f32_16x16x32_bf16 v[104:107], v[48:51], v[176:179], v[104:107]
    s_cselect_b32 s50, 8192, s50
    ds_read_b64_tr_b16 v[46:47], v21 offset:4096
    v_xor_b32 v22, 0x10000, v22
    v_mfma_f32_16x16x32_bf16 v[108:111], v[48:51], v[180:183], v[108:111]
    s_add_u32 s59, s59, s50
    ds_read_b64_tr_b16 v[48:49], v22 offset:0
    v_mfma_f32_16x16x32_bf16 v[112:115], v[52:55], v[176:179], v[112:115]
    s_add_u32 s58, s58, 8192
    s_and_b32 m0, s58, 0x1ffff
    ds_read_b64_tr_b16 v[50:51], v22 offset:4096
    v_xor_b32 v23, 0x10000, v23
    v_mfma_f32_16x16x32_bf16 v[116:119], v[52:55], v[180:183], v[116:119]
    s_waitcnt vmcnt(18) lgkmcnt(6)
    ds_read_b64_tr_b16 v[52:53], v23 offset:0
    s_sub_u32 s55, s55, 1
    s_cmp_lg_u32 s55, 0
    s_cbranch_scc1 K6_LOOP
    v_swap_b32 v122, v124
    v_swap_b32 v123, v125
    s_nop 1
    v_mfma_f32_16x16x32_bf16 v[56:59], v[24:27], v[120:123], v[56:59]
    ds_read_b64_tr_b16 v[54:55], v23 offset:4096
    buffer_load_dwordx4 v[160:163], v12, s[28:31], s48 offen offset:0 sc1
    v_mfma_f32_16x16x32_bf16 v[60:63], v[24:27], v[124:127], v[60:63]
    ds_read_b64_tr_b16 v[24:25], v16 offset:8192
    v_mfma_f32_16x16x32_bf16 v[64:67], v[28:31], v[120:123], v[64:67]
    ds_read_b64_tr_b16 v[26:27], v16 offset:12288
    buffer_load_dwordx4 v[164:167], v12, s[28:31], s48 offen offset:1024 sc1
    v_mfma_f32_16x16x32_bf16 v[68:71], v[28:31], v[124:127], v[68:71]
    s_cmp_ge_u32 s48, 5898240
    ds_read_b64_tr_b16 v[28:29], v17 offset:8192
    v_mfma_f32_16x16x32_bf16 v[72:75], v[32:35], v[120:123], v[72:75]
    s_cselect_b32 s62, 4289200128, s63
    ds_read_b64_tr_b16 v[30:31], v17 offset:12288
    v_mfma_f32_16x16x32_bf16 v[76:79], v[32:35], v[124:127], v[76:79]
    s_cmp_ge_u32 s48, 6160384
    ds_read_b64_tr_b16 v[32:33], v18 offset:8192
    v_mfma_f32_16x16x32_bf16 v[80:83], v[36:39], v[120:123], v[80:83]
    s_cselect_b32 s62, 131072, s62
    ds_read_b64_tr_b16 v[34:35], v18 offset:12288
    v_mfma_f32_16x16x32_bf16 v[84:87], v[36:39], v[124:127], v[84:87]
    s_waitcnt lgkmcnt(6)
    ds_read_b64_tr_b16 v[36:37], v19 offset:8192
    v_mfma_f32_16x16x32_bf16 v[88:91], v[40:43], v[120:123], v[88:91]
    s_add_u32 s48, s48, s62
    ds_read_b64_tr_b16 v[38:39], v19 offset:12288
    v_mfma_f32_16x16x32_bf16 v[92:95], v[40:43], v[124:127], v[92:95]
    ds_read_b64_tr_b16 v[40:41], v20 offset:8192
    v_mfma_f32_16x16x32_bf16 v[96:99], v[44:47], v[120:123], v[96:99]
    ds_read_b64_tr_b16 v[42:43], v20 offset:12288
    v_mfma_f32_16x16x32_bf16 v[100:103], v[44:47], v[124:127], v[100:103]
    ds_read_b64_tr_b16 v[44:45], v21 offset:8192
    v_mfma_f32_16x16x32_bf16 v[104:107], v[48:51], v[120:123], v[104:107]
    ds_read_b64_tr_b16 v[46:47], v21 offset:12288
    buffer_load_dword v200, v13, s[24:27], s54 offen sc1
    s_add_u32 s54, s54, 24576
    v_mfma_f32_16x16x32_bf16 v[108:111], v[48:51], v[124:127], v[108:111]
    ds_read_b64_tr_b16 v[48:49], v22 offset:8192
    v_mfma_f32_16x16x32_bf16 v[112:115], v[52:55], v[120:123], v[112:115]
    ds_read_b64_tr_b16 v[50:51], v22 offset:12288
    v_mfma_f32_16x16x32_bf16 v[116:119], v[52:55], v[124:127], v[116:119]
    s_waitcnt vmcnt(17) lgkmcnt(6)
    ds_read_b64_tr_b16 v[52:53], v23 offset:8192
    v_swap_b32 v130, v132
    v_swap_b32 v131, v133
    s_nop 1
    v_mfma_f32_16x16x32_bf16 v[56:59], v[24:27], v[128:131], v[56:59]
    ds_read_b64_tr_b16 v[54:55], v23 offset:12288
    buffer_load_dwordx4 v[168:171], v12, s[28:31], s48 offen offset:0 sc1
    s_barrier
    v_mfma_f32_16x16x32_bf16 v[60:63], v[24:27], v[132:135], v[60:63]
    ds_read_b64_tr_b16 v[24:25], v16 offset:16384
    v_mfma_f32_16x16x32_bf16 v[64:67], v[28:31], v[128:131], v[64:67]
    ds_read_b64_tr_b16 v[26:27], v16 offset:20480
    buffer_load_dwordx4 v[172:175], v12, s[28:31], s48 offen offset:1024 sc1
    v_mfma_f32_16x16x32_bf16 v[68:71], v[28:31], v[132:135], v[68:71]
    s_cmp_ge_u32 s48, 5898240
    ds_read_b64_tr_b16 v[28:29], v17 offset:16384
    v_mfma_f32_16x16x32_bf16 v[72:75], v[32:35], v[128:131], v[72:75]
    s_cselect_b32 s62, 4289200128, s63
    ds_read_b64_tr_b16 v[30:31], v17 offset:20480
    v_mfma_f32_16x16x32_bf16 v[76:79], v[32:35], v[132:135], v[76:79]
    s_cmp_ge_u32 s48, 6160384
    ds_read_b64_tr_b16 v[32:33], v18 offset:16384
    v_mfma_f32_16x16x32_bf16 v[80:83], v[36:39], v[128:131], v[80:83]
    s_cselect_b32 s62, 131072, s62
    ds_read_b64_tr_b16 v[34:35], v18 offset:20480
    v_mfma_f32_16x16x32_bf16 v[84:87], v[36:39], v[132:135], v[84:87]
    s_waitcnt lgkmcnt(6)
    ds_read_b64_tr_b16 v[36:37], v19 offset:16384
    v_mfma_f32_16x16x32_bf16 v[88:91], v[40:43], v[128:131], v[88:91]
    s_add_u32 s48, s48, s62
    ds_read_b64_tr_b16 v[38:39], v19 offset:20480
    v_mfma_f32_16x16x32_bf16 v[92:95], v[40:43], v[132:135], v[92:95]
    ds_read_b64_tr_b16 v[40:41], v20 offset:16384
    v_mfma_f32_16x16x32_bf16 v[96:99], v[44:47], v[128:131], v[96:99]
    ds_read_b64_tr_b16 v[42:43], v20 offset:20480
    v_mfma_f32_16x16x32_bf16 v[100:103], v[44:47], v[132:135], v[100:103]
    ds_read_b64_tr_b16 v[44:45], v21 offset:16384
    v_mfma_f32_16x16x32_bf16 v[104:107], v[48:51], v[128:131], v[104:107]
    ds_read_b64_tr_b16 v[46:47], v21 offset:20480
    buffer_load_dword v201, v13, s[24:27], s54 offen sc1
    s_add_u32 s54, s54, 24576
    v_mfma_f32_16x16x32_bf16 v[108:111], v[48:51], v[132:135], v[108:111]
    ds_read_b64_tr_b16 v[48:49], v22 offset:16384
    v_mfma_f32_16x16x32_bf16 v[112:115], v[52:55], v[128:131], v[112:115]
    ds_read_b64_tr_b16 v[50:51], v22 offset:20480
    v_mfma_f32_16x16x32_bf16 v[116:119], v[52:55], v[132:135], v[116:119]
    s_waitcnt vmcnt(16) lgkmcnt(6)
    ds_read_b64_tr_b16 v[52:53], v23 offset:16384
    v_swap_b32 v138, v140
    v_swap_b32 v139, v141
    s_nop 1
    v_mfma_f32_16x16x32_bf16 v[56:59], v[24:27], v[136:139], v[56:59]
    ds_read_b64_tr_b16 v[54:55], v23 offset:20480
    buffer_load_dwordx4 v[176:179], v12, s[28:31], s48 offen offset:0 sc1
    v_mfma_f32_16x16x32_bf16 v[60:63], v[24:27], v[140:143], v[60:63]
    ds_read_b64_tr_b16 v[24:25], v16 offset:24576
    v_mfma_f32_16x16x32_bf16 v[64:67], v[28:31], v[136:139], v[64:67]
    ds_read_b64_tr_b16 v[26:27], v16 offset:28672
    buffer_load_dwordx4 v[180:183], v12, s[28:31], s48 offen offset:1024 sc1
    v_mfma_f32_16x16x32_bf16 v[68:71], v[28:31], v[140:143], v[68:71]
    s_cmp_ge_u32 s48, 5898240
    ds_read_b64_tr_b16 v[28:29], v17 offset:24576
    v_mfma_f32_16x16x32_bf16 v[72:75], v[32:35], v[136:139], v[72:75]
    s_cselect_b32 s62, 4289200128, s63
    ds_read_b64_tr_b16 v[30:31], v17 offset:28672
    v_mfma_f32_16x16x32_bf16 v[76:79], v[32:35], v[140:143], v[76:79]
    s_cmp_ge_u32 s48, 6160384
    ds_read_b64_tr_b16 v[32:33], v18 offset:24576
    v_mfma_f32_16x16x32_bf16 v[80:83], v[36:39], v[136:139], v[80:83]
    s_cselect_b32 s62, 131072, s62
    ds_read_b64_tr_b16 v[34:35], v18 offset:28672
    v_mfma_f32_16x16x32_bf16 v[84:87], v[36:39], v[140:143], v[84:87]
    s_waitcnt lgkmcnt(6)
    ds_read_b64_tr_b16 v[36:37], v19 offset:24576
    v_mfma_f32_16x16x32_bf16 v[88:91], v[40:43], v[136:139], v[88:91]
    s_add_u32 s48, s48, s62
    ds_read_b64_tr_b16 v[38:39], v19 offset:28672
    v_mfma_f32_16x16x32_bf16 v[92:95], v[40:43], v[140:143], v[92:95]
    ds_read_b64_tr_b16 v[40:41], v20 offset:24576
    v_mfma_f32_16x16x32_bf16 v[96:99], v[44:47], v[136:139], v[96:99]
    ds_read_b64_tr_b16 v[42:43], v20 offset:28672
    v_mfma_f32_16x16x32_bf16 v[100:103], v[44:47], v[140:143], v[100:103]
    ds_read_b64_tr_b16 v[44:45], v21 offset:24576
    v_mfma_f32_16x16x32_bf16 v[104:107], v[48:51], v[136:139], v[104:107]
    ds_read_b64_tr_b16 v[46:47], v21 offset:28672
    buffer_load_dword v202, v13, s[24:27], s54 offen sc1
    s_add_u32 s54, s54, 24576
    v_mfma_f32_16x16x32_bf16 v[108:111], v[48:51], v[140:143], v[108:111]
    ds_read_b64_tr_b16 v[48:49], v22 offset:24576
    v_mfma_f32_16x16x32_bf16 v[112:115], v[52:55], v[136:139], v[112:115]
    ds_read_b64_tr_b16 v[50:51], v22 offset:28672
    v_mfma_f32_16x16x32_bf16 v[116:119], v[52:55], v[140:143], v[116:119]
    s_waitcnt vmcnt(15) lgkmcnt(6)
    ds_read_b64_tr_b16 v[52:53], v23 offset:24576
    v_swap_b32 v146, v148
    v_swap_b32 v147, v149
    s_nop 1
    v_mfma_f32_16x16x32_bf16 v[56:59], v[24:27], v[144:147], v[56:59]
    ds_read_b64_tr_b16 v[54:55], v23 offset:28672
    s_barrier
    v_mfma_f32_16x16x32_bf16 v[60:63], v[24:27], v[148:151], v[60:63]
    ds_read_b64_tr_b16 v[24:25], v16 offset:32768
    v_mfma_f32_16x16x32_bf16 v[64:67], v[28:31], v[144:147], v[64:67]
    ds_read_b64_tr_b16 v[26:27], v16 offset:36864
    v_mfma_f32_16x16x32_bf16 v[68:71], v[28:31], v[148:151], v[68:71]
    ds_read_b64_tr_b16 v[28:29], v17 offset:32768
    v_mfma_f32_16x16x32_bf16 v[72:75], v[32:35], v[144:147], v[72:75]
    ds_read_b64_tr_b16 v[30:31], v17 offset:36864
    v_mfma_f32_16x16x32_bf16 v[76:79], v[32:35], v[148:151], v[76:79]
    ds_read_b64_tr_b16 v[32:33], v18 offset:32768
    v_mfma_f32_16x16x32_bf16 v[80:83], v[36:39], v[144:147], v[80:83]
    ds_read_b64_tr_b16 v[34:35], v18 offset:36864
    v_mfma_f32_16x16x32_bf16 v[84:87], v[36:39], v[148:151], v[84:87]
    s_waitcnt lgkmcnt(6)
    ds_read_b64_tr_b16 v[36:37], v19 offset:32768
    v_mfma_f32_16x16x32_bf16 v[88:91], v[40:43], v[144:147], v[88:91]
    ds_read_b64_tr_b16 v[38:39], v19 offset:36864
    v_mfma_f32_16x16x32_bf16 v[92:95], v[40:43], v[148:151], v[92:95]
    ds_read_b64_tr_b16 v[40:41], v20 offset:32768
    v_mfma_f32_16x16x32_bf16 v[96:99], v[44:47], v[144:147], v[96:99]
    ds_read_b64_tr_b16 v[42:43], v20 offset:36864
    v_mfma_f32_16x16x32_bf16 v[100:103], v[44:47], v[148:151], v[100:103]
    ds_read_b64_tr_b16 v[44:45], v21 offset:32768
    v_mfma_f32_16x16x32_bf16 v[104:107], v[48:51], v[144:147], v[104:107]
    ds_read_b64_tr_b16 v[46:47], v21 offset:36864
    buffer_load_dword v203, v13, s[24:27], s54 offen sc1
    s_add_u32 s54, s54, 24576
    v_mfma_f32_16x16x32_bf16 v[108:111], v[48:51], v[148:151], v[108:111]
    ds_read_b64_tr_b16 v[48:49], v22 offset:32768
    v_mfma_f32_16x16x32_bf16 v[112:115], v[52:55], v[144:147], v[112:115]
    ds_read_b64_tr_b16 v[50:51], v22 offset:36864
    v_mfma_f32_16x16x32_bf16 v[116:119], v[52:55], v[148:151], v[116:119]
    s_waitcnt vmcnt(12) lgkmcnt(6)
    ds_read_b64_tr_b16 v[52:53], v23 offset:32768
    v_swap_b32 v154, v156
    v_swap_b32 v155, v157
    s_nop 1
    v_mfma_f32_16x16x32_bf16 v[56:59], v[24:27], v[152:155], v[56:59]
    ds_read_b64_tr_b16 v[54:55], v23 offset:36864
    v_mfma_f32_16x16x32_bf16 v[60:63], v[24:27], v[156:159], v[60:63]
    ds_read_b64_tr_b16 v[24:25], v16 offset:40960
    v_mfma_f32_16x16x32_bf16 v[64:67], v[28:31], v[152:155], v[64:67]
    ds_read_b64_tr_b16 v[26:27], v16 offset:45056
    v_mfma_f32_16x16x32_bf16 v[68:71], v[28:31], v[156:159], v[68:71]
    ds_read_b64_tr_b16 v[28:29], v17 offset:40960
    v_mfma_f32_16x16x32_bf16 v[72:75], v[32:35], v[152:155], v[72:75]
    ds_read_b64_tr_b16 v[30:31], v17 offset:45056
    v_mfma_f32_16x16x32_bf16 v[76:79], v[32:35], v[156:159], v[76:79]
    ds_read_b64_tr_b16 v[32:33], v18 offset:40960
    v_mfma_f32_16x16x32_bf16 v[80:83], v[36:39], v[152:155], v[80:83]
    ds_read_b64_tr_b16 v[34:35], v18 offset:45056
    v_mfma_f32_16x16x32_bf16 v[84:87], v[36:39], v[156:159], v[84:87]
    s_waitcnt lgkmcnt(6)
    ds_read_b64_tr_b16 v[36:37], v19 offset:40960
    v_mfma_f32_16x16x32_bf16 v[88:91], v[40:43], v[152:155], v[88:91]
    ds_read_b64_tr_b16 v[38:39], v19 offset:45056
    v_mfma_f32_16x16x32_bf16 v[92:95], v[40:43], v[156:159], v[92:95]
    ds_read_b64_tr_b16 v[40:41], v20 offset:40960
    v_mfma_f32_16x16x32_bf16 v[96:99], v[44:47], v[152:155], v[96:99]
    ds_read_b64_tr_b16 v[42:43], v20 offset:45056
    v_mfma_f32_16x16x32_bf16 v[100:103], v[44:47], v[156:159], v[100:103]
    ds_read_b64_tr_b16 v[44:45], v21 offset:40960
    v_mfma_f32_16x16x32_bf16 v[104:107], v[48:51], v[152:155], v[104:107]
    ds_read_b64_tr_b16 v[46:47], v21 offset:45056
    v_mfma_f32_16x16x32_bf16 v[108:111], v[48:51], v[156:159], v[108:111]
    ds_read_b64_tr_b16 v[48:49], v22 offset:40960
    v_mfma_f32_16x16x32_bf16 v[112:115], v[52:55], v[152:155], v[112:115]
    ds_read_b64_tr_b16 v[50:51], v22 offset:45056
    v_mfma_f32_16x16x32_bf16 v[116:119], v[52:55], v[156:159], v[116:119]
    s_waitcnt vmcnt(8) lgkmcnt(6)
    ds_read_b64_tr_b16 v[52:53], v23 offset:40960
    v_swap_b32 v162, v164
    v_swap_b32 v163, v165
    s_nop 1
    v_mfma_f32_16x16x32_bf16 v[56:59], v[24:27], v[160:163], v[56:59]
    ds_read_b64_tr_b16 v[54:55], v23 offset:45056
    s_barrier
    v_mfma_f32_16x16x32_bf16 v[60:63], v[24:27], v[164:167], v[60:63]
    ds_read_b64_tr_b16 v[24:25], v16 offset:49152
    v_mfma_f32_16x16x32_bf16 v[64:67], v[28:31], v[160:163], v[64:67]
    ds_read_b64_tr_b16 v[26:27], v16 offset:53248
    v_mfma_f32_16x16x32_bf16 v[68:71], v[28:31], v[164:167], v[68:71]
    ds_read_b64_tr_b16 v[28:29], v17 offset:49152
    v_mfma_f32_16x16x32_bf16 v[72:75], v[32:35], v[160:163], v[72:75]
    ds_read_b64_tr_b16 v[30:31], v17 offset:53248
    v_mfma_f32_16x16x32_bf16 v[76:79], v[32:35], v[164:167], v[76:79]
    ds_read_b64_tr_b16 v[32:33], v18 offset:49152
    v_mfma_f32_16x16x32_bf16 v[80:83], v[36:39], v[160:163], v[80:83]
    ds_read_b64_tr_b16 v[34:35], v18 offset:53248
    v_mfma_f32_16x16x32_bf16 v[84:87], v[36:39], v[164:167], v[84:87]
    s_waitcnt lgkmcnt(6)
    ds_read_b64_tr_b16 v[36:37], v19 offset:49152
    v_mfma_f32_16x16x32_bf16 v[88:91], v[40:43], v[160:163], v[88:91]
    ds_read_b64_tr_b16 v[38:39], v19 offset:53248
    v_mfma_f32_16x16x32_bf16 v[92:95], v[40:43], v[164:167], v[92:95]
    ds_read_b64_tr_b16 v[40:41], v20 offset:49152
    v_mfma_f32_16x16x32_bf16 v[96:99], v[44:47], v[160:163], v[96:99]
    ds_read_b64_tr_b16 v[42:43], v20 offset:53248
    v_mfma_f32_16x16x32_bf16 v[100:103], v[44:47], v[164:167], v[100:103]
    ds_read_b64_tr_b16 v[44:45], v21 offset:49152
    v_mfma_f32_16x16x32_bf16 v[104:107], v[48:51], v[160:163], v[104:107]
    ds_read_b64_tr_b16 v[46:47], v21 offset:53248
    v_mfma_f32_16x16x32_bf16 v[108:111], v[48:51], v[164:167], v[108:111]
    ds_read_b64_tr_b16 v[48:49], v22 offset:49152
    v_mfma_f32_16x16x32_bf16 v[112:115], v[52:55], v[160:163], v[112:115]
    ds_read_b64_tr_b16 v[50:51], v22 offset:53248
    v_mfma_f32_16x16x32_bf16 v[116:119], v[52:55], v[164:167], v[116:119]
    s_waitcnt vmcnt(5) lgkmcnt(6)
    ds_read_b64_tr_b16 v[52:53], v23 offset:49152
    v_swap_b32 v170, v172
    v_swap_b32 v171, v173
    s_nop 1
    v_mfma_f32_16x16x32_bf16 v[56:59], v[24:27], v[168:171], v[56:59]
    ds_read_b64_tr_b16 v[54:55], v23 offset:53248
    v_mfma_f32_16x16x32_bf16 v[60:63], v[24:27], v[172:175], v[60:63]
    ds_read_b64_tr_b16 v[24:25], v16 offset:57344
    v_mfma_f32_16x16x32_bf16 v[64:67], v[28:31], v[168:171], v[64:67]
    ds_read_b64_tr_b16 v[26:27], v16 offset:61440
    v_mfma_f32_16x16x32_bf16 v[68:71], v[28:31], v[172:175], v[68:71]
    ds_read_b64_tr_b16 v[28:29], v17 offset:57344
    v_mfma_f32_16x16x32_bf16 v[72:75], v[32:35], v[168:171], v[72:75]
    ds_read_b64_tr_b16 v[30:31], v17 offset:61440
    v_mfma_f32_16x16x32_bf16 v[76:79], v[32:35], v[172:175], v[76:79]
    ds_read_b64_tr_b16 v[32:33], v18 offset:57344
    v_mfma_f32_16x16x32_bf16 v[80:83], v[36:39], v[168:171], v[80:83]
    ds_read_b64_tr_b16 v[34:35], v18 offset:61440
    v_mfma_f32_16x16x32_bf16 v[84:87], v[36:39], v[172:175], v[84:87]
    s_waitcnt lgkmcnt(6)
    ds_read_b64_tr_b16 v[36:37], v19 offset:57344
    v_mfma_f32_16x16x32_bf16 v[88:91], v[40:43], v[168:171], v[88:91]
    ds_read_b64_tr_b16 v[38:39], v19 offset:61440
    v_mfma_f32_16x16x32_bf16 v[92:95], v[40:43], v[172:175], v[92:95]
    ds_read_b64_tr_b16 v[40:41], v20 offset:57344
    v_mfma_f32_16x16x32_bf16 v[96:99], v[44:47], v[168:171], v[96:99]
    ds_read_b64_tr_b16 v[42:43], v20 offset:61440
    v_mfma_f32_16x16x32_bf16 v[100:103], v[44:47], v[172:175], v[100:103]
    ds_read_b64_tr_b16 v[44:45], v21 offset:57344
    v_mfma_f32_16x16x32_bf16 v[104:107], v[48:51], v[168:171], v[104:107]
    ds_read_b64_tr_b16 v[46:47], v21 offset:61440
    v_mfma_f32_16x16x32_bf16 v[108:111], v[48:51], v[172:175], v[108:111]
    ds_read_b64_tr_b16 v[48:49], v22 offset:57344
    v_mfma_f32_16x16x32_bf16 v[112:115], v[52:55], v[168:171], v[112:115]
    ds_read_b64_tr_b16 v[50:51], v22 offset:61440
    v_mfma_f32_16x16x32_bf16 v[116:119], v[52:55], v[172:175], v[116:119]
    s_waitcnt vmcnt(2) lgkmcnt(6)
    ds_read_b64_tr_b16 v[52:53], v23 offset:57344
    v_swap_b32 v178, v180
    v_swap_b32 v179, v181
    s_nop 1
    v_mfma_f32_16x16x32_bf16 v[56:59], v[24:27], v[176:179], v[56:59]
    ds_read_b64_tr_b16 v[54:55], v23 offset:61440
    v_mfma_f32_16x16x32_bf16 v[60:63], v[24:27], v[180:183], v[60:63]
    v_mfma_f32_16x16x32_bf16 v[64:67], v[28:31], v[176:179], v[64:67]
    v_mfma_f32_16x16x32_bf16 v[68:71], v[28:31], v[180:183], v[68:71]
    v_mfma_f32_16x16x32_bf16 v[72:75], v[32:35], v[176:179], v[72:75]
    v_mfma_f32_16x16x32_bf16 v[76:79], v[32:35], v[180:183], v[76:79]
    v_mfma_f32_16x16x32_bf16 v[80:83], v[36:39], v[176:179], v[80:83]
    v_mfma_f32_16x16x32_bf16 v[84:87], v[36:39], v[180:183], v[84:87]
    s_waitcnt lgkmcnt(0)
    v_mfma_f32_16x16x32_bf16 v[88:91], v[40:43], v[176:179], v[88:91]
    v_mfma_f32_16x16x32_bf16 v[92:95], v[40:43], v[180:183], v[92:95]
    v_mfma_f32_16x16x32_bf16 v[96:99], v[44:47], v[176:179], v[96:99]
    v_mfma_f32_16x16x32_bf16 v[100:103], v[44:47], v[180:183], v[100:103]
    v_mfma_f32_16x16x32_bf16 v[104:107], v[48:51], v[176:179], v[104:107]
    v_mfma_f32_16x16x32_bf16 v[108:111], v[48:51], v[180:183], v[108:111]
    v_mfma_f32_16x16x32_bf16 v[112:115], v[52:55], v[176:179], v[112:115]
    v_mfma_f32_16x16x32_bf16 v[116:119], v[52:55], v[180:183], v[116:119]
    s_lshl_b32 s42, s2, 2
    s_add_u32 s42, s42, s36
    s_xor_b32 s43, s42, 4
    s_lshl_b32 s42, s42, 12
    s_add_u32 s42, s42, 0x1000000
    s_lshl_b32 s43, s43, 12
    s_add_u32 s43, s43, 0x1000000
    s_nop 1
    v_cvt_pk_bf16_f32 v120, v88, v89
    v_cvt_pk_bf16_f32 v121, v90, v91
    v_cvt_pk_bf16_f32 v122, v96, v97
    v_cvt_pk_bf16_f32 v123, v98, v99
    v_min_u32 v120, -2, v120
    v_min_u32 v121, -2, v121
    v_min_u32 v122, -2, v122
    v_min_u32 v123, -2, v123
    buffer_store_dwordx4 v[120:123], v2, s[24:27], s42 offen offset:0 sc1
    v_cvt_pk_bf16_f32 v124, v92, v93
    v_cvt_pk_bf16_f32 v125, v94, v95
    v_cvt_pk_bf16_f32 v126, v100, v101
    v_cvt_pk_bf16_f32 v127, v102, v103
    v_min_u32 v124, -2, v124
    v_min_u32 v125, -2, v125
    v_min_u32 v126, -2, v126
    v_min_u32 v127, -2, v127
    buffer_store_dwordx4 v[124:127], v2, s[24:27], s42 offen offset:1024 sc1
    v_cvt_pk_bf16_f32 v128, v104, v105
    v_cvt_pk_bf16_f32 v129, v106, v107
    v_cvt_pk_bf16_f32 v130, v112, v113
    v_cvt_pk_bf16_f32 v131, v114, v115
    v_min_u32 v128, -2, v128
    v_min_u32 v129, -2, v129
    v_min_u32 v130, -2, v130
    v_min_u32 v131, -2, v131
    buffer_store_dwordx4 v[128:131], v2, s[24:27], s42 offen offset:2048 sc1
    v_cvt_pk_bf16_f32 v132, v108, v109
    v_cvt_pk_bf16_f32 v133, v110, v111
    v_cvt_pk_bf16_f32 v134, v116, v117
    v_cvt_pk_bf16_f32 v135, v118, v119
    v_min_u32 v132, -2, v132
    v_min_u32 v133, -2, v133
    v_min_u32 v134, -2, v134
    v_min_u32 v135, -2, v135
    buffer_store_dwordx4 v[132:135], v2, s[24:27], s42 offen offset:3072 sc1
    s_waitcnt vmcnt(4)
    v_add_f32 v200, v200, v201
    v_add_f32 v202, v202, v203
    v_add_f32 v200, v200, v202
    v_cvt_pk_bf16_f32 v200, v200, v200
    v_and_b32 v200, 0xffff0000, v200
    v_lshlrev_b32 v13, 2, v1
    v_add_u32 v13, s45, v13
    v_lshlrev_b32 v14, 4, v15
    v_add_u32 v14, s45, v14
    ds_write_b32 v13, v200 offset:6144
    s_waitcnt lgkmcnt(0)
    ds_read_b128 v[184:187], v14 offset:6144
    ds_read_b128 v[188:191], v14 offset:6208
    ds_read_b128 v[192:195], v14 offset:6272
    ds_read_b128 v[196:199], v14 offset:6336
    s_waitcnt lgkmcnt(0)
    v_accvgpr_read_b32 v156, a48
    v_accvgpr_read_b32 v157, a49
    v_lshlrev_b32 v152, 16, v156
    v_and_b32 v153, 0xffff0000, v156
    v_lshlrev_b32 v154, 16, v157
    v_and_b32 v155, 0xffff0000, v157
    v_pk_fma_f32 v[56:57], v[56:57], v[184:185], v[152:153]
    v_pk_fma_f32 v[58:59], v[58:59], v[186:187], v[154:155]
    v_accvgpr_read_b32 v156, a50
    v_accvgpr_read_b32 v157, a51
    v_lshlrev_b32 v152, 16, v156
    v_and_b32 v153, 0xffff0000, v156
    v_lshlrev_b32 v154, 16, v157
    v_and_b32 v155, 0xffff0000, v157
    v_pk_fma_f32 v[64:65], v[64:65], v[188:189], v[152:153]
    v_pk_fma_f32 v[66:67], v[66:67], v[190:191], v[154:155]
    v_accvgpr_read_b32 v156, a52
    v_accvgpr_read_b32 v157, a53
    v_lshlrev_b32 v152, 16, v156
    v_and_b32 v153, 0xffff0000, v156
    v_lshlrev_b32 v154, 16, v157
    v_and_b32 v155, 0xffff0000, v157
    v_pk_fma_f32 v[72:73], v[72:73], v[192:193], v[152:153]
    v_pk_fma_f32 v[74:75], v[74:75], v[194:195], v[154:155]
    v_accvgpr_read_b32 v156, a54
    v_accvgpr_read_b32 v157, a55
    v_lshlrev_b32 v152, 16, v156
    v_and_b32 v153, 0xffff0000, v156
    v_lshlrev_b32 v154, 16, v157
    v_and_b32 v155, 0xffff0000, v157
    v_pk_fma_f32 v[80:81], v[80:81], v[196:197], v[152:153]
    v_pk_fma_f32 v[82:83], v[82:83], v[198:199], v[154:155]
    v_accvgpr_read_b32 v156, a56
    v_accvgpr_read_b32 v157, a57
    v_lshlrev_b32 v152, 16, v156
    v_and_b32 v153, 0xffff0000, v156
    v_lshlrev_b32 v154, 16, v157
    v_and_b32 v155, 0xffff0000, v157
    v_pk_fma_f32 v[60:61], v[60:61], v[184:185], v[152:153]
    v_pk_fma_f32 v[62:63], v[62:63], v[186:187], v[154:155]
    v_accvgpr_read_b32 v156, a58
    v_accvgpr_read_b32 v157, a59
    v_lshlrev_b32 v152, 16, v156
    v_and_b32 v153, 0xffff0000, v156
    v_lshlrev_b32 v154, 16, v157
    v_and_b32 v155, 0xffff0000, v157
    v_pk_fma_f32 v[68:69], v[68:69], v[188:189], v[152:153]
    v_pk_fma_f32 v[70:71], v[70:71], v[190:191], v[154:155]
    v_accvgpr_read_b32 v156, a60
    v_accvgpr_read_b32 v157, a61
    v_lshlrev_b32 v152, 16, v156
    v_and_b32 v153, 0xffff0000, v156
    v_lshlrev_b32 v154, 16, v157
    v_and_b32 v155, 0xffff0000, v157
    v_pk_fma_f32 v[76:77], v[76:77], v[192:193], v[152:153]
    v_pk_fma_f32 v[78:79], v[78:79], v[194:195], v[154:155]
    v_accvgpr_read_b32 v156, a62
    v_accvgpr_read_b32 v157, a63
    v_lshlrev_b32 v152, 16, v156
    v_and_b32 v153, 0xffff0000, v156
    v_lshlrev_b32 v154, 16, v157
    v_and_b32 v155, 0xffff0000, v157
    v_pk_fma_f32 v[84:85], v[84:85], v[196:197], v[152:153]
    v_pk_fma_f32 v[86:87], v[86:87], v[198:199], v[154:155]
    v_and_b32 v5, 15, v1
    v_lshrrev_b32 v4, 1, v15
    v_xor_b32 v4, v4, v5
    v_and_b32 v4, 7, v4
    v_lshlrev_b32 v14, 7, v5
    v_lshl_add_u32 v14, v4, 4, v14
    v_and_b32 v4, 1, v15
    v_lshl_add_u32 v14, v4, 3, v14
    v_add_u32 v16, s45, v14
    v_xor_b32 v17, 32, v16
    v_xor_b32 v18, 64, v16
    v_xor_b32 v19, 96, v16
    v_lshrrev_b32 v6, 3, v1
    v_xor_b32 v5, v6, v1
    s_lshl_b32 s44, s47, 5
    v_add_u32 v6, s44, v6
    v_lshlrev_b32 v6, 11, v6
    v_and_b32 v5, 7, v5
    v_lshl_add_u32 v6, v5, 4, v6
    s_lshl_b32 s44, s41, 7
    v_add_u32 v6, s44, v6
    v_add_u32 v7, s45, v2
    s_mov_b32 s60, 0x200000
    s_waitcnt vmcnt(2)
K6_EX:
    buffer_load_dwordx4 v[136:139], v2, s[24:27], s43 offen offset:0 sc1
    buffer_load_dwordx4 v[140:143], v2, s[24:27], s43 offen offset:1024 sc1
    buffer_load_dwordx4 v[144:147], v2, s[24:27], s43 offen offset:2048 sc1
    buffer_load_dwordx4 v[148:151], v2, s[24:27], s43 offen offset:3072 sc1
    s_sub_u32 s60, s60, 1
    s_waitcnt vmcnt(0)
    v_max3_u32 v10, v136, v137, v138
    v_max_u32 v10, v10, v139
    v_max3_u32 v10, v10, v140, v141
    v_max3_u32 v10, v10, v142, v143
    v_max3_u32 v10, v10, v144, v145
    v_max3_u32 v10, v10, v146, v147
    v_max3_u32 v10, v10, v148, v149
    v_max3_u32 v10, v10, v150, v151
    v_cmp_eq_u32 vcc, -1, v10
    s_cmp_eq_u32 s60, 0
    s_cbranch_scc1 K6_EXOK
    s_cmp_eq_u64 vcc, 0
    s_cbranch_scc1 K6_EXOK
    s_sleep 4
    s_branch K6_EX
K6_EXOK:
    v_lshlrev_b32 v152, 16, v136
    v_and_b32 v153, 0xffff0000, v136
    v_lshlrev_b32 v154, 16, v137
    v_and_b32 v155, 0xffff0000, v137
    v_pk_fma_f32 v[56:57], v[152:153], v[184:185], v[56:57]
    v_pk_fma_f32 v[58:59], v[154:155], v[186:187], v[58:59]
    v_cvt_pk_bf16_f32 v160, v56, v57
    v_cvt_pk_bf16_f32 v161, v58, v59
    ds_write_b64 v16, v[160:161] offset:0
    v_lshlrev_b32 v152, 16, v138
    v_and_b32 v153, 0xffff0000, v138
    v_lshlrev_b32 v154, 16, v139
    v_and_b32 v155, 0xffff0000, v139
    v_pk_fma_f32 v[64:65], v[152:153], v[188:189], v[64:65]
    v_pk_fma_f32 v[66:67], v[154:155], v[190:191], v[66:67]
    v_cvt_pk_bf16_f32 v162, v64, v65
    v_cvt_pk_bf16_f32 v163, v66, v67
    ds_write_b64 v17, v[162:163] offset:0
    v_lshlrev_b32 v152, 16, v140
    v_and_b32 v153, 0xffff0000, v140
    v_lshlrev_b32 v154, 16, v141
    v_and_b32 v155, 0xffff0000, v141
    v_pk_fma_f32 v[60:61], v[152:153], v[184:185], v[60:61]
    v_pk_fma_f32 v[62:63], v[154:155], v[186:187], v[62:63]
    v_cvt_pk_bf16_f32 v168, v60, v61
    v_cvt_pk_bf16_f32 v169, v62, v63
    ds_write_b64 v16, v[168:169] offset:2048
    v_lshlrev_b32 v152, 16, v142
    v_and_b32 v153, 0xffff0000, v142
    v_lshlrev_b32 v154, 16, v143
    v_and_b32 v155, 0xffff0000, v143
    v_pk_fma_f32 v[68:69], v[152:153], v[188:189], v[68:69]
    v_pk_fma_f32 v[70:71], v[154:155], v[190:191], v[70:71]
    v_cvt_pk_bf16_f32 v170, v68, v69
    v_cvt_pk_bf16_f32 v171, v70, v71
    ds_write_b64 v17, v[170:171] offset:2048
    v_lshlrev_b32 v152, 16, v144
    v_and_b32 v153, 0xffff0000, v144
    v_lshlrev_b32 v154, 16, v145
    v_and_b32 v155, 0xffff0000, v145
    v_pk_fma_f32 v[72:73], v[152:153], v[192:193], v[72:73]
    v_pk_fma_f32 v[74:75], v[154:155], v[194:195], v[74:75]
    v_cvt_pk_bf16_f32 v164, v72, v73
    v_cvt_pk_bf16_f32 v165, v74, v75
    ds_write_b64 v18, v[164:165] offset:0
    v_lshlrev_b32 v152, 16, v146
    v_and_b32 v153, 0xffff0000, v146
    v_lshlrev_b32 v154, 16, v147
    v_and_b32 v155, 0xffff0000, v147
    v_pk_fma_f32 v[80:81], v[152:153], v[196:197], v[80:81]
    v_pk_fma_f32 v[82:83], v[154:155], v[198:199], v[82:83]
    v_cvt_pk_bf16_f32 v166, v80, v81
    v_cvt_pk_bf16_f32 v167, v82, v83
    ds_write_b64 v19, v[166:167] offset:0
    v_lshlrev_b32 v152, 16, v148
    v_and_b32 v153, 0xffff0000, v148
    v_lshlrev_b32 v154, 16, v149
    v_and_b32 v155, 0xffff0000, v149
    v_pk_fma_f32 v[76:77], v[152:153], v[192:193], v[76:77]
    v_pk_fma_f32 v[78:79], v[154:155], v[194:195], v[78:79]
    v_cvt_pk_bf16_f32 v172, v76, v77
    v_cvt_pk_bf16_f32 v173, v78, v79
    ds_write_b64 v18, v[172:173] offset:2048
    v_lshlrev_b32 v152, 16, v150
    v_and_b32 v153, 0xffff0000, v150
    v_lshlrev_b32 v154, 16, v151
    v_and_b32 v155, 0xffff0000, v151
    v_pk_fma_f32 v[84:85], v[152:153], v[196:197], v[84:85]
    v_pk_fma_f32 v[86:87], v[154:155], v[198:199], v[86:87]
    v_cvt_pk_bf16_f32 v174, v84, v85
    v_cvt_pk_bf16_f32 v175, v86, v87
    ds_write_b64 v19, v[174:175] offset:2048
    s_waitcnt lgkmcnt(0)
    ds_read_b128 v[120:123], v7 offset:0
    ds_read_b128 v[124:127], v7 offset:1024
    ds_read_b128 v[128:131], v7 offset:2048
    ds_read_b128 v[132:135], v7 offset:3072
    s_mov_b32 s43, 0
    s_waitcnt lgkmcnt(3)
    buffer_store_dwordx4 v[120:123], v6, s[20:23], s43 offen sc1
    s_add_u32 s43, s43, 16384
    s_waitcnt lgkmcnt(2)
    buffer_store_dwordx4 v[124:127], v6, s[20:23], s43 offen sc1
    s_add_u32 s43, s43, 16384
    s_waitcnt lgkmcnt(1)
    buffer_store_dwordx4 v[128:131], v6, s[20:23], s43 offen sc1
    s_add_u32 s43, s43, 16384
    s_waitcnt lgkmcnt(0)
    buffer_store_dwordx4 v[132:135], v6, s[20:23], s43 offen sc1
K3_END:
    s_endpgm
K3_SLOW:
    s_mov_b32 s42, 1
    s_mov_b32 s34, 0
    s_mov_b32 s37, 0x30000
    s_mov_b32 s44, 0x30000
    v_mov_b32 v8, 0xff800000
    v_mov_b32 v9, 0xff800000
    s_mov_b32 s41, 0
    s_mov_b32 s43, 64
K3_MAXLOOP:
    buffer_load_dwordx4 a[0:3], v2, s[28:31], s41 offen
    buffer_load_dwordx4 a[4:7], v2, s[28:31], s41 offen offset:1024
    s_add_u32 s41, s41, 4096
    s_waitcnt vmcnt(0)
    v_mfma_f32_32x32x16_bf16 v[100:115], a[0:3], v[12:15], 0
    v_mfma_f32_32x32x16_bf16 v[116:131], a[0:3], v[20:23], 0
    v_mfma_f32_32x32x16_bf16 v[100:115], a[4:7], v[16:19], v[100:115]
    v_mfma_f32_32x32x16_bf16 v[116:131], a[4:7], v[24:27], v[116:131]
    s_nop 15
    v_max3_f32 v8, v8, v100, v101
    v_max3_f32 v8, v8, v102, v103
    v_max3_f32 v8, v8, v104, v105
    v_max3_f32 v8, v8, v106, v107
    v_max3_f32 v8, v8, v108, v109
    v_max3_f32 v8, v8, v110, v111
    v_max3_f32 v8, v8, v112, v113
    v_max3_f32 v8, v8, v114, v115
    v_max3_f32 v9, v9, v116, v117
    v_max3_f32 v9, v9, v118, v119
    v_max3_f32 v9, v9, v120, v121
    v_max3_f32 v9, v9, v122, v123
    v_max3_f32 v9, v9, v124, v125
    v_max3_f32 v9, v9, v126, v127
    v_max3_f32 v9, v9, v128, v129
    v_max3_f32 v9, v9, v130, v131
    s_sub_u32 s43, s43, 1
    s_cmp_lg_u32 s43, 0
    s_cbranch_scc1 K3_MAXLOOP
    buffer_load_dwordx4 a[0:3], v2, s[28:31], 0 offen
    buffer_load_dwordx4 a[4:7], v2, s[28:31], 0 offen offset:1024
    s_lshl_b32 s38, s36, 10
    s_cmp_lt_u32 s36, 2
    s_cselect_b32 s41, 4096, 0
    s_add_u32 s41, s41, s38
    s_mov_b32 m0, s38
    s_xor_b32 s38, s38, 0x8000
    buffer_load_dwordx4 v2, s[28:31], s41 offen lds
    s_add_u32 m0, m0, 4096
    s_add_u32 s41, s41, 4096
    buffer_load_dwordx4 v2, s[28:31], s41 offen lds
    s_add_u32 m0, m0, 4096
    s_add_u32 s41, s41, 4096
    buffer_load_dwordx4 v2, s[28:31], s41 offen lds
    s_add_u32 m0, m0, 4096
    s_add_u32 s41, s41, 4096
    buffer_load_dwordx4 v2, s[28:31], s41 offen lds
    s_add_u32 m0, m0, 4096
    s_add_u32 s41, s41, 4096
    buffer_load_dwordx4 v2, s[28:31], s41 offen lds
    s_add_u32 m0, m0, 4096
    s_add_u32 s41, s41, 4096
    buffer_load_dwordx4 v2, s[28:31], s41 offen lds
    s_add_u32 m0, m0, 4096
    s_add_u32 s41, s41, 4096
    buffer_load_dwordx4 v2, s[28:31], s41 offen lds
    s_add_u32 m0, m0, 4096
    s_add_u32 s41, s41, 4096
    buffer_load_dwordx4 v2, s[28:31], s41 offen lds
    s_add_u32 m0, m0, 4096
    s_add_u32 s41, s41, 4096
    v_mov_b64 v[60:61], 0
    v_mov_b64 v[62:63], 0
    v_mov_b64 v[64:65], 0
    v_mov_b64 v[66:67], 0
    v_mov_b64 v[68:69], 0
    v_mov_b64 v[70:71], 0
    v_mov_b64 v[72:73], 0
    v_mov_b64 v[74:75], 0
    v_mov_b64 v[76:77], 0
    v_mov_b64 v[78:79], 0
    v_mov_b64 v[80:81], 0
    v_mov_b64 v[82:83], 0
    v_mov_b64 v[84:85], 0
    v_mov_b64 v[86:87], 0
    v_mov_b64 v[88:89], 0
    v_mov_b64 v[90:91], 0
    v_mov_b64 v[92:93], 0
    v_mov_b64 v[94:95], 0
    v_mov_b64 v[96:97], 0
    v_mov_b64 v[98:99], 0
    v_accvgpr_write_b32 a8, 0
    v_accvgpr_write_b32 a9, 0
    v_accvgpr_write_b32 a10, 0
    v_accvgpr_write_b32 a11, 0
    v_accvgpr_write_b32 a12, 0
    v_accvgpr_write_b32 a13, 0
    v_accvgpr_write_b32 a14, 0
    v_accvgpr_write_b32 a15, 0
    v_mov_b64 v[140:141], 0
    v_mov_b64 v[142:143], 0
    v_mov_b64 v[144:145], 0
    v_mov_b64 v[146:147], 0
    v_mov_b32 v7, v2
    s_waitcnt vmcnt(0)
    s_branch K3_SETMAX
.p2align 8
CODE_END:
.section .rodata,"a"
.p2align 6
.amdhsa_kernel k1_mod_ln_kernel
  .amdhsa_next_free_vgpr 96
  .amdhsa_next_free_sgpr 60
  .amdhsa_accum_offset 96
  .amdhsa_group_segment_fixed_size 0
  .amdhsa_kernarg_size 104
  .amdhsa_user_sgpr_count 2
  .amdhsa_user_sgpr_kernarg_segment_ptr 1
  .amdhsa_system_sgpr_workgroup_id_x 1
  .amdhsa_float_denorm_mode_32 3
  .amdhsa_float_denorm_mode_16_64 3
.end_amdhsa_kernel
.p2align 6
.amdhsa_kernel k2_qkv_kernel
  .amdhsa_next_free_vgpr 260
  .amdhsa_next_free_sgpr 64
  .amdhsa_accum_offset 240
  .amdhsa_group_segment_fixed_size 0
  .amdhsa_kernarg_size 104
  .amdhsa_user_sgpr_count 2
  .amdhsa_user_sgpr_kernarg_segment_ptr 1
  .amdhsa_system_sgpr_workgroup_id_x 1
  .amdhsa_float_denorm_mode_32 3
  .amdhsa_float_denorm_mode_16_64 3
.end_amdhsa_kernel
.p2align 6
.amdhsa_kernel k3_attn_kernel
  .amdhsa_next_free_vgpr 320
  .amdhsa_next_free_sgpr 64
  .amdhsa_accum_offset 256
  .amdhsa_group_segment_fixed_size 0
  .amdhsa_kernarg_size 104
  .amdhsa_user_sgpr_count 2
  .amdhsa_user_sgpr_kernarg_segment_ptr 1
  .amdhsa_system_sgpr_workgroup_id_x 1
  .amdhsa_float_denorm_mode_32 3
  .amdhsa_float_denorm_mode_16_64 3
.end_amdhsa_kernel
```
